```python
import torch

def _softmax(x, axis=-1):
    return torch.softmax(x, dim=axis)
def _gelu(x):
    return torch.nn.functional.gelu(x, approximate="tanh")
def _silu(x):
    return torch.nn.functional.silu(x)
def _sigmoid(x):
    return torch.sigmoid(x)
def _layernorm(x, axis=-1, eps=1e-5):
    m = x.mean(dim=axis, keepdim=True)
    v = x.var(dim=axis, keepdim=True, unbiased=False)
    return (x - m) / torch.sqrt(v + eps)
def _scatter_add(tgt, idx, src, axis=0):
    return tgt.clone().index_add_(axis, idx, src)
def _segment_sum(src, seg, n):
    out = torch.zeros((n,) + src.shape[1:], dtype=src.dtype)
    return out.index_add_(0, seg, src)
def _pad(x, pw):
    flat = tuple(v for pair in reversed(pw) for v in pair)
    return torch.nn.functional.pad(x, flat)

kernel_name = 'interleave_layers__mha_block_cached__dense_activation_silu__decode'

def setup_inputs():

    _w = (lambda a: (lambda t: t.to(torch.bfloat16) if t.is_floating_point() else t)(torch.as_tensor(a)))
    def _A_setup():
        B, Sq, D = 1, 1, 640
        H, Sk, Dh = 32, 32768, 192
        return {
            "x": _w((lambda *s: torch.randn(*s, dtype=torch.bfloat16) * 0.1)(B, Sq, D)),
            "k_cache": _w((lambda *s: torch.randn(*s, dtype=torch.bfloat16) * 1.6)(B, H, Sk, Dh)),
            "v_cache": _w((lambda *s: torch.randn(*s, dtype=torch.bfloat16) * 1.6)(B, H, Sk, Dh)),
            "wq": _w((lambda *s: torch.randn(*s, dtype=torch.bfloat16) * 1.6)(D, H * Dh) * (D ** -0.5)),
            "wo": _w((lambda *s: torch.randn(*s, dtype=torch.bfloat16) * 1.6)(H * Dh, D) * ((H * Dh) ** -0.5)),
        }
    _A_in = _A_setup()

    def _B_setup():
        B, S, D, F = 1, 1, 640, 1536
        return {
            "x": _w((lambda *s: torch.randn(*s, dtype=torch.bfloat16) * 0.1)(B, S, D)),
            "w1": _w((lambda *s: torch.randn(*s, dtype=torch.bfloat16) * 0.8)(D, F) * (D ** -0.5)),
            "w2": _w((lambda *s: torch.randn(*s, dtype=torch.bfloat16) * 0.8)(F, D) * (F ** -0.5)),
        }
    _B_in = _B_setup()

    return {
        "A_x": _A_in["x"],
        "A_k_cache": _A_in["k_cache"],
        "A_v_cache": _A_in["v_cache"],
        "A_wq": _A_in["wq"],
        "A_wo": _A_in["wo"],
        "B_x": _B_in["x"],
        "B_w1": _B_in["w1"],
        "B_w2": _B_in["w2"],
    }

def reference(A_x, A_k_cache, A_v_cache, A_wq, A_wo, B_x, B_w1, B_w2):
    def _A_ref(x, k_cache, v_cache, wq, wo):
        B, Sq, D = x.shape
        H, Dh = 32, 192
        q = (lambda x, *d: x.permute(*d))((x @ wq).reshape(B, Sq, H, Dh), 0, 2, 1, 3)
        scores = torch.einsum("bhqd,bhkd->bhqk", q, k_cache) * (Dh ** -0.5)
        p = _softmax(scores, axis=-1)
        o = torch.einsum("bhqk,bhkd->bhqd", p, v_cache)
        return (lambda x, *d: x.permute(*d))(o, 0, 2, 1, 3).reshape(B, Sq, H * Dh) @ wo

    def _B_ref(x, w1, w2):
        h = torch.einsum("bsd,df->bsf", x, w1)
        h = _silu(h)
        out = torch.einsum("bsf,fd->bsd", h, w2)
        return out

    x = A_x
    x = x + _A_ref(_layernorm(x, axis=-1), A_k_cache, A_v_cache, A_wq, A_wo)
    x = x + _B_ref(_layernorm(x, axis=-1), B_w1, B_w2)
    x = x + _A_ref(_layernorm(x, axis=-1), A_k_cache, A_v_cache, A_wq, A_wo)
    x = x + _B_ref(_layernorm(x, axis=-1), B_w1, B_w2)
    return x
```

```asm
; @launch grid=(256,1,1) block=(256,1,1) lds=163840
.amdgcn_target "amdgcn-amd-amdhsa--gfx950"
.text
.globl interleave_layers__mha_block_cached__dense_activation_silu__decode_kernel
.p2align 8
.type interleave_layers__mha_block_cached__dense_activation_silu__decode_kernel,@function
interleave_layers__mha_block_cached__dense_activation_silu__decode_kernel:
    s_cmp_ge_u32 s2, 256
    s_cbranch_scc1 L_end
    s_load_dwordx2 s[4:5], s[0:1], 8
    s_load_dwordx2 s[32:33], s[0:1], 0
    s_load_dwordx2 s[8:9], s[0:1], 16
    s_load_dwordx2 s[16:17], s[0:1], 24
    s_load_dwordx2 s[20:21], s[0:1], 32
    s_load_dwordx2 s[24:25], s[0:1], 48
    s_load_dwordx2 s[28:29], s[0:1], 56
    s_load_dwordx2 s[36:37], s[0:1], 64
    s_load_dwordx2 s[40:41], s[0:1], 72
    s_load_dwordx2 s[12:13], s[0:1], 80
    v_lshrrev_b32 v1, 6, v0
    v_and_b32 v0, 63, v0
    v_readfirstlane_b32 s46, v1
    s_mov_b32 s34, 1280
    s_mov_b32 s35, 0x20000
    s_mov_b32 s6, 402653184
    s_mov_b32 s7, 0x20000
    s_mov_b32 s10, 402653184
    s_mov_b32 s11, 0x20000
    s_mov_b32 s18, 7864320
    s_mov_b32 s19, 0x20000
    s_mov_b32 s22, 7864320
    s_mov_b32 s23, 0x20000
    s_mov_b32 s26, 1966080
    s_mov_b32 s27, 0x20000
    s_mov_b32 s30, 1966080
    s_mov_b32 s31, 0x20000
    s_mov_b32 s42, 256
    s_mov_b32 s43, 0x20000
    s_mov_b32 s14, 12582912
    s_mov_b32 s15, 0x20000
    s_lshr_b32 s44, s2, 3
    s_and_b32 s45, s2, 7
    s_lshr_b32 s60, s2, 4
    s_lshr_b32 s61, s2, 5
    s_add_u32 s61, s61, s2
    s_and_b32 s61, s61, 3
    s_lshl2_add_u32 s60, s60, s61
    s_bfe_u32 s61, s2, 0x20002
    s_mul_i32 s62, s60, 43
    s_lshr_b32 s63, s62, 8
    s_lshr_b32 s62, s62, 7
    s_mul_i32 s64, s62, 3
    s_sub_u32 s64, s60, s64
    s_cmp_lg_u32 s64, 0
    s_addc_u32 s49, 42, 0
    s_mul_i32 s47, s64, 85
    s_add_u32 s47, s47, s49
    s_sub_u32 s47, s47, 42
    s_lshl_b32 s50, s62, 8
    s_add_u32 s47, s47, s50
    s_lshl_b32 s64, s64, 2
    s_add_u32 s64, s64, s61
    s_mul_i32 s51, s63, 6
    s_sub_u32 s51, s60, s51
    s_mul_i32 s48, s51, 43
    s_cmp_gt_u32 s51, 0
    s_subb_u32 s48, s48, 0
    s_cmp_gt_u32 s51, 3
    s_subb_u32 s48, s48, 0
    s_add_u32 s63, s63, 22
    s_cmp_ge_u32 s60, 60
    s_cselect_b32 s63, 21, s63
    s_cselect_b32 s50, 86, 0
    s_addc_u32 s51, s51, 0
    s_add_u32 s48, s48, s50
    s_lshl_b32 s50, s63, 8
    s_add_u32 s48, s48, s50
    s_lshl_b32 s51, s51, 2
    s_add_u32 s51, s51, s61
    s_bitcmp1_b32 s46, 0
    s_cselect_b32 s57, s63, s62
    s_cselect_b32 s65, s51, s64
    s_add_u32 s53, s48, 42
    s_mul_i32 s53, s53, 49152
    s_mul_i32 s60, s60, 42
    s_lshr_b32 s60, s60, 6
    s_add_u32 s48, s48, s60
    s_lshr_b32 s60, s61, 1
    s_lshl2_add_u32 s60, s60, s46
    s_lshl_b32 s60, s60, 2
    s_lshr_b32 s60, 0xc571b260, s60
    s_xor_b32 s61, s61, s46
    s_lshl_b32 s61, s61, 3
    s_xor_b32 s60, s60, s61
    s_and_b32 s60, s60, 15
    s_xor_b32 s61, s60, 8
    s_mul_i32 s60, s60, 3072
    s_mul_i32 s61, s61, 3072
    s_mul_i32 s47, s47, 49152
    s_mul_i32 s48, s48, 49152
    s_add_u32 s58, s48, s61
    s_add_u32 s48, s48, s60
    s_mov_b32 s50, s48
    v_bfe_u32 v1, v0, 1, 3
    v_mul_u32_u24 v1, 384, v1
    v_and_b32 v30, 1, v0
    v_lshl_add_u32 v1, v30, 6, v1
    v_and_b32 v30, 48, v0
    v_add_u32 v1, v1, v30
    s_waitcnt lgkmcnt(0)
    buffer_load_dwordx4 v[40:43], v1, s[4:7], s50 offen offset:0 nt
    buffer_load_dwordx4 v[44:47], v1, s[4:7], s50 offen offset:128 nt
    buffer_load_dwordx4 v[48:51], v1, s[4:7], s50 offen offset:256 nt
    s_add_u32 s50, s58, 49152
    s_cmp_ge_u32 s50, s53
    s_cselect_b32 s62, 2064384, 0
    s_sub_u32 s50, s50, s62
    buffer_load_dwordx4 v[52:55], v1, s[4:7], s50 offen offset:0 nt
    buffer_load_dwordx4 v[56:59], v1, s[4:7], s50 offen offset:128 nt
    buffer_load_dwordx4 v[60:63], v1, s[4:7], s50 offen offset:256 nt
    s_add_u32 s50, s48, 98304
    s_cmp_ge_u32 s50, s53
    s_cselect_b32 s62, 2064384, 0
    s_sub_u32 s50, s50, s62
    s_mov_b32 s0, s60
    s_branch L_main
L_rescale:
    s_nop 1
    v_max_f32_dpp v20, v31, v31 row_ror:8 row_mask:0xf bank_mask:0xf
    s_nop 1
    v_max_f32_dpp v20, v20, v20 row_bcast:15 row_mask:0xa bank_mask:0xf
    s_nop 1
    v_max_f32_dpp v20, v20, v20 row_bcast:31 row_mask:0xc bank_mask:0xf
    s_nop 1
    v_readlane_b32 s52, v20, 63
    s_nop 1
    v_mov_b32 v20, s52
    v_mul_f32 v20, 0xbfb8aa3b, v20
    v_sub_f32 v21, v20, v28
    v_exp_f32 v21, v21
    v_mov_b32 v28, v20
    v_mul_f32 v29, v29, v21
    v_mul_f32 v8, v8, v21
    v_mul_f32 v9, v9, v21
    v_mul_f32 v10, v10, v21
    v_mul_f32 v11, v11, v21
    v_mul_f32 v12, v12, v21
    v_mul_f32 v13, v13, v21
    v_mul_f32 v14, v14, v21
    v_mul_f32 v15, v15, v21
    v_mul_f32 v16, v16, v21
    v_mul_f32 v17, v17, v21
    v_mul_f32 v18, v18, v21
    v_mul_f32 v19, v19, v21
    s_setpc_b64 s[54:55]
L_patch:
    s_bitcmp1_b64 s[70:71], s59
    s_cbranch_scc1 L_hard
    v_lshrrev_b32 v30, 10, v80
    v_cmp_eq_u32 vcc, s59, v30
L_patch1:
    s_ff1_i32_b64 s60, vcc
    s_bitset0_b64 vcc, s60
    v_readlane_b32 s61, v80, s60
    v_readlane_b32 s62, v81, s60
    s_nop 1
    s_bfe_u32 s60, s61, 0x40006
    s_lshl_b64 exec, 1, s61
    s_cmp_eq_u32 s60, 0
    s_cselect_b32 s61, s62, 0
    v_xor_b32 v76, s61, v76
    s_cmp_eq_u32 s60, 1
    s_cselect_b32 s61, s62, 0
    v_xor_b32 v77, s61, v77
    s_cmp_eq_u32 s60, 2
    s_cselect_b32 s61, s62, 0
    v_xor_b32 v78, s61, v78
    s_cmp_eq_u32 s60, 3
    s_cselect_b32 s61, s62, 0
    v_xor_b32 v79, s61, v79
    s_cmp_eq_u32 s60, 4
    s_cselect_b32 s61, s62, 0
    v_xor_b32 v36, s61, v36
    s_cmp_eq_u32 s60, 5
    s_cselect_b32 s61, s62, 0
    v_xor_b32 v37, s61, v37
    s_cmp_eq_u32 s60, 6
    s_cselect_b32 s61, s62, 0
    v_xor_b32 v38, s61, v38
    s_cmp_eq_u32 s60, 7
    s_cselect_b32 s61, s62, 0
    v_xor_b32 v39, s61, v39
    s_cmp_eq_u32 s60, 8
    s_cselect_b32 s61, s62, 0
    v_xor_b32 v24, s61, v24
    s_cmp_eq_u32 s60, 9
    s_cselect_b32 s61, s62, 0
    v_xor_b32 v25, s61, v25
    s_cmp_eq_u32 s60, 10
    s_cselect_b32 s61, s62, 0
    v_xor_b32 v26, s61, v26
    s_cmp_eq_u32 s60, 11
    s_cselect_b32 s61, s62, 0
    v_xor_b32 v27, s61, v27
    s_mov_b64 exec, -1
    s_cmp_lg_u64 vcc, 0
    s_cbranch_scc1 L_patch1
    s_setpc_b64 s[54:55]
L_hard:
    s_cmp_ge_u32 s59, 36
    s_cselect_b32 s60, 27, 0
    s_sub_u32 s60, s59, s60
    s_bitcmp1_b32 s60, 0
    s_cselect_b32 s61, s58, s48
    s_mul_i32 s60, s60, 49152
    s_add_u32 s60, s60, s61
    s_cmp_ge_u32 s60, s53
    s_cselect_b32 s61, 2064384, 0
    s_sub_u32 s60, s60, s61
    s_cmp_ge_u32 s59, 36
    s_cbranch_scc1 L_hardv
    buffer_load_dwordx4 v[76:79], v1, s[4:7], s60 offen offset:0
    buffer_load_dwordx4 v[36:39], v1, s[4:7], s60 offen offset:128
    buffer_load_dwordx4 v[24:27], v1, s[4:7], s60 offen offset:256
    s_waitcnt vmcnt(0)
    s_setpc_b64 s[54:55]
L_hardv:
    buffer_load_dwordx4 v[76:79], v2, s[8:11], s60 offen offset:0
    buffer_load_dwordx4 v[36:39], v2, s[8:11], s60 offen offset:128
    buffer_load_dwordx4 v[24:27], v2, s[8:11], s60 offen offset:256
    s_waitcnt vmcnt(0)
    s_setpc_b64 s[54:55]
L_ko:
    v_alignbit_b32 v78, v76, v76, 4
    v_and_b32 v20, s101, v76
    v_alignbit_b32 v38, v36, v36, 4
    v_and_b32 v21, s101, v36
    v_alignbit_b32 v26, v24, v24, 4
    v_and_b32 v22, s101, v24
    v_perm_b32 v76, v20, v77, s74
    v_perm_b32 v77, v20, v77, s75
    v_and_b32 v20, s101, v78
    v_perm_b32 v36, v21, v37, s74
    v_perm_b32 v37, v21, v37, s75
    v_and_b32 v21, s101, v38
    v_perm_b32 v24, v22, v25, s74
    v_perm_b32 v25, v22, v25, s75
    v_and_b32 v22, s101, v26
    v_perm_b32 v78, v20, v79, s74
    v_perm_b32 v79, v20, v79, s75
    v_perm_b32 v38, v21, v39, s74
    v_perm_b32 v39, v21, v39, s75
    v_perm_b32 v26, v22, v27, s74
    v_perm_b32 v27, v22, v27, s75
    v_pk_min_u16 v20, v76, 1 op_sel_hi:[1,0]
    v_pk_min_u16 v21, v77, 1 op_sel_hi:[1,0]
    v_pk_min_u16 v22, v78, 1 op_sel_hi:[1,0]
    v_pk_min_u16 v23, v79, 1 op_sel_hi:[1,0]
    v_pk_mad_u16 v76, v20, s100, v76
    v_pk_mad_u16 v77, v21, s100, v77
    v_pk_mad_u16 v78, v22, s100, v78
    v_pk_mad_u16 v79, v23, s100, v79
    v_pk_min_u16 v20, v36, 1 op_sel_hi:[1,0]
    v_pk_min_u16 v21, v37, 1 op_sel_hi:[1,0]
    v_pk_min_u16 v22, v38, 1 op_sel_hi:[1,0]
    v_pk_min_u16 v23, v39, 1 op_sel_hi:[1,0]
    v_pk_mad_u16 v36, v20, s100, v36
    v_pk_mad_u16 v37, v21, s100, v37
    v_pk_mad_u16 v38, v22, s100, v38
    v_pk_mad_u16 v39, v23, s100, v39
    v_pk_min_u16 v20, v24, 1 op_sel_hi:[1,0]
    v_pk_min_u16 v21, v25, 1 op_sel_hi:[1,0]
    v_pk_min_u16 v22, v26, 1 op_sel_hi:[1,0]
    v_pk_min_u16 v23, v27, 1 op_sel_hi:[1,0]
    v_pk_mad_u16 v24, v20, s100, v24
    v_pk_mad_u16 v25, v21, s100, v25
    v_pk_mad_u16 v26, v22, s100, v26
    v_pk_mad_u16 v27, v23, s100, v27
    s_bitcmp1_b64 s[68:69], s59
    s_cbranch_scc0 L_ko1
    s_call_b64 s[54:55], L_patch
L_ko1:
    v_mfma_f32_16x16x32_bf16 v[20:23], v[76:79], a[240:243], 0
    v_mfma_f32_16x16x32_bf16 v[20:23], v[36:39], a[244:247], v[20:23]
    v_mfma_f32_16x16x32_bf16 v[20:23], v[24:27], a[248:251], v[20:23]
    s_nop 0
L_kot:
    s_nop 6
    v_add_f32_dpp v30, v21, v20 quad_perm:[1,0,3,2] row_mask:0xf bank_mask:0x3
    s_nop 1
    v_add_f32_dpp v30, v23, v22 quad_perm:[1,0,3,2] row_mask:0xf bank_mask:0xc
    s_nop 1
    v_mov_b32_dpp v31, v30 quad_perm:[0,0,2,2] row_mask:0xf bank_mask:0xf
    v_cvt_pk_bf16_f32 v31, 0, v31
    v_mul_f32 v31, 0x3d93cd3a, v31
    v_cvt_pk_bf16_f32 v31, v31, v31
    v_and_b32 v31, 0xffff0000, v31
    v_cmp_lt_f32 vcc, s52, v31
    s_cbranch_vccz L_ko2
    s_call_b64 s[54:55], L_rescale
L_ko2:
    v_fmamk_f32 v31, v31, 0x3fb8aa3b, v28
    v_exp_f32 v31, v31
    s_nop 0
    v_add_f32 v29, v29, v31
    v_cvt_pk_bf16_f32 v34, v31, v31
    s_setpc_b64 s[66:67]
L_ks:
    v_alignbit_b32 v78, v76, v76, 4
    v_and_b32 v20, s101, v76
    v_alignbit_b32 v38, v36, v36, 4
    v_and_b32 v21, s101, v36
    v_alignbit_b32 v26, v24, v24, 4
    v_and_b32 v22, s101, v24
    v_perm_b32 v76, v20, v77, s74
    v_perm_b32 v77, v20, v77, s75
    v_and_b32 v20, s101, v78
    v_perm_b32 v36, v21, v37, s74
    v_perm_b32 v37, v21, v37, s75
    v_and_b32 v21, s101, v38
    v_perm_b32 v24, v22, v25, s74
    v_perm_b32 v25, v22, v25, s75
    v_and_b32 v22, s101, v26
    v_perm_b32 v78, v20, v79, s74
    v_perm_b32 v79, v20, v79, s75
    v_perm_b32 v38, v21, v39, s74
    v_perm_b32 v39, v21, v39, s75
    v_perm_b32 v26, v22, v27, s74
    v_perm_b32 v27, v22, v27, s75
    v_pk_min_u16 v20, v76, 1 op_sel_hi:[1,0]
    v_pk_min_u16 v21, v77, 1 op_sel_hi:[1,0]
    v_pk_min_u16 v22, v78, 1 op_sel_hi:[1,0]
    v_pk_min_u16 v23, v79, 1 op_sel_hi:[1,0]
    v_pk_mad_u16 v76, v20, s100, v76
    v_pk_mad_u16 v77, v21, s100, v77
    v_pk_mad_u16 v78, v22, s100, v78
    v_pk_mad_u16 v79, v23, s100, v79
    v_pk_min_u16 v20, v36, 1 op_sel_hi:[1,0]
    v_pk_min_u16 v21, v37, 1 op_sel_hi:[1,0]
    v_pk_min_u16 v22, v38, 1 op_sel_hi:[1,0]
    v_pk_min_u16 v23, v39, 1 op_sel_hi:[1,0]
    v_pk_mad_u16 v36, v20, s100, v36
    v_pk_mad_u16 v37, v21, s100, v37
    v_pk_mad_u16 v38, v22, s100, v38
    v_pk_mad_u16 v39, v23, s100, v39
    v_pk_min_u16 v20, v24, 1 op_sel_hi:[1,0]
    v_pk_min_u16 v21, v25, 1 op_sel_hi:[1,0]
    v_pk_min_u16 v22, v26, 1 op_sel_hi:[1,0]
    v_pk_min_u16 v23, v27, 1 op_sel_hi:[1,0]
    v_pk_mad_u16 v24, v20, s100, v24
    v_pk_mad_u16 v25, v21, s100, v25
    v_pk_mad_u16 v26, v22, s100, v26
    v_pk_mad_u16 v27, v23, s100, v27
    s_bitcmp1_b64 s[68:69], s59
    s_cbranch_scc0 L_ks1
    s_call_b64 s[54:55], L_patch
L_ks1:
    v_mfma_f32_16x16x32_bf16 v[20:23], v[76:79], a[240:243], 0
    v_mfma_f32_16x16x32_bf16 v[20:23], v[36:39], a[244:247], v[20:23]
    v_mfma_f32_16x16x32_bf16 v[20:23], v[24:27], a[248:251], v[20:23]
    s_nop 0
L_kst:
    s_nop 6
    v_add_f32_dpp v30, v21, v20 quad_perm:[1,0,3,2] row_mask:0xf bank_mask:0x3
    s_nop 1
    v_add_f32_dpp v30, v23, v22 quad_perm:[1,0,3,2] row_mask:0xf bank_mask:0xc
    s_nop 1
    v_mov_b32_dpp v31, v30 quad_perm:[0,0,2,2] row_mask:0xf bank_mask:0xf
    v_cvt_pk_bf16_f32 v31, 0, v31
    v_mul_f32 v31, 0x3d93cd3a, v31
    v_cvt_pk_bf16_f32 v31, v31, v31
    s_setpc_b64 s[66:67]
L_vo:
    v_alignbit_b32 v78, v76, v76, 4
    v_and_b32 v20, s101, v76
    v_alignbit_b32 v38, v36, v36, 4
    v_and_b32 v21, s101, v36
    v_alignbit_b32 v26, v24, v24, 4
    v_and_b32 v22, s101, v24
    v_perm_b32 v76, v20, v77, s74
    v_perm_b32 v77, v20, v77, s75
    v_and_b32 v20, s101, v78
    v_perm_b32 v36, v21, v37, s74
    v_perm_b32 v37, v21, v37, s75
    v_and_b32 v21, s101, v38
    v_perm_b32 v24, v22, v25, s74
    v_perm_b32 v25, v22, v25, s75
    v_and_b32 v22, s101, v26
    v_perm_b32 v78, v20, v79, s74
    v_perm_b32 v79, v20, v79, s75
    v_perm_b32 v38, v21, v39, s74
    v_perm_b32 v39, v21, v39, s75
    v_perm_b32 v26, v22, v27, s74
    v_perm_b32 v27, v22, v27, s75
    v_pk_min_u16 v20, v76, 1 op_sel_hi:[1,0]
    v_pk_min_u16 v21, v77, 1 op_sel_hi:[1,0]
    v_pk_min_u16 v22, v78, 1 op_sel_hi:[1,0]
    v_pk_min_u16 v23, v79, 1 op_sel_hi:[1,0]
    v_pk_mad_u16 v76, v20, s99, v76
    v_pk_mad_u16 v77, v21, s99, v77
    v_pk_mad_u16 v78, v22, s99, v78
    v_pk_mad_u16 v79, v23, s99, v79
    v_pk_min_u16 v20, v36, 1 op_sel_hi:[1,0]
    v_pk_min_u16 v21, v37, 1 op_sel_hi:[1,0]
    v_pk_min_u16 v22, v38, 1 op_sel_hi:[1,0]
    v_pk_min_u16 v23, v39, 1 op_sel_hi:[1,0]
    v_pk_mad_u16 v36, v20, s99, v36
    v_pk_mad_u16 v37, v21, s99, v37
    v_pk_mad_u16 v38, v22, s99, v38
    v_pk_mad_u16 v39, v23, s99, v39
    v_pk_min_u16 v20, v24, 1 op_sel_hi:[1,0]
    v_pk_min_u16 v21, v25, 1 op_sel_hi:[1,0]
    v_pk_min_u16 v22, v26, 1 op_sel_hi:[1,0]
    v_pk_min_u16 v23, v27, 1 op_sel_hi:[1,0]
    v_pk_mad_u16 v24, v20, s99, v24
    v_pk_mad_u16 v25, v21, s99, v25
    v_pk_mad_u16 v26, v22, s99, v26
    v_pk_mad_u16 v27, v23, s99, v27
    s_bitcmp1_b64 s[68:69], s59
    s_cbranch_scc0 L_vo1
    s_call_b64 s[54:55], L_patch
L_vo1:
    v_and_b32 v20, v4, v34
    v_and_b32 v21, v5, v34
    v_and_b32 v22, v6, v34
    v_and_b32 v23, v7, v34
    s_nop 1
    v_mfma_f32_16x16x32_bf16 v[8:11], v[20:23], v[76:79], v[8:11]
    v_mfma_f32_16x16x32_bf16 v[12:15], v[20:23], v[36:39], v[12:15]
    v_mfma_f32_16x16x32_bf16 v[16:19], v[20:23], v[24:27], v[16:19]
    s_setpc_b64 s[66:67]
L_kat:
    s_nop 6
    v_add_f32_dpp v30, v21, v20 quad_perm:[1,0,3,2] row_mask:0xf bank_mask:0x3
    s_nop 1
    v_add_f32_dpp v30, v23, v22 quad_perm:[1,0,3,2] row_mask:0xf bank_mask:0xc
    s_nop 1
    v_mov_b32_dpp v31, v30 quad_perm:[0,0,2,2] row_mask:0xf bank_mask:0xf
    v_cvt_pk_bf16_f32 v31, 0, v31
    v_mul_f32 v31, 0x3d93cd3a, v31
    v_cvt_pk_bf16_f32 v31, v31, v31
    ds_write_b16 v33, v31 offset:0
    v_and_b32 v30, 0xffff0000, v31
    v_max_f32 v35, v35, v30
    v_add_u32 v33, 16, v33
    s_setpc_b64 s[66:67]
L_pst:
    ds_read_u16_d16_hi v34, v33
    v_add_u32 v33, 16, v33
L_prob:
    s_waitcnt lgkmcnt(0)
    v_fmamk_f32 v31, v34, 0x3fb8aa3b, v28
    v_exp_f32 v31, v31
    s_nop 0
    v_add_f32 v29, v29, v31
    v_cvt_pk_bf16_f32 v31, v31, v31
    v_and_b32 v24, v4, v31
    v_and_b32 v25, v5, v31
    v_and_b32 v26, v6, v31
    v_and_b32 v27, v7, v31
    s_setpc_b64 s[66:67]
L_pack0:
    v_pk_sub_u16 v76, v40, 1 op_sel_hi:[1,0]
    v_pk_sub_u16 v77, v41, 1 op_sel_hi:[1,0]
    v_pk_sub_u16 v78, v42, 1 op_sel_hi:[1,0]
    v_pk_sub_u16 v79, v43, 1 op_sel_hi:[1,0]
    v_pk_sub_u16 v20, v40, s99 clamp
    v_pk_sub_u16 v21, v41, s99 clamp
    v_pk_sub_u16 v22, v42, s99 clamp
    v_pk_sub_u16 v23, v43, s99 clamp
    v_pk_min_u16 v76, v76, v77
    v_pk_min_u16 v78, v78, v79
    v_perm_b32 v77, v21, v20, s72
    v_perm_b32 v79, v23, v22, s72
    v_pk_min_u16 v30, v76, v78
    v_perm_b32 v76, v21, v20, s73
    v_perm_b32 v78, v23, v22, s73
    v_pk_sub_u16 v36, v44, 1 op_sel_hi:[1,0]
    v_pk_sub_u16 v37, v45, 1 op_sel_hi:[1,0]
    v_pk_sub_u16 v38, v46, 1 op_sel_hi:[1,0]
    v_pk_sub_u16 v39, v47, 1 op_sel_hi:[1,0]
    v_pk_sub_u16 v20, v44, s99 clamp
    v_pk_sub_u16 v21, v45, s99 clamp
    v_pk_sub_u16 v22, v46, s99 clamp
    v_pk_sub_u16 v23, v47, s99 clamp
    v_pk_min_u16 v36, v36, v37
    v_pk_min_u16 v38, v38, v39
    v_perm_b32 v37, v21, v20, s72
    v_perm_b32 v39, v23, v22, s72
    v_pk_min_u16 v30, v30, v36
    v_pk_min_u16 v30, v30, v38
    v_perm_b32 v36, v21, v20, s73
    v_perm_b32 v38, v23, v22, s73
    v_pk_sub_u16 v24, v48, 1 op_sel_hi:[1,0]
    v_pk_sub_u16 v25, v49, 1 op_sel_hi:[1,0]
    v_pk_sub_u16 v26, v50, 1 op_sel_hi:[1,0]
    v_pk_sub_u16 v27, v51, 1 op_sel_hi:[1,0]
    v_pk_sub_u16 v20, v48, s99 clamp
    v_pk_sub_u16 v21, v49, s99 clamp
    v_pk_sub_u16 v22, v50, s99 clamp
    v_pk_sub_u16 v23, v51, s99 clamp
    v_pk_min_u16 v24, v24, v25
    v_pk_min_u16 v26, v26, v27
    v_perm_b32 v25, v21, v20, s72
    v_perm_b32 v27, v23, v22, s72
    v_pk_min_u16 v30, v30, v24
    v_pk_min_u16 v30, v30, v26
    v_perm_b32 v24, v21, v20, s73
    v_perm_b32 v26, v23, v22, s73
    v_or3_b32 v20, v76, v78, v36
    v_or3_b32 v21, v38, v24, v26
    v_pk_sub_u16 v30, s99, v30 clamp
    v_alignbit_b32 v78, v78, v78, 28
    v_alignbit_b32 v38, v38, v38, 28
    v_alignbit_b32 v26, v26, v26, 28
    v_or_b32 v20, v20, v21
    v_and_b32 v20, 0x78787878, v20
    v_bfi_b32 v76, s101, v76, v78
    v_bfi_b32 v36, s101, v36, v38
    v_bfi_b32 v24, s101, v24, v26
    v_or_b32 v30, v30, v20
    v_cmp_ne_u32 vcc, 0, v30
    s_setpc_b64 s[66:67]
L_pack1:
    v_pk_sub_u16 v76, v52, 1 op_sel_hi:[1,0]
    v_pk_sub_u16 v77, v53, 1 op_sel_hi:[1,0]
    v_pk_sub_u16 v78, v54, 1 op_sel_hi:[1,0]
    v_pk_sub_u16 v79, v55, 1 op_sel_hi:[1,0]
    v_pk_sub_u16 v20, v52, s99 clamp
    v_pk_sub_u16 v21, v53, s99 clamp
    v_pk_sub_u16 v22, v54, s99 clamp
    v_pk_sub_u16 v23, v55, s99 clamp
    v_pk_min_u16 v76, v76, v77
    v_pk_min_u16 v78, v78, v79
    v_perm_b32 v77, v21, v20, s72
    v_perm_b32 v79, v23, v22, s72
    v_pk_min_u16 v30, v76, v78
    v_perm_b32 v76, v21, v20, s73
    v_perm_b32 v78, v23, v22, s73
    v_pk_sub_u16 v36, v56, 1 op_sel_hi:[1,0]
    v_pk_sub_u16 v37, v57, 1 op_sel_hi:[1,0]
    v_pk_sub_u16 v38, v58, 1 op_sel_hi:[1,0]
    v_pk_sub_u16 v39, v59, 1 op_sel_hi:[1,0]
    v_pk_sub_u16 v20, v56, s99 clamp
    v_pk_sub_u16 v21, v57, s99 clamp
    v_pk_sub_u16 v22, v58, s99 clamp
    v_pk_sub_u16 v23, v59, s99 clamp
    v_pk_min_u16 v36, v36, v37
    v_pk_min_u16 v38, v38, v39
    v_perm_b32 v37, v21, v20, s72
    v_perm_b32 v39, v23, v22, s72
    v_pk_min_u16 v30, v30, v36
    v_pk_min_u16 v30, v30, v38
    v_perm_b32 v36, v21, v20, s73
    v_perm_b32 v38, v23, v22, s73
    v_pk_sub_u16 v24, v60, 1 op_sel_hi:[1,0]
    v_pk_sub_u16 v25, v61, 1 op_sel_hi:[1,0]
    v_pk_sub_u16 v26, v62, 1 op_sel_hi:[1,0]
    v_pk_sub_u16 v27, v63, 1 op_sel_hi:[1,0]
    v_pk_sub_u16 v20, v60, s99 clamp
    v_pk_sub_u16 v21, v61, s99 clamp
    v_pk_sub_u16 v22, v62, s99 clamp
    v_pk_sub_u16 v23, v63, s99 clamp
    v_pk_min_u16 v24, v24, v25
    v_pk_min_u16 v26, v26, v27
    v_perm_b32 v25, v21, v20, s72
    v_perm_b32 v27, v23, v22, s72
    v_pk_min_u16 v30, v30, v24
    v_pk_min_u16 v30, v30, v26
    v_perm_b32 v24, v21, v20, s73
    v_perm_b32 v26, v23, v22, s73
    v_or3_b32 v20, v76, v78, v36
    v_or3_b32 v21, v38, v24, v26
    v_pk_sub_u16 v30, s99, v30 clamp
    v_alignbit_b32 v78, v78, v78, 28
    v_alignbit_b32 v38, v38, v38, 28
    v_alignbit_b32 v26, v26, v26, 28
    v_or_b32 v20, v20, v21
    v_and_b32 v20, 0x78787878, v20
    v_bfi_b32 v76, s101, v76, v78
    v_bfi_b32 v36, s101, v36, v38
    v_bfi_b32 v24, s101, v24, v26
    v_or_b32 v30, v30, v20
    v_cmp_ne_u32 vcc, 0, v30
    s_setpc_b64 s[66:67]
L_pack2:
    v_pk_sub_u16 v76, v64, 1 op_sel_hi:[1,0]
    v_pk_sub_u16 v77, v65, 1 op_sel_hi:[1,0]
    v_pk_sub_u16 v78, v66, 1 op_sel_hi:[1,0]
    v_pk_sub_u16 v79, v67, 1 op_sel_hi:[1,0]
    v_pk_sub_u16 v20, v64, s99 clamp
    v_pk_sub_u16 v21, v65, s99 clamp
    v_pk_sub_u16 v22, v66, s99 clamp
    v_pk_sub_u16 v23, v67, s99 clamp
    v_pk_min_u16 v76, v76, v77
    v_pk_min_u16 v78, v78, v79
    v_perm_b32 v77, v21, v20, s72
    v_perm_b32 v79, v23, v22, s72
    v_pk_min_u16 v30, v76, v78
    v_perm_b32 v76, v21, v20, s73
    v_perm_b32 v78, v23, v22, s73
    v_pk_sub_u16 v36, v68, 1 op_sel_hi:[1,0]
    v_pk_sub_u16 v37, v69, 1 op_sel_hi:[1,0]
    v_pk_sub_u16 v38, v70, 1 op_sel_hi:[1,0]
    v_pk_sub_u16 v39, v71, 1 op_sel_hi:[1,0]
    v_pk_sub_u16 v20, v68, s99 clamp
    v_pk_sub_u16 v21, v69, s99 clamp
    v_pk_sub_u16 v22, v70, s99 clamp
    v_pk_sub_u16 v23, v71, s99 clamp
    v_pk_min_u16 v36, v36, v37
    v_pk_min_u16 v38, v38, v39
    v_perm_b32 v37, v21, v20, s72
    v_perm_b32 v39, v23, v22, s72
    v_pk_min_u16 v30, v30, v36
    v_pk_min_u16 v30, v30, v38
    v_perm_b32 v36, v21, v20, s73
    v_perm_b32 v38, v23, v22, s73
    v_pk_sub_u16 v24, v72, 1 op_sel_hi:[1,0]
    v_pk_sub_u16 v25, v73, 1 op_sel_hi:[1,0]
    v_pk_sub_u16 v26, v74, 1 op_sel_hi:[1,0]
    v_pk_sub_u16 v27, v75, 1 op_sel_hi:[1,0]
    v_pk_sub_u16 v20, v72, s99 clamp
    v_pk_sub_u16 v21, v73, s99 clamp
    v_pk_sub_u16 v22, v74, s99 clamp
    v_pk_sub_u16 v23, v75, s99 clamp
    v_pk_min_u16 v24, v24, v25
    v_pk_min_u16 v26, v26, v27
    v_perm_b32 v25, v21, v20, s72
    v_perm_b32 v27, v23, v22, s72
    v_pk_min_u16 v30, v30, v24
    v_pk_min_u16 v30, v30, v26
    v_perm_b32 v24, v21, v20, s73
    v_perm_b32 v26, v23, v22, s73
    v_or3_b32 v20, v76, v78, v36
    v_or3_b32 v21, v38, v24, v26
    v_pk_sub_u16 v30, s99, v30 clamp
    v_alignbit_b32 v78, v78, v78, 28
    v_alignbit_b32 v38, v38, v38, 28
    v_alignbit_b32 v26, v26, v26, 28
    v_or_b32 v20, v20, v21
    v_and_b32 v20, 0x78787878, v20
    v_bfi_b32 v76, s101, v76, v78
    v_bfi_b32 v36, s101, v36, v38
    v_bfi_b32 v24, s101, v24, v26
    v_or_b32 v30, v30, v20
    v_cmp_ne_u32 vcc, 0, v30
    s_setpc_b64 s[66:67]
L_pexc0:
    s_call_b64 s[54:55], L_unpack
    v_xor_b32 v76, v40, v76
    v_xor_b32 v77, v41, v77
    v_xor_b32 v78, v42, v78
    v_xor_b32 v79, v43, v79
    v_xor_b32 v36, v44, v36
    v_xor_b32 v37, v45, v37
    v_xor_b32 v38, v46, v38
    v_xor_b32 v39, v47, v39
    v_xor_b32 v24, v48, v24
    v_xor_b32 v25, v49, v25
    v_xor_b32 v26, v50, v26
    v_xor_b32 v27, v51, v27
    s_branch L_pexc
L_pexc1:
    s_call_b64 s[54:55], L_unpack
    v_xor_b32 v76, v52, v76
    v_xor_b32 v77, v53, v77
    v_xor_b32 v78, v54, v78
    v_xor_b32 v79, v55, v79
    v_xor_b32 v36, v56, v36
    v_xor_b32 v37, v57, v37
    v_xor_b32 v38, v58, v38
    v_xor_b32 v39, v59, v39
    v_xor_b32 v24, v60, v24
    v_xor_b32 v25, v61, v25
    v_xor_b32 v26, v62, v26
    v_xor_b32 v27, v63, v27
    s_branch L_pexc
L_pexc2:
    s_call_b64 s[54:55], L_unpack
    v_xor_b32 v76, v64, v76
    v_xor_b32 v77, v65, v77
    v_xor_b32 v78, v66, v78
    v_xor_b32 v79, v67, v79
    v_xor_b32 v36, v68, v36
    v_xor_b32 v37, v69, v37
    v_xor_b32 v38, v70, v38
    v_xor_b32 v39, v71, v39
    v_xor_b32 v24, v72, v24
    v_xor_b32 v25, v73, v25
    v_xor_b32 v26, v74, v26
    v_xor_b32 v27, v75, v27
L_pexc:
    s_bitset1_b64 s[68:69], s59
    v_cmp_ne_u32 vcc, 0, v76
    s_cbranch_vccz L_pexcn0
    v_mov_b32 v30, v76
    s_movk_i32 s62, 0
    s_call_b64 s[54:55], L_append
L_pexcn0:
    v_cmp_ne_u32 vcc, 0, v77
    s_cbranch_vccz L_pexcn1
    v_mov_b32 v30, v77
    s_movk_i32 s62, 64
    s_call_b64 s[54:55], L_append
L_pexcn1:
    v_cmp_ne_u32 vcc, 0, v78
    s_cbranch_vccz L_pexcn2
    v_mov_b32 v30, v78
    s_movk_i32 s62, 128
    s_call_b64 s[54:55], L_append
L_pexcn2:
    v_cmp_ne_u32 vcc, 0, v79
    s_cbranch_vccz L_pexcn3
    v_mov_b32 v30, v79
    s_movk_i32 s62, 192
    s_call_b64 s[54:55], L_append
L_pexcn3:
    v_cmp_ne_u32 vcc, 0, v36
    s_cbranch_vccz L_pexcn4
    v_mov_b32 v30, v36
    s_movk_i32 s62, 256
    s_call_b64 s[54:55], L_append
L_pexcn4:
    v_cmp_ne_u32 vcc, 0, v37
    s_cbranch_vccz L_pexcn5
    v_mov_b32 v30, v37
    s_movk_i32 s62, 320
    s_call_b64 s[54:55], L_append
L_pexcn5:
    v_cmp_ne_u32 vcc, 0, v38
    s_cbranch_vccz L_pexcn6
    v_mov_b32 v30, v38
    s_movk_i32 s62, 384
    s_call_b64 s[54:55], L_append
L_pexcn6:
    v_cmp_ne_u32 vcc, 0, v39
    s_cbranch_vccz L_pexcn7
    v_mov_b32 v30, v39
    s_movk_i32 s62, 448
    s_call_b64 s[54:55], L_append
L_pexcn7:
    v_cmp_ne_u32 vcc, 0, v24
    s_cbranch_vccz L_pexcn8
    v_mov_b32 v30, v24
    s_movk_i32 s62, 512
    s_call_b64 s[54:55], L_append
L_pexcn8:
    v_cmp_ne_u32 vcc, 0, v25
    s_cbranch_vccz L_pexcn9
    v_mov_b32 v30, v25
    s_movk_i32 s62, 576
    s_call_b64 s[54:55], L_append
L_pexcn9:
    v_cmp_ne_u32 vcc, 0, v26
    s_cbranch_vccz L_pexcn10
    v_mov_b32 v30, v26
    s_movk_i32 s62, 640
    s_call_b64 s[54:55], L_append
L_pexcn10:
    v_cmp_ne_u32 vcc, 0, v27
    s_cbranch_vccz L_pexcn11
    v_mov_b32 v30, v27
    s_movk_i32 s62, 704
    s_call_b64 s[54:55], L_append
L_pexcn11:
    s_setpc_b64 s[66:67]
L_unpack:
    v_alignbit_b32 v78, v76, v76, 4
    v_and_b32 v20, s101, v76
    v_alignbit_b32 v38, v36, v36, 4
    v_and_b32 v21, s101, v36
    v_alignbit_b32 v26, v24, v24, 4
    v_and_b32 v22, s101, v24
    v_perm_b32 v76, v20, v77, s74
    v_perm_b32 v77, v20, v77, s75
    v_and_b32 v20, s101, v78
    v_perm_b32 v36, v21, v37, s74
    v_perm_b32 v37, v21, v37, s75
    v_and_b32 v21, s101, v38
    v_perm_b32 v24, v22, v25, s74
    v_perm_b32 v25, v22, v25, s75
    v_and_b32 v22, s101, v26
    v_perm_b32 v78, v20, v79, s74
    v_perm_b32 v79, v20, v79, s75
    v_perm_b32 v38, v21, v39, s74
    v_perm_b32 v39, v21, v39, s75
    v_perm_b32 v26, v22, v27, s74
    v_perm_b32 v27, v22, v27, s75
    v_pk_min_u16 v20, v76, 1 op_sel_hi:[1,0]
    v_pk_min_u16 v21, v77, 1 op_sel_hi:[1,0]
    v_pk_min_u16 v22, v78, 1 op_sel_hi:[1,0]
    v_pk_min_u16 v23, v79, 1 op_sel_hi:[1,0]
    v_pk_mad_u16 v76, v20, s99, v76
    v_pk_mad_u16 v77, v21, s99, v77
    v_pk_mad_u16 v78, v22, s99, v78
    v_pk_mad_u16 v79, v23, s99, v79
    v_pk_min_u16 v20, v36, 1 op_sel_hi:[1,0]
    v_pk_min_u16 v21, v37, 1 op_sel_hi:[1,0]
    v_pk_min_u16 v22, v38, 1 op_sel_hi:[1,0]
    v_pk_min_u16 v23, v39, 1 op_sel_hi:[1,0]
    v_pk_mad_u16 v36, v20, s99, v36
    v_pk_mad_u16 v37, v21, s99, v37
    v_pk_mad_u16 v38, v22, s99, v38
    v_pk_mad_u16 v39, v23, s99, v39
    v_pk_min_u16 v20, v24, 1 op_sel_hi:[1,0]
    v_pk_min_u16 v21, v25, 1 op_sel_hi:[1,0]
    v_pk_min_u16 v22, v26, 1 op_sel_hi:[1,0]
    v_pk_min_u16 v23, v27, 1 op_sel_hi:[1,0]
    v_pk_mad_u16 v24, v20, s99, v24
    v_pk_mad_u16 v25, v21, s99, v25
    v_pk_mad_u16 v26, v22, s99, v26
    v_pk_mad_u16 v27, v23, s99, v27
    s_setpc_b64 s[54:55]
L_append:
    s_lshl_b32 s60, s59, 10
    s_or_b32 s62, s62, s60
L_append1:
    s_cmp_ge_u32 s3, 64
    s_cbranch_scc1 L_append2
    s_mov_b32 m0, s3
    s_ff1_i32_b64 s60, vcc
    s_bitset0_b64 vcc, s60
    v_readlane_b32 s61, v30, s60
    s_or_b32 s60, s60, s62
    s_add_u32 s3, s3, 1
    v_writelane_b32 v80, s60, m0
    v_writelane_b32 v81, s61, m0
    s_cmp_lg_u64 vcc, 0
    s_cbranch_scc1 L_append1
    s_setpc_b64 s[54:55]
L_append2:
    s_bitset1_b64 s[70:71], s59
    s_setpc_b64 s[54:55]
L_main:
    v_lshlrev_b32 v3, 4, v0
    v_lshrrev_b32 v2, 3, v0
    v_mul_u32_u24 v2, 384, v2
    v_and_b32 v30, 7, v0
    v_lshl_add_u32 v2, v30, 4, v2
    v_and_b32 v31, 1, v0
    v_lshlrev_b32 v31, 4, v31
    v_mov_b32 v32, 0xffff
    v_lshlrev_b32 v31, v31, v32
    v_lshrrev_b32 v30, 1, v30
    v_cmp_eq_u32 vcc, 0, v30
    s_nop 1
    v_cndmask_b32 v4, 0, v31, vcc
    v_cmp_eq_u32 vcc, 1, v30
    s_nop 1
    v_cndmask_b32 v5, 0, v31, vcc
    v_cmp_eq_u32 vcc, 2, v30
    s_nop 1
    v_cndmask_b32 v6, 0, v31, vcc
    v_cmp_eq_u32 vcc, 3, v30
    s_nop 1
    v_cndmask_b32 v7, 0, v31, vcc
    s_mov_b32 s56, 0
    s_mov_b64 s[68:69], 0
    s_mov_b64 s[70:71], 0
    s_mov_b32 s3, 0
    s_mov_b32 s72, 0x06040200
    s_mov_b32 s73, 0x07050301
    s_mov_b32 s74, 0x05010400
    s_mov_b32 s75, 0x07030602
    s_mov_b32 s101, 0x87878787
    v_mov_b32 v80, -1
    v_mov_b32 v81, 0
    s_mul_i32 s60, s46, 38400
    v_lshl_add_u32 v32, v0, 2, s60
    v_add_u32 v128, s45, v0
    v_and_b32 v128, 7, v128
    v_and_or_b32 v128, v0, 56, v128
    v_lshlrev_b32 v129, 3, v128
    v_lshlrev_b32 v128, 4, v128
    s_sub_u32 s63, s44, 24
    s_and_b32 s60, s2, 3
    s_lshl2_add_u32 s63, s63, s60
    s_lshr_b32 s60, s45, 2
    s_lshl1_add_u32 s63, s63, s60
    v_lshrrev_b32 v128, 2, v128
    buffer_load_dwordx2 v[116:117], v129, s[32:35], 0 offen
    buffer_load_dwordx2 v[118:119], v129, s[32:35], 0 offen offset:512
    buffer_load_dword v120, v128, s[32:35], 0 offen offset:1024
    s_lshl_b32 s60, s63, 6
    v_lshl_add_u32 v131, v0, 1, s60
    buffer_load_ushort v135, v131, s[32:35], 0 offen
    v_lshrrev_b32 v126, 3, v0
    v_mul_u32_u24 v126, 196608, v126
    v_and_b32 v127, 7, v0
    v_lshl_add_u32 v127, v127, 4, v126
    v_add_u32 v126, v126, v127
    s_lshl_b32 s61, s45, 2
    s_add_u32 s61, s61, s46
    s_mul_i32 s61, s61, 12288
    s_mul_i32 s62, s44, 384
    s_add_u32 s61, s61, s62
    s_add_u32 s62, s61, 3145728
    buffer_load_dwordx4 v[148:151], v126, s[16:19], s61 offen offset:0 nt
    buffer_load_dwordx4 v[152:155], v126, s[16:19], s61 offen offset:128 nt
    buffer_load_dwordx4 v[156:159], v126, s[16:19], s61 offen offset:256 nt
    buffer_load_dwordx4 v[160:163], v126, s[16:19], s62 offen offset:0 nt
    buffer_load_dwordx4 v[164:167], v126, s[16:19], s62 offen offset:128 nt
    buffer_load_dwordx4 v[168:171], v126, s[16:19], s62 offen offset:256 nt
    s_cmp_ge_u32 s46, 2
    s_cbranch_scc1 L_wq2_1
    s_mul_i32 s62, s45, 24576
    s_sub_u32 s61, s61, s62
    s_add_u32 s61, s61, 6291456
    buffer_load_dwordx4 a[240:243], v127, s[16:19], s61 offen offset:0 nt
    buffer_load_dwordx4 a[244:247], v127, s[16:19], s61 offen offset:128 nt
    buffer_load_dwordx4 a[248:251], v127, s[16:19], s61 offen offset:256 nt
L_wq2_1:
    v_mov_b32 v104, -1
    v_mov_b32 v105, -1
    v_mov_b32 v106, -1
    v_mov_b32 v107, -1
    s_lshl2_add_u32 s60, s45, s46
    s_mul_i32 s61, s60, 192
    s_lshl_b32 s60, s44, 14
    s_add_u32 s61, s61, s60
    s_add_u32 s61, s61, 4194304
    v_and_b32 v108, 32, v0
    v_lshlrev_b32 v108, 5, v108
    v_and_or_b32 v108, v0, 16, v108
    v_lshlrev_b32 v108, 5, v108
    v_and_or_b32 v108, v0, 15, v108
    v_lshlrev_b32 v108, 4, v108
    s_lshl2_add_u32 s60, s2, s46
    s_mul_i32 s60, s60, 2048
    s_mov_b32 exec_lo, 0x0fff0fff
    s_mov_b32 exec_hi, 0xfff
    buffer_store_dwordx4 v[104:107], v108, s[12:15], s61 offen sc1 nt
    s_mov_b64 exec, -1
    buffer_store_dwordx4 v[104:107], v3, s[12:15], s60 offen offset:0 sc1 nt
    buffer_store_dwordx4 v[104:107], v3, s[12:15], s60 offen offset:1024 sc1 nt
    s_waitcnt vmcnt(16)
    buffer_load_dwordx4 v[64:67], v1, s[4:7], s50 offen offset:0 nt
    buffer_load_dwordx4 v[68:71], v1, s[4:7], s50 offen offset:128 nt
    buffer_load_dwordx4 v[72:75], v1, s[4:7], s50 offen offset:256 nt
    s_add_u32 s50, s58, 147456
    s_cmp_ge_u32 s50, s53
    s_cselect_b32 s62, 2064384, 0
    s_sub_u32 s50, s50, s62
    v_and_b32 v76, 0x7fff7fff, v40
    v_and_b32 v77, 0x7fff7fff, v41
    v_and_b32 v78, 0x7fff7fff, v42
    v_and_b32 v79, 0x7fff7fff, v43
    v_and_b32 v36, 0x7fff7fff, v44
    v_and_b32 v37, 0x7fff7fff, v45
    v_and_b32 v38, 0x7fff7fff, v46
    v_and_b32 v39, 0x7fff7fff, v47
    v_and_b32 v24, 0x7fff7fff, v48
    v_and_b32 v25, 0x7fff7fff, v49
    v_and_b32 v26, 0x7fff7fff, v50
    v_and_b32 v27, 0x7fff7fff, v51
    v_pk_max_u16 v76, v76, v38
    v_pk_max_u16 v77, v77, v39
    v_pk_max_u16 v78, v78, v24
    v_pk_max_u16 v79, v79, v25
    v_pk_max_u16 v36, v36, v26
    v_pk_max_u16 v37, v37, v27
    v_pk_max_u16 v76, v76, v79
    v_pk_max_u16 v77, v77, v36
    v_pk_max_u16 v78, v78, v37
    v_pk_max_u16 v76, v76, v77
    v_pk_max_u16 v76, v76, v78
    v_lshlrev_b32 v77, 16, v76
    v_max_u32 v76, v76, v77
    s_nop 1
    v_max_u32_dpp v76, v76, v76 quad_perm:[1,0,3,2] row_mask:0xf bank_mask:0xf
    s_nop 1
    v_max_u32_dpp v76, v76, v76 quad_perm:[2,3,0,1] row_mask:0xf bank_mask:0xf
    s_nop 1
    v_max_u32_dpp v76, v76, v76 row_half_mirror row_mask:0xf bank_mask:0xf
    s_nop 1
    v_max_u32_dpp v76, v76, v76 row_mirror row_mask:0xf bank_mask:0xf
    s_nop 1
    v_max_u32_dpp v76, v76, v76 row_bcast:15 row_mask:0xa bank_mask:0xf
    s_nop 1
    v_max_u32_dpp v76, v76, v76 row_bcast:31 row_mask:0xc bank_mask:0xf
    s_nop 1
    v_readlane_b32 s99, v76, 63
    s_nop 1
    s_lshr_b32 s99, s99, 16
    s_max_u32 s99, s99, 1967
    s_sub_u32 s99, s99, 1967
    s_mul_i32 s99, s99, 0x10001
    s_mov_b32 s100, s99
    s_call_b64 s[66:67], L_pack0
    v_accvgpr_write_b32 a0, v76
    v_accvgpr_write_b32 a1, v77
    v_accvgpr_write_b32 a2, v79
    v_accvgpr_write_b32 a3, v36
    v_accvgpr_write_b32 a4, v37
    v_accvgpr_write_b32 a5, v39
    v_accvgpr_write_b32 a6, v24
    v_accvgpr_write_b32 a7, v25
    v_accvgpr_write_b32 a8, v27
    s_movk_i32 s59, 0
    s_cbranch_vccz L_clean_2
    s_call_b64 s[66:67], L_pexc0
L_clean_2:
    s_waitcnt vmcnt(16)
    buffer_load_dwordx4 v[40:43], v1, s[4:7], s50 offen offset:0 nt
    buffer_load_dwordx4 v[44:47], v1, s[4:7], s50 offen offset:128 nt
    buffer_load_dwordx4 v[48:51], v1, s[4:7], s50 offen offset:256 nt
    s_add_u32 s50, s48, 196608
    s_cmp_ge_u32 s50, s53
    s_cselect_b32 s62, 2064384, 0
    s_sub_u32 s50, s50, s62
    s_call_b64 s[66:67], L_pack1
    v_accvgpr_write_b32 a45, v76
    v_accvgpr_write_b32 a46, v77
    v_accvgpr_write_b32 a47, v79
    v_accvgpr_write_b32 a48, v36
    v_accvgpr_write_b32 a49, v37
    v_accvgpr_write_b32 a50, v39
    v_accvgpr_write_b32 a51, v24
    v_accvgpr_write_b32 a52, v25
    v_accvgpr_write_b32 a53, v27
    s_movk_i32 s59, 1
    s_cbranch_vccz L_clean_3
    s_call_b64 s[66:67], L_pexc1
L_clean_3:
    s_waitcnt vmcnt(3)
    buffer_load_dwordx4 v[52:55], v1, s[4:7], s50 offen offset:0 nt
    buffer_load_dwordx4 v[56:59], v1, s[4:7], s50 offen offset:128 nt
    buffer_load_dwordx4 v[60:63], v1, s[4:7], s50 offen offset:256 nt
    s_add_u32 s50, s58, 245760
    s_cmp_ge_u32 s50, s53
    s_cselect_b32 s62, 2064384, 0
    s_sub_u32 s50, s50, s62
    s_call_b64 s[66:67], L_pack2
    v_accvgpr_write_b32 a54, v76
    v_accvgpr_write_b32 a55, v77
    v_accvgpr_write_b32 a56, v79
    v_accvgpr_write_b32 a57, v36
    v_accvgpr_write_b32 a58, v37
    v_accvgpr_write_b32 a59, v39
    v_accvgpr_write_b32 a60, v24
    v_accvgpr_write_b32 a61, v25
    v_accvgpr_write_b32 a62, v27
    s_movk_i32 s59, 2
    s_cbranch_vccz L_clean_4
    s_call_b64 s[66:67], L_pexc2
L_clean_4:
    v_lshlrev_b32 v104, 16, v116
    v_and_b32 v105, 0xffff0000, v116
    v_lshlrev_b32 v106, 16, v117
    v_and_b32 v107, 0xffff0000, v117
    v_lshlrev_b32 v108, 16, v118
    v_and_b32 v109, 0xffff0000, v118
    v_lshlrev_b32 v110, 16, v119
    v_and_b32 v111, 0xffff0000, v119
    v_lshlrev_b32 v112, 16, v120
    v_and_b32 v113, 0xffff0000, v120
    s_bitcmp1_b32 s46, 0
    s_cselect_b64 vcc, -1, 0
    s_bitcmp1_b32 s46, 1
    s_cselect_b64 s[60:61], -1, 0
    v_cndmask_b32 v132, v104, v105, vcc
    v_cndmask_b32 v130, v106, v107, vcc
    v_cndmask_b32 v133, v108, v109, vcc
    v_cndmask_b32 v131, v110, v111, vcc
    v_cndmask_b32 v134, v112, v113, vcc
    v_cndmask_b32 v132, v132, v130, s[60:61]
    v_cndmask_b32 v133, v133, v131, s[60:61]
    s_nop 0
    v_mov_b32_dpp v134, v134 row_newbcast:0 row_mask:0xf bank_mask:0x3
    v_mov_b32_dpp v132, v132 row_newbcast:0 row_mask:0xf bank_mask:0x3
    v_mov_b32_dpp v133, v133 row_newbcast:0 row_mask:0xf bank_mask:0x3
    v_mov_b32_dpp v134, v134 row_newbcast:8 row_mask:0xf bank_mask:0xc
    v_mov_b32_dpp v132, v132 row_newbcast:8 row_mask:0xf bank_mask:0xc
    v_mov_b32_dpp v133, v133 row_newbcast:8 row_mask:0xf bank_mask:0xc
    v_lshlrev_b32 v135, 16, v135
    v_lshlrev_b32 v131, 2, v0
    v_add_u32 v131, 161024, v131
    s_mov_b32 exec_hi, 0
    ds_write_b32 v131, v135
    s_mov_b64 exec, -1
    s_mul_i32 s60, s46, 768
    s_add_u32 s60, s60, 153600
    v_lshrrev_b32 v135, 5, v0
    v_lshl_add_u32 v135, v135, 8, s60
    v_and_b32 v131, 7, v0
    v_lshl_add_u32 v135, v131, 5, v135
    v_and_b32 v131, 16, v0
    v_add_u32 v135, v135, v131
    v_readfirstlane_b32 s60, v104
    s_nop 1
    v_pk_add_f32 v[104:105], v[104:105], s[60:61] op_sel_hi:[1,0] neg_lo:[0,1] neg_hi:[0,1]
    v_pk_add_f32 v[106:107], v[106:107], s[60:61] op_sel_hi:[1,0] neg_lo:[0,1] neg_hi:[0,1]
    v_pk_add_f32 v[108:109], v[108:109], s[60:61] op_sel_hi:[1,0] neg_lo:[0,1] neg_hi:[0,1]
    v_pk_add_f32 v[110:111], v[110:111], s[60:61] op_sel_hi:[1,0] neg_lo:[0,1] neg_hi:[0,1]
    v_pk_add_f32 v[112:113], v[112:113], s[60:61] op_sel_hi:[1,0] neg_lo:[0,1] neg_hi:[0,1]
    v_pk_mul_f32 v[114:115], v[104:105], v[104:105]
    v_pk_fma_f32 v[114:115], v[106:107], v[106:107], v[114:115]
    v_pk_add_f32 v[104:105], v[104:105], v[106:107]
    v_pk_fma_f32 v[114:115], v[108:109], v[108:109], v[114:115]
    v_pk_add_f32 v[104:105], v[104:105], v[108:109]
    v_pk_fma_f32 v[114:115], v[110:111], v[110:111], v[114:115]
    v_pk_add_f32 v[104:105], v[104:105], v[110:111]
    v_pk_fma_f32 v[114:115], v[112:113], v[112:113], v[114:115]
    v_pk_add_f32 v[104:105], v[104:105], v[112:113]
    v_add_f32 v115, v114, v115
    v_add_f32 v114, v104, v105
    s_nop 0
    s_nop 0
    v_add_f32_dpp v114, v114, v114 quad_perm:[1,0,3,2] row_mask:0xf bank_mask:0xf
    v_add_f32_dpp v115, v115, v115 quad_perm:[1,0,3,2] row_mask:0xf bank_mask:0xf
    s_nop 0
    v_add_f32_dpp v114, v114, v114 quad_perm:[2,3,0,1] row_mask:0xf bank_mask:0xf
    v_add_f32_dpp v115, v115, v115 quad_perm:[2,3,0,1] row_mask:0xf bank_mask:0xf
    s_nop 0
    v_add_f32_dpp v114, v114, v114 row_half_mirror row_mask:0xf bank_mask:0xf
    v_add_f32_dpp v115, v115, v115 row_half_mirror row_mask:0xf bank_mask:0xf
    s_nop 0
    v_add_f32_dpp v114, v114, v114 row_mirror row_mask:0xf bank_mask:0xf
    v_add_f32_dpp v115, v115, v115 row_mirror row_mask:0xf bank_mask:0xf
    s_nop 0
    v_add_f32_dpp v114, v114, v114 row_bcast:15 row_mask:0xa bank_mask:0xf
    v_add_f32_dpp v115, v115, v115 row_bcast:15 row_mask:0xa bank_mask:0xf
    s_nop 0
    v_add_f32_dpp v114, v114, v114 row_bcast:31 row_mask:0xc bank_mask:0xf
    v_add_f32_dpp v115, v115, v115 row_bcast:31 row_mask:0xc bank_mask:0xf
    s_nop 0
    v_readlane_b32 s61, v114, 63
    v_readlane_b32 s62, v115, 63
    v_mov_b32 v128, 0x3acccccd
    s_nop 0
    v_mul_f32 v114, s61, v128
    v_mul_f32 v115, s62, v128
    v_fma_f32 v115, -v114, v114, v115
    v_max_f32 v115, 0, v115
    v_add_f32 v114, s60, v114
    v_cvt_pk_bf16_f32 v114, 0, v114
    v_cvt_pk_bf16_f32 v115, 0, v115
    v_add_f32 v115, 0x3727c5ac, v115
    v_cvt_pk_bf16_f32 v115, 0, v115
    v_sqrt_f32 v115, v115
    s_nop 0
    v_cvt_pk_bf16_f32 v115, 0, v115
    v_rcp_f32 v115, v115
    v_sub_f32 v132, v132, v114
    v_cvt_pk_bf16_f32 v132, 0, v132
    v_sub_f32 v133, v133, v114
    v_cvt_pk_bf16_f32 v133, 0, v133
    v_sub_f32 v134, v134, v114
    v_cvt_pk_bf16_f32 v134, 0, v134
    v_mul_f32 v132, v132, v115
    v_cvt_pk_bf16_f32 v132, v132, v132
    v_mul_f32 v133, v133, v115
    v_cvt_pk_bf16_f32 v133, v133, v133
    v_mul_f32 v134, v134, v115
    v_cvt_pk_bf16_f32 v134, v134, v134
    v_and_b32 v128, v4, v132
    v_and_b32 v129, v5, v132
    v_and_b32 v130, v6, v132
    v_and_b32 v131, v7, v132
    v_and_b32 v120, v4, v133
    v_and_b32 v121, v5, v133
    v_and_b32 v122, v6, v133
    v_and_b32 v123, v7, v133
    v_mfma_f32_16x16x32_bf16 v[104:107], v[128:131], v[148:151], 0
    v_mfma_f32_16x16x32_bf16 v[108:111], v[128:131], v[152:155], 0
    v_mfma_f32_16x16x32_bf16 v[112:115], v[128:131], v[156:159], 0
    v_and_b32 v124, v4, v134
    v_and_b32 v125, v5, v134
    v_and_b32 v126, v6, v134
    v_and_b32 v127, v7, v134
    v_mfma_f32_16x16x32_bf16 v[104:107], v[120:123], v[160:163], v[104:107]
    v_mfma_f32_16x16x32_bf16 v[108:111], v[120:123], v[164:167], v[108:111]
    v_mfma_f32_16x16x32_bf16 v[112:115], v[120:123], v[168:171], v[112:115]
    s_cmp_ge_u32 s46, 2
    s_cbranch_scc1 L_q2_5
    v_mfma_f32_16x16x32_bf16 v[104:107], v[124:127], a[240:243], v[104:107]
    v_mfma_f32_16x16x32_bf16 v[108:111], v[124:127], a[244:247], v[108:111]
    v_mfma_f32_16x16x32_bf16 v[112:115], v[124:127], a[248:251], v[112:115]
L_q2_5:
    s_nop 7
    v_permlane32_swap_b32 v104, v108
    v_permlane32_swap_b32 v105, v109
    v_permlane32_swap_b32 v106, v110
    v_permlane32_swap_b32 v107, v111
    v_permlane32_swap_b32 v112, v116
    v_permlane32_swap_b32 v113, v117
    v_permlane32_swap_b32 v114, v118
    v_permlane32_swap_b32 v115, v119
    v_add_f32_dpp v104, v108, v104 row_ror:8 row_mask:0xf bank_mask:0xf
    v_add_f32_dpp v105, v109, v105 row_ror:8 row_mask:0xf bank_mask:0xf
    v_add_f32_dpp v106, v110, v106 row_ror:8 row_mask:0xf bank_mask:0xf
    v_add_f32_dpp v107, v111, v107 row_ror:8 row_mask:0xf bank_mask:0xf
    v_add_f32_dpp v112, v116, v112 row_ror:8 row_mask:0xf bank_mask:0xf
    v_add_f32_dpp v113, v117, v113 row_ror:8 row_mask:0xf bank_mask:0xf
    v_add_f32_dpp v114, v118, v114 row_ror:8 row_mask:0xf bank_mask:0xf
    v_add_f32_dpp v115, v119, v115 row_ror:8 row_mask:0xf bank_mask:0xf
    s_mov_b32 exec_lo, 0x00ff00ff
    s_mov_b32 exec_hi, 0x00ff00ff
    ds_write_b128 v135, v[104:107]
    s_mov_b32 exec_hi, 0
    ds_write_b128 v135, v[112:115] offset:512
    s_mov_b64 exec, -1
    v_add_u32 v128, 153600, v3
    s_waitcnt lgkmcnt(0)
    s_barrier
    s_waitcnt vmcnt(3)
    buffer_load_dwordx4 v[64:67], v1, s[4:7], s50 offen offset:0 nt
    buffer_load_dwordx4 v[68:71], v1, s[4:7], s50 offen offset:128 nt
    buffer_load_dwordx4 v[72:75], v1, s[4:7], s50 offen offset:256 nt
    s_add_u32 s50, s48, 294912
    s_cmp_ge_u32 s50, s53
    s_cselect_b32 s62, 2064384, 0
    s_sub_u32 s50, s50, s62
    s_call_b64 s[66:67], L_pack0
    v_accvgpr_write_b32 a63, v76
    v_accvgpr_write_b32 a64, v77
    v_accvgpr_write_b32 a65, v79
    v_accvgpr_write_b32 a66, v36
    v_accvgpr_write_b32 a67, v37
    v_accvgpr_write_b32 a68, v39
    v_accvgpr_write_b32 a69, v24
    v_accvgpr_write_b32 a70, v25
    v_accvgpr_write_b32 a71, v27
    s_movk_i32 s59, 3
    s_cbranch_vccz L_clean_6
    s_call_b64 s[66:67], L_pexc0
L_clean_6:
    s_cmp_lg_u32 s46, 0
    s_cbranch_scc1 L_nopub_7
    ds_read_b128 v[104:107], v128 offset:0
    ds_read_b128 v[108:111], v128 offset:768
    ds_read_b128 v[112:115], v128 offset:1536
    ds_read_b128 v[116:119], v128 offset:2304
    s_mul_i32 s61, s45, 768
    s_lshl_b32 s62, s44, 14
    s_add_u32 s61, s61, s62
    s_add_u32 s61, s61, 4718592
    s_add_u32 s62, s61, 8192
    s_mov_b32 exec_hi, 0xffff
    s_waitcnt lgkmcnt(0)
    v_pk_add_f32 v[104:105], v[104:105], v[112:113]
    v_pk_add_f32 v[106:107], v[106:107], v[114:115]
    v_pk_add_f32 v[108:109], v[108:109], v[116:117]
    v_pk_add_f32 v[110:111], v[110:111], v[118:119]
    v_pk_add_f32 v[104:105], v[104:105], v[108:109]
    v_pk_add_f32 v[106:107], v[106:107], v[110:111]
    buffer_store_dwordx4 v[104:107], v3, s[12:15], s61 offen sc1
    s_mov_b64 exec, -1
    s_mov_b32 s60, 1
    s_lshl_b32 s61, s44, 3
    s_atomic_add s60, s[40:41], s61
L_nopub_7:
    s_waitcnt vmcnt(3)
    buffer_load_dwordx4 v[40:43], v1, s[4:7], s50 offen offset:0 nt
    buffer_load_dwordx4 v[44:47], v1, s[4:7], s50 offen offset:128 nt
    buffer_load_dwordx4 v[48:51], v1, s[4:7], s50 offen offset:256 nt
    s_add_u32 s50, s58, 344064
    s_cmp_ge_u32 s50, s53
    s_cselect_b32 s62, 2064384, 0
    s_sub_u32 s50, s50, s62
    s_call_b64 s[66:67], L_pack1
    v_accvgpr_write_b32 a72, v76
    v_accvgpr_write_b32 a73, v77
    v_accvgpr_write_b32 a74, v79
    v_accvgpr_write_b32 a75, v36
    v_accvgpr_write_b32 a76, v37
    v_accvgpr_write_b32 a77, v39
    v_accvgpr_write_b32 a78, v24
    v_accvgpr_write_b32 a79, v25
    v_accvgpr_write_b32 a80, v27
    s_movk_i32 s59, 4
    s_cbranch_vccz L_clean_8
    s_call_b64 s[66:67], L_pexc1
L_clean_8:
    s_waitcnt vmcnt(3)
    buffer_load_dwordx4 v[52:55], v1, s[4:7], s50 offen offset:0 nt
    buffer_load_dwordx4 v[56:59], v1, s[4:7], s50 offen offset:128 nt
    buffer_load_dwordx4 v[60:63], v1, s[4:7], s50 offen offset:256 nt
    s_add_u32 s50, s48, 393216
    s_cmp_ge_u32 s50, s53
    s_cselect_b32 s62, 2064384, 0
    s_sub_u32 s50, s50, s62
    s_call_b64 s[66:67], L_pack2
    v_accvgpr_write_b32 a81, v76
    v_accvgpr_write_b32 a82, v77
    v_accvgpr_write_b32 a83, v79
    v_accvgpr_write_b32 a84, v36
    v_accvgpr_write_b32 a85, v37
    v_accvgpr_write_b32 a86, v39
    v_accvgpr_write_b32 a87, v24
    v_accvgpr_write_b32 a88, v25
    v_accvgpr_write_b32 a89, v27
    s_movk_i32 s59, 5
    s_cbranch_vccz L_clean_9
    s_call_b64 s[66:67], L_pexc2
L_clean_9:
    s_waitcnt vmcnt(3)
    buffer_load_dwordx4 v[64:67], v1, s[4:7], s50 offen offset:0 nt
    buffer_load_dwordx4 v[68:71], v1, s[4:7], s50 offen offset:128 nt
    buffer_load_dwordx4 v[72:75], v1, s[4:7], s50 offen offset:256 nt
    s_add_u32 s50, s58, 442368
    s_cmp_ge_u32 s50, s53
    s_cselect_b32 s62, 2064384, 0
    s_sub_u32 s50, s50, s62
    s_cmp_lg_u32 s46, 3
    s_cbranch_scc1 L_noprobe_10
    s_bfe_u32 s32, s2, 0x20002
    s_mul_i32 s32, s32, 98304
    s_lshl_b32 s33, s2, 8
    s_and_b32 s33, s33, 0x1f00
    s_add_u32 s32, s32, s33
    s_add_u32 s32, s32, s47
    s_add_u32 s33, s32, 16384
    s_load_dword s64, s[4:5], s33
    s_load_dword s64, s[8:9], s33
    s_lshl_b32 s33, s2, 15
    s_add_u32 s33, s33, 12599296
    s_load_dword s64, s[12:13], s33
    s_mov_b32 s98, 1
L_noprobe_10:
    s_call_b64 s[66:67], L_pack0
    v_accvgpr_write_b32 a90, v76
    v_accvgpr_write_b32 a91, v77
    v_accvgpr_write_b32 a92, v79
    v_accvgpr_write_b32 a93, v36
    v_accvgpr_write_b32 a94, v37
    v_accvgpr_write_b32 a95, v39
    v_accvgpr_write_b32 a96, v24
    v_accvgpr_write_b32 a97, v25
    v_accvgpr_write_b32 a98, v27
    s_movk_i32 s59, 6
    s_cbranch_vccz L_clean_11
    s_call_b64 s[66:67], L_pexc0
L_clean_11:
    s_waitcnt vmcnt(3)
    buffer_load_dwordx4 v[40:43], v1, s[4:7], s50 offen offset:0 nt
    buffer_load_dwordx4 v[44:47], v1, s[4:7], s50 offen offset:128 nt
    buffer_load_dwordx4 v[48:51], v1, s[4:7], s50 offen offset:256 nt
    s_add_u32 s50, s48, 491520
    s_cmp_ge_u32 s50, s53
    s_cselect_b32 s62, 2064384, 0
    s_sub_u32 s50, s50, s62
    s_call_b64 s[66:67], L_pack1
    v_accvgpr_write_b32 a99, v76
    v_accvgpr_write_b32 a100, v77
    v_accvgpr_write_b32 a101, v79
    v_accvgpr_write_b32 a102, v36
    v_accvgpr_write_b32 a103, v37
    v_accvgpr_write_b32 a104, v39
    v_accvgpr_write_b32 a105, v24
    v_accvgpr_write_b32 a106, v25
    v_accvgpr_write_b32 a107, v27
    s_movk_i32 s59, 7
    s_cbranch_vccz L_clean_12
    s_call_b64 s[66:67], L_pexc1
L_clean_12:
    s_waitcnt vmcnt(3)
    buffer_load_dwordx4 v[52:55], v1, s[4:7], s50 offen offset:0 nt
    buffer_load_dwordx4 v[56:59], v1, s[4:7], s50 offen offset:128 nt
    buffer_load_dwordx4 v[60:63], v1, s[4:7], s50 offen offset:256 nt
    s_add_u32 s50, s58, 540672
    s_cmp_ge_u32 s50, s53
    s_cselect_b32 s62, 2064384, 0
    s_sub_u32 s50, s50, s62
    s_cmp_lg_u32 s46, 3
    s_cbranch_scc1 L_noprobe_13
    s_memtime s[34:35]
    s_waitcnt lgkmcnt(0)
    s_load_dword s64, s[4:5], s32
L_noprobe_13:
    s_call_b64 s[66:67], L_pack2
    v_accvgpr_write_b32 a108, v76
    v_accvgpr_write_b32 a109, v77
    v_accvgpr_write_b32 a110, v79
    v_accvgpr_write_b32 a111, v36
    v_accvgpr_write_b32 a112, v37
    v_accvgpr_write_b32 a113, v39
    v_accvgpr_write_b32 a114, v24
    v_accvgpr_write_b32 a115, v25
    v_accvgpr_write_b32 a116, v27
    s_movk_i32 s59, 8
    s_cbranch_vccz L_clean_14
    s_call_b64 s[66:67], L_pexc2
L_clean_14:
    s_cmp_lg_u32 s46, 3
    s_cbranch_scc1 L_noprobe_15
    s_waitcnt lgkmcnt(0)
    s_memtime s[54:55]
    s_add_u32 s32, s32, 24576
    s_waitcnt lgkmcnt(0)
    s_sub_u32 s33, s54, s34
L_noprobe_15:
    s_waitcnt vmcnt(3)
    buffer_load_dwordx4 v[64:67], v1, s[4:7], s50 offen offset:0 nt
    buffer_load_dwordx4 v[68:71], v1, s[4:7], s50 offen offset:128 nt
    buffer_load_dwordx4 v[72:75], v1, s[4:7], s50 offen offset:256 nt
    s_add_u32 s50, s48, 589824
    s_cmp_ge_u32 s50, s53
    s_cselect_b32 s62, 2064384, 0
    s_sub_u32 s50, s50, s62
    s_call_b64 s[66:67], L_pack0
    v_accvgpr_write_b32 a9, v76
    v_accvgpr_write_b32 a10, v77
    v_accvgpr_write_b32 a11, v79
    v_accvgpr_write_b32 a12, v36
    v_accvgpr_write_b32 a13, v37
    v_accvgpr_write_b32 a14, v39
    v_accvgpr_write_b32 a15, v24
    v_accvgpr_write_b32 a16, v25
    v_accvgpr_write_b32 a17, v27
    s_movk_i32 s59, 9
    s_cbranch_vccz L_clean_16
    s_call_b64 s[66:67], L_pexc0
L_clean_16:
    s_waitcnt vmcnt(3)
    buffer_load_dwordx4 v[40:43], v1, s[4:7], s50 offen offset:0 nt
    buffer_load_dwordx4 v[44:47], v1, s[4:7], s50 offen offset:128 nt
    buffer_load_dwordx4 v[48:51], v1, s[4:7], s50 offen offset:256 nt
    s_add_u32 s50, s58, 638976
    s_cmp_ge_u32 s50, s53
    s_cselect_b32 s62, 2064384, 0
    s_sub_u32 s50, s50, s62
    s_cmp_lg_u32 s46, 3
    s_cbranch_scc1 L_noprobe_17
    s_memtime s[34:35]
    s_waitcnt lgkmcnt(0)
    s_load_dword s64, s[4:5], s32
L_noprobe_17:
    s_call_b64 s[66:67], L_pack1
    v_accvgpr_write_b32 a27, v76
    v_accvgpr_write_b32 a28, v77
    v_accvgpr_write_b32 a29, v79
    v_accvgpr_write_b32 a30, v36
    v_accvgpr_write_b32 a31, v37
    v_accvgpr_write_b32 a32, v39
    v_accvgpr_write_b32 a33, v24
    v_accvgpr_write_b32 a34, v25
    v_accvgpr_write_b32 a35, v27
    s_movk_i32 s59, 10
    s_cbranch_vccz L_clean_18
    s_call_b64 s[66:67], L_pexc1
L_clean_18:
    s_cmp_lg_u32 s46, 3
    s_cbranch_scc1 L_noprobe_19
    s_waitcnt lgkmcnt(0)
    s_memtime s[54:55]
    s_sub_u32 s32, s32, 24576
    s_waitcnt lgkmcnt(0)
    s_sub_u32 s54, s54, s34
    s_lshr_b32 s34, s32, 21
    s_lshr_b32 s35, s2, 2
    s_cmp_gt_u32 s33, s54
    s_addc_u32 s34, s34, s35
    s_and_b32 s34, s34, 1
    s_lshl_b32 s34, s34, 8
    s_add_u32 s98, s98, s34
L_noprobe_19:
    s_waitcnt vmcnt(3)
    buffer_load_dwordx4 v[52:55], v1, s[4:7], s50 offen offset:0 nt
    buffer_load_dwordx4 v[56:59], v1, s[4:7], s50 offen offset:128 nt
    buffer_load_dwordx4 v[60:63], v1, s[4:7], s50 offen offset:256 nt
    s_add_u32 s50, s48, 688128
    s_cmp_ge_u32 s50, s53
    s_cselect_b32 s62, 2064384, 0
    s_sub_u32 s50, s50, s62
    s_call_b64 s[66:67], L_pack2
    v_accvgpr_write_b32 a117, v76
    v_accvgpr_write_b32 a118, v77
    v_accvgpr_write_b32 a119, v79
    v_accvgpr_write_b32 a120, v36
    v_accvgpr_write_b32 a121, v37
    v_accvgpr_write_b32 a122, v39
    v_accvgpr_write_b32 a123, v24
    v_accvgpr_write_b32 a124, v25
    v_accvgpr_write_b32 a125, v27
    s_movk_i32 s59, 11
    s_cbranch_vccz L_clean_20
    s_call_b64 s[66:67], L_pexc2
L_clean_20:
    s_waitcnt vmcnt(3)
    buffer_load_dwordx4 v[64:67], v1, s[4:7], s50 offen offset:0 nt
    buffer_load_dwordx4 v[68:71], v1, s[4:7], s50 offen offset:128 nt
    buffer_load_dwordx4 v[72:75], v1, s[4:7], s50 offen offset:256 nt
    s_add_u32 s50, s58, 737280
    s_cmp_ge_u32 s50, s53
    s_cselect_b32 s62, 2064384, 0
    s_sub_u32 s50, s50, s62
    s_cmp_lg_u32 s46, 3
    s_cbranch_scc1 L_noprobe_21
    s_memtime s[34:35]
    s_waitcnt lgkmcnt(0)
    s_load_dword s64, s[8:9], s32
L_noprobe_21:
    s_call_b64 s[66:67], L_pack0
    v_accvgpr_write_b32 a135, v76
    v_accvgpr_write_b32 a136, v77
    v_accvgpr_write_b32 a137, v79
    v_accvgpr_write_b32 a138, v36
    v_accvgpr_write_b32 a139, v37
    v_accvgpr_write_b32 a140, v39
    v_accvgpr_write_b32 a141, v24
    v_accvgpr_write_b32 a142, v25
    v_accvgpr_write_b32 a143, v27
    s_movk_i32 s59, 12
    s_cbranch_vccz L_clean_22
    s_call_b64 s[66:67], L_pexc0
L_clean_22:
    s_cmp_lg_u32 s46, 3
    s_cbranch_scc1 L_noprobe_23
    s_waitcnt lgkmcnt(0)
    s_memtime s[54:55]
    s_add_u32 s32, s32, 24576
    s_waitcnt lgkmcnt(0)
    s_sub_u32 s33, s54, s34
L_noprobe_23:
    s_waitcnt vmcnt(3)
    buffer_load_dwordx4 v[40:43], v1, s[4:7], s50 offen offset:0 nt
    buffer_load_dwordx4 v[44:47], v1, s[4:7], s50 offen offset:128 nt
    buffer_load_dwordx4 v[48:51], v1, s[4:7], s50 offen offset:256 nt
    s_add_u32 s50, s48, 786432
    s_cmp_ge_u32 s50, s53
    s_cselect_b32 s62, 2064384, 0
    s_sub_u32 s50, s50, s62
    s_call_b64 s[66:67], L_pack1
    v_accvgpr_write_b32 a153, v76
    v_accvgpr_write_b32 a154, v77
    v_accvgpr_write_b32 a155, v79
    v_accvgpr_write_b32 a156, v36
    v_accvgpr_write_b32 a157, v37
    v_accvgpr_write_b32 a158, v39
    v_accvgpr_write_b32 a159, v24
    v_accvgpr_write_b32 a160, v25
    v_accvgpr_write_b32 a161, v27
    s_movk_i32 s59, 13
    s_cbranch_vccz L_clean_24
    s_call_b64 s[66:67], L_pexc1
L_clean_24:
    s_waitcnt vmcnt(3)
    buffer_load_dwordx4 v[52:55], v1, s[4:7], s50 offen offset:0 nt
    buffer_load_dwordx4 v[56:59], v1, s[4:7], s50 offen offset:128 nt
    buffer_load_dwordx4 v[60:63], v1, s[4:7], s50 offen offset:256 nt
    s_add_u32 s50, s58, 835584
    s_cmp_ge_u32 s50, s53
    s_cselect_b32 s62, 2064384, 0
    s_sub_u32 s50, s50, s62
    s_cmp_lg_u32 s46, 3
    s_cbranch_scc1 L_noprobe_25
    s_memtime s[34:35]
    s_waitcnt lgkmcnt(0)
    s_load_dword s64, s[8:9], s32
L_noprobe_25:
    s_call_b64 s[66:67], L_pack2
    v_accvgpr_write_b32 a171, v76
    v_accvgpr_write_b32 a172, v77
    v_accvgpr_write_b32 a173, v79
    v_accvgpr_write_b32 a174, v36
    v_accvgpr_write_b32 a175, v37
    v_accvgpr_write_b32 a176, v39
    v_accvgpr_write_b32 a177, v24
    v_accvgpr_write_b32 a178, v25
    v_accvgpr_write_b32 a179, v27
    s_movk_i32 s59, 14
    s_cbranch_vccz L_clean_26
    s_call_b64 s[66:67], L_pexc2
L_clean_26:
    s_cmp_lg_u32 s46, 3
    s_cbranch_scc1 L_noprobe_27
    s_waitcnt lgkmcnt(0)
    s_memtime s[54:55]
    s_sub_u32 s32, s32, 24576
    s_waitcnt lgkmcnt(0)
    s_sub_u32 s54, s54, s34
    s_lshr_b32 s34, s32, 21
    s_lshr_b32 s35, s2, 2
    s_cmp_gt_u32 s33, s54
    s_addc_u32 s34, s34, s35
    s_and_b32 s34, s34, 1
    s_lshl_b32 s34, s34, 16
    s_add_u32 s98, s98, s34
    s_and_b32 s32, s32, 0x1f00
    s_lshl_b32 s33, s2, 15
    s_add_u32 s32, s32, s33
    s_add_u32 s32, s32, 12582912
L_noprobe_27:
    v_and_b32 v129, 31, v0
    v_lshlrev_b32 v129, 3, v129
    buffer_load_dword v128, v129, s[40:43], 0 offen sc1
    s_waitcnt vmcnt(4)
    buffer_load_dwordx4 v[64:67], v1, s[4:7], s50 offen offset:0 nt
    buffer_load_dwordx4 v[68:71], v1, s[4:7], s50 offen offset:128 nt
    buffer_load_dwordx4 v[72:75], v1, s[4:7], s50 offen offset:256 nt
    s_add_u32 s50, s48, 884736
    s_cmp_ge_u32 s50, s53
    s_cselect_b32 s62, 2064384, 0
    s_sub_u32 s50, s50, s62
    s_call_b64 s[66:67], L_pack0
    v_accvgpr_write_b32 a189, v76
    v_accvgpr_write_b32 a190, v77
    v_accvgpr_write_b32 a191, v79
    v_accvgpr_write_b32 a192, v36
    v_accvgpr_write_b32 a193, v37
    v_accvgpr_write_b32 a194, v39
    v_accvgpr_write_b32 a195, v24
    v_accvgpr_write_b32 a196, v25
    v_accvgpr_write_b32 a197, v27
    s_movk_i32 s59, 15
    s_cbranch_vccz L_clean_28
    s_call_b64 s[66:67], L_pexc0
L_clean_28:
    s_waitcnt vmcnt(4)
    buffer_load_dwordx4 v[40:43], v1, s[4:7], s50 offen offset:0 nt
    buffer_load_dwordx4 v[44:47], v1, s[4:7], s50 offen offset:128 nt
    buffer_load_dwordx4 v[48:51], v1, s[4:7], s50 offen offset:256 nt
    s_add_u32 s50, s58, 933888
    s_cmp_ge_u32 s50, s53
    s_cselect_b32 s62, 2064384, 0
    s_sub_u32 s50, s50, s62
    s_cmp_lg_u32 s46, 3
    s_cbranch_scc1 L_noprobe_29
    s_memtime s[34:35]
    s_waitcnt lgkmcnt(0)
    s_load_dword s64, s[12:13], s32
L_noprobe_29:
    s_call_b64 s[66:67], L_pack1
    v_accvgpr_write_b32 a207, v76
    v_accvgpr_write_b32 a208, v77
    v_accvgpr_write_b32 a209, v79
    v_accvgpr_write_b32 a210, v36
    v_accvgpr_write_b32 a211, v37
    v_accvgpr_write_b32 a212, v39
    v_accvgpr_write_b32 a213, v24
    v_accvgpr_write_b32 a214, v25
    v_accvgpr_write_b32 a215, v27
    s_movk_i32 s59, 16
    s_cbranch_vccz L_clean_30
    s_call_b64 s[66:67], L_pexc1
L_clean_30:
    s_cmp_lg_u32 s46, 3
    s_cbranch_scc1 L_noprobe_31
    s_waitcnt lgkmcnt(0)
    s_memtime s[54:55]
    s_add_u32 s32, s32, 24576
    s_waitcnt lgkmcnt(0)
    s_sub_u32 s33, s54, s34
L_noprobe_31:
    s_waitcnt vmcnt(3)
    buffer_load_dwordx4 v[52:55], v1, s[4:7], s50 offen offset:0 nt
    buffer_load_dwordx4 v[56:59], v1, s[4:7], s50 offen offset:128 nt
    buffer_load_dwordx4 v[60:63], v1, s[4:7], s50 offen offset:256 nt
    s_add_u32 s50, s48, 983040
    s_cmp_ge_u32 s50, s53
    s_cselect_b32 s62, 2064384, 0
    s_sub_u32 s50, s50, s62
    s_call_b64 s[66:67], L_pack2
    v_accvgpr_write_b32 a225, v76
    v_accvgpr_write_b32 a226, v77
    v_accvgpr_write_b32 a227, v79
    v_accvgpr_write_b32 a228, v36
    v_accvgpr_write_b32 a229, v37
    v_accvgpr_write_b32 a230, v39
    v_accvgpr_write_b32 a231, v24
    v_accvgpr_write_b32 a232, v25
    v_accvgpr_write_b32 a233, v27
    s_movk_i32 s59, 17
    s_cbranch_vccz L_clean_32
    s_call_b64 s[66:67], L_pexc2
L_clean_32:
    s_mov_b32 s59, 400000
    s_branch L_barc_34
L_bar_33:
    buffer_load_dword v128, v129, s[40:43], 0 offen sc1
    s_waitcnt vmcnt(0)
L_barc_34:
    v_cmp_gt_u32 vcc, 8, v128
    s_cbranch_vccz L_bard_35
    s_sub_u32 s59, s59, 1
    s_cbranch_scc0 L_bar_33
L_bard_35:
    s_lshl_b32 s63, s57, 14
    s_add_u32 s63, s63, 4718592
    s_add_u32 s1, s63, 3072
    s_mov_b32 exec_hi, 0xffff
    buffer_load_dwordx4 v[104:107], v3, s[12:15], s63 offen offset:0 sc1
    buffer_load_dwordx4 v[108:111], v3, s[12:15], s63 offen offset:768 sc1
    buffer_load_dwordx4 v[112:115], v3, s[12:15], s63 offen offset:1536 sc1
    buffer_load_dwordx4 v[116:119], v3, s[12:15], s63 offen offset:2304 sc1
    buffer_load_dwordx4 v[120:123], v3, s[12:15], s1 offen offset:0 sc1
    buffer_load_dwordx4 v[124:127], v3, s[12:15], s1 offen offset:768 sc1
    buffer_load_dwordx4 v[128:131], v3, s[12:15], s1 offen offset:1536 sc1
    buffer_load_dwordx4 v[132:135], v3, s[12:15], s1 offen offset:2304 sc1
    s_mov_b64 exec, -1
    s_waitcnt vmcnt(11)
    buffer_load_dwordx4 v[64:67], v1, s[4:7], s50 offen offset:0 nt
    buffer_load_dwordx4 v[68:71], v1, s[4:7], s50 offen offset:128 nt
    buffer_load_dwordx4 v[72:75], v1, s[4:7], s50 offen offset:256 nt
    s_add_u32 s50, s58, 1032192
    s_cmp_ge_u32 s50, s53
    s_cselect_b32 s62, 2064384, 0
    s_sub_u32 s50, s50, s62
    s_cmp_lg_u32 s46, 3
    s_cbranch_scc1 L_noprobe_36
    s_memtime s[34:35]
    s_waitcnt lgkmcnt(0)
    s_load_dword s64, s[12:13], s32
L_noprobe_36:
    s_call_b64 s[66:67], L_pack0
    ds_write2st64_b32 v32, v76, v77 offset0:0 offset1:1
    ds_write_b32 v32, v79 offset:512
    ds_write2st64_b32 v32, v36, v37 offset0:3 offset1:4
    ds_write_b32 v32, v39 offset:1280
    ds_write2st64_b32 v32, v24, v25 offset0:6 offset1:7
    ds_write_b32 v32, v27 offset:2048
    s_movk_i32 s59, 18
    s_cbranch_vccz L_clean_37
    s_call_b64 s[66:67], L_pexc0
L_clean_37:
    s_cmp_lg_u32 s46, 3
    s_cbranch_scc1 L_noprobe_38
    s_waitcnt lgkmcnt(0)
    s_memtime s[54:55]
    s_sub_u32 s32, s32, 24576
    s_waitcnt lgkmcnt(0)
    s_sub_u32 s54, s54, s34
    s_lshr_b32 s34, s32, 21
    s_lshr_b32 s35, s2, 2
    s_cmp_gt_u32 s33, s54
    s_addc_u32 s34, s34, s35
    s_and_b32 s34, s34, 1
    s_lshl_b32 s34, s34, 24
    s_add_u32 s98, s98, s34
L_noprobe_38:
    s_waitcnt vmcnt(11)
    buffer_load_dwordx4 v[40:43], v1, s[4:7], s50 offen offset:0 nt
    buffer_load_dwordx4 v[44:47], v1, s[4:7], s50 offen offset:128 nt
    buffer_load_dwordx4 v[48:51], v1, s[4:7], s50 offen offset:256 nt
    s_add_u32 s50, s48, 1081344
    s_cmp_ge_u32 s50, s53
    s_cselect_b32 s62, 2064384, 0
    s_sub_u32 s50, s50, s62
    s_call_b64 s[66:67], L_pack1
    ds_write2st64_b32 v32, v76, v77 offset0:18 offset1:19
    ds_write_b32 v32, v79 offset:5120
    ds_write2st64_b32 v32, v36, v37 offset0:21 offset1:22
    ds_write_b32 v32, v39 offset:5888
    ds_write2st64_b32 v32, v24, v25 offset0:24 offset1:25
    ds_write_b32 v32, v27 offset:6656
    s_movk_i32 s59, 19
    s_cbranch_vccz L_clean_39
    s_call_b64 s[66:67], L_pexc1
L_clean_39:
    s_waitcnt vmcnt(3)
    buffer_load_dwordx4 v[52:55], v1, s[4:7], s50 offen offset:0 nt
    buffer_load_dwordx4 v[56:59], v1, s[4:7], s50 offen offset:128 nt
    buffer_load_dwordx4 v[60:63], v1, s[4:7], s50 offen offset:256 nt
    s_add_u32 s50, s58, 1130496
    s_cmp_ge_u32 s50, s53
    s_cselect_b32 s62, 2064384, 0
    s_sub_u32 s50, s50, s62
    s_call_b64 s[66:67], L_pack2
    ds_write2st64_b32 v32, v76, v77 offset0:36 offset1:37
    ds_write_b32 v32, v79 offset:9728
    ds_write2st64_b32 v32, v36, v37 offset0:39 offset1:40
    ds_write_b32 v32, v39 offset:10496
    ds_write2st64_b32 v32, v24, v25 offset0:42 offset1:43
    ds_write_b32 v32, v27 offset:11264
    s_movk_i32 s59, 20
    s_cbranch_vccz L_clean_40
    s_call_b64 s[66:67], L_pexc2
L_clean_40:
    s_mov_b32 exec_hi, 0xffff
    s_mov_b32 s59, 400000
    s_branch L_chk_42
L_poll_41:
    buffer_load_dwordx4 v[104:107], v3, s[12:15], s63 offen offset:0 sc1
    buffer_load_dwordx4 v[108:111], v3, s[12:15], s63 offen offset:768 sc1
    buffer_load_dwordx4 v[112:115], v3, s[12:15], s63 offen offset:1536 sc1
    buffer_load_dwordx4 v[116:119], v3, s[12:15], s63 offen offset:2304 sc1
    buffer_load_dwordx4 v[120:123], v3, s[12:15], s1 offen offset:0 sc1
    buffer_load_dwordx4 v[124:127], v3, s[12:15], s1 offen offset:768 sc1
    buffer_load_dwordx4 v[128:131], v3, s[12:15], s1 offen offset:1536 sc1
    buffer_load_dwordx4 v[132:135], v3, s[12:15], s1 offen offset:2304 sc1
    s_waitcnt vmcnt(0)
L_chk_42:
    v_max_u32 v148, v104, v105
    v_max3_u32 v148, v148, v106, v107
    v_max3_u32 v148, v148, v108, v109
    v_max3_u32 v148, v148, v110, v111
    v_max3_u32 v148, v148, v112, v113
    v_max3_u32 v148, v148, v114, v115
    v_max3_u32 v148, v148, v116, v117
    v_max3_u32 v148, v148, v118, v119
    v_max3_u32 v148, v148, v120, v121
    v_max3_u32 v148, v148, v122, v123
    v_max3_u32 v148, v148, v124, v125
    v_max3_u32 v148, v148, v126, v127
    v_max3_u32 v148, v148, v128, v129
    v_max3_u32 v148, v148, v130, v131
    v_max3_u32 v148, v148, v132, v133
    v_max3_u32 v148, v148, v134, v135
    v_cmp_eq_u32 vcc, -1, v148
    s_cbranch_vccz L_got_43
    s_sub_u32 s59, s59, 1
    s_cbranch_scc0 L_poll_41
L_got_43:
    v_pk_add_f32 v[104:105], v[104:105], v[120:121]
    v_pk_add_f32 v[106:107], v[106:107], v[122:123]
    v_pk_add_f32 v[108:109], v[108:109], v[124:125]
    v_pk_add_f32 v[110:111], v[110:111], v[126:127]
    v_pk_add_f32 v[112:113], v[112:113], v[128:129]
    v_pk_add_f32 v[114:115], v[114:115], v[130:131]
    v_pk_add_f32 v[116:117], v[116:117], v[132:133]
    v_pk_add_f32 v[118:119], v[118:119], v[134:135]
    s_and_b32 s60, s46, 1
    s_mul_i32 s60, s60, 384
    s_add_u32 s60, s60, 159872
    v_lshl_add_u32 v120, v0, 3, s60
    v_pk_add_f32 v[104:105], v[104:105], v[112:113]
    v_pk_add_f32 v[106:107], v[106:107], v[114:115]
    v_pk_add_f32 v[108:109], v[108:109], v[116:117]
    v_pk_add_f32 v[110:111], v[110:111], v[118:119]
    v_pk_add_f32 v[104:105], v[104:105], v[108:109]
    v_pk_add_f32 v[106:107], v[106:107], v[110:111]
    v_cvt_pk_bf16_f32 v104, v104, v105
    v_cvt_pk_bf16_f32 v105, v106, v107
    ds_write_b64 v120, v[104:105]
    s_mov_b64 exec, -1
    s_waitcnt vmcnt(3)
    buffer_load_dwordx4 v[64:67], v1, s[4:7], s50 offen offset:0 nt
    buffer_load_dwordx4 v[68:71], v1, s[4:7], s50 offen offset:128 nt
    buffer_load_dwordx4 v[72:75], v1, s[4:7], s50 offen offset:256 nt
    s_add_u32 s50, s48, 1179648
    s_cmp_ge_u32 s50, s53
    s_cselect_b32 s62, 2064384, 0
    s_sub_u32 s50, s50, s62
    s_call_b64 s[66:67], L_pack0
    ds_write2st64_b32 v32, v76, v77 offset0:54 offset1:55
    ds_write_b32 v32, v79 offset:14336
    ds_write2st64_b32 v32, v36, v37 offset0:57 offset1:58
    ds_write_b32 v32, v39 offset:15104
    ds_write2st64_b32 v32, v24, v25 offset0:60 offset1:61
    ds_write_b32 v32, v27 offset:15872
    s_movk_i32 s59, 21
    s_cbranch_vccz L_clean_44
    s_call_b64 s[66:67], L_pexc0
L_clean_44:
    s_waitcnt lgkmcnt(0)
    s_barrier
    v_and_b32 v30, 1, v0
    v_lshlrev_b32 v30, 6, v30
    v_and_b32 v31, 48, v0
    v_add_u32 v30, v30, v31
    v_add_u32 v30, 159872, v30
    ds_read_b128 a[240:243], v30 offset:384
    ds_read_b128 a[244:247], v30 offset:512
    ds_read_b128 a[248:251], v30 offset:640
    ds_read_b128 a[20:23], v30 offset:0
    ds_read_b128 a[36:39], v30 offset:128
    ds_read_b128 a[40:43], v30 offset:256
    s_mul_i32 s60, s46, 1536
    s_add_u32 s60, s60, 153600
    v_lshrrev_b32 v33, 3, v0
    v_lshl_add_u32 v33, v33, 1, s60
    s_mul_i32 s60, s46, 38400
    s_add_u32 s60, s60, 2304
    v_lshrrev_b32 v8, 3, v0
    v_lshl_add_u32 v8, v8, 1, s60
    v_mov_b32 v35, 0xff800000
    v_mov_b32 v9, 0xff800000
    v_mov_b32 v34, 0
    s_waitcnt vmcnt(3)
    buffer_load_dwordx4 v[40:43], v1, s[4:7], s50 offen offset:0 nt
    buffer_load_dwordx4 v[44:47], v1, s[4:7], s50 offen offset:128 nt
    buffer_load_dwordx4 v[48:51], v1, s[4:7], s50 offen offset:256 nt
    s_add_u32 s50, s58, 1228800
    s_cmp_ge_u32 s50, s53
    s_cselect_b32 s62, 2064384, 0
    s_sub_u32 s50, s50, s62
    s_waitcnt lgkmcnt(0)
    v_mfma_f32_16x16x32_bf16 v[20:23], v[52:55], a[240:243], 0
    v_mfma_f32_16x16x32_bf16 v[20:23], v[56:59], a[244:247], v[20:23]
    v_mfma_f32_16x16x32_bf16 v[20:23], v[60:63], a[248:251], v[20:23]
    s_call_b64 s[66:67], L_kst
    ds_write_b16 v8, v31 offset:352
    v_and_b32 v30, 0xffff0000, v31
    v_max_f32 v9, v9, v30
    s_call_b64 s[66:67], L_pack1
    ds_write2st64_b32 v32, v76, v77 offset0:72 offset1:73
    ds_write_b32 v32, v79 offset:18944
    ds_write2st64_b32 v32, v36, v37 offset0:75 offset1:76
    ds_write_b32 v32, v39 offset:19712
    ds_write2st64_b32 v32, v24, v25 offset0:78 offset1:79
    ds_write_b32 v32, v27 offset:20480
    s_movk_i32 s59, 22
    s_cbranch_vccz L_clean_45
    s_call_b64 s[66:67], L_pexc1
L_clean_45:
    s_waitcnt vmcnt(3)
    buffer_load_dwordx4 v[52:55], v1, s[4:7], s50 offen offset:0 nt
    buffer_load_dwordx4 v[56:59], v1, s[4:7], s50 offen offset:128 nt
    buffer_load_dwordx4 v[60:63], v1, s[4:7], s50 offen offset:256 nt
    s_add_u32 s50, s48, 1277952
    s_cmp_ge_u32 s50, s53
    s_cselect_b32 s62, 2064384, 0
    s_sub_u32 s50, s50, s62
    s_cmp_lg_u32 s46, 3
    s_cbranch_scc1 L_noprobe_46
    s_and_b32 s32, s2, 3
    s_lshl_b32 s32, s32, 6
    s_add_u32 s32, s32, 4
    s_atomic_add s98, s[40:41], s32
L_noprobe_46:
    v_mfma_f32_16x16x32_bf16 v[20:23], v[64:67], a[240:243], 0
    v_mfma_f32_16x16x32_bf16 v[20:23], v[68:71], a[244:247], v[20:23]
    v_mfma_f32_16x16x32_bf16 v[20:23], v[72:75], a[248:251], v[20:23]
    s_call_b64 s[66:67], L_kst
    ds_write_b16 v8, v31 offset:368
    v_and_b32 v30, 0xffff0000, v31
    v_max_f32 v9, v9, v30
    s_call_b64 s[66:67], L_pack2
    ds_write2st64_b32 v32, v76, v77 offset0:90 offset1:91
    ds_write_b32 v32, v79 offset:23552
    ds_write2st64_b32 v32, v36, v37 offset0:93 offset1:94
    ds_write_b32 v32, v39 offset:24320
    ds_write2st64_b32 v32, v24, v25 offset0:96 offset1:97
    ds_write_b32 v32, v27 offset:25088
    s_movk_i32 s59, 23
    s_cbranch_vccz L_clean_47
    s_call_b64 s[66:67], L_pexc2
L_clean_47:
    s_waitcnt vmcnt(3)
    buffer_load_dwordx4 v[64:67], v1, s[4:7], s50 offen offset:0 nt
    buffer_load_dwordx4 v[68:71], v1, s[4:7], s50 offen offset:128 nt
    buffer_load_dwordx4 v[72:75], v1, s[4:7], s50 offen offset:256 nt
    s_add_u32 s50, s58, 1327104
    s_cmp_ge_u32 s50, s53
    s_cselect_b32 s62, 2064384, 0
    s_sub_u32 s50, s50, s62
    v_mfma_f32_16x16x32_bf16 v[20:23], v[40:43], a[240:243], 0
    v_mfma_f32_16x16x32_bf16 v[20:23], v[44:47], a[244:247], v[20:23]
    v_mfma_f32_16x16x32_bf16 v[20:23], v[48:51], a[248:251], v[20:23]
    s_call_b64 s[66:67], L_kst
    ds_write_b16 v8, v31 offset:384
    v_and_b32 v30, 0xffff0000, v31
    v_max_f32 v9, v9, v30
    s_call_b64 s[66:67], L_pack0
    ds_write2st64_b32 v32, v76, v77 offset0:108 offset1:109
    ds_write_b32 v32, v79 offset:28160
    ds_write2st64_b32 v32, v36, v37 offset0:111 offset1:112
    ds_write_b32 v32, v39 offset:28928
    ds_write2st64_b32 v32, v24, v25 offset0:114 offset1:115
    ds_write_b32 v32, v27 offset:29696
    s_movk_i32 s59, 24
    s_cbranch_vccz L_clean_48
    s_call_b64 s[66:67], L_pexc0
L_clean_48:
    s_waitcnt vmcnt(3)
    buffer_load_dwordx4 v[40:43], v1, s[4:7], s50 offen offset:0 nt
    buffer_load_dwordx4 v[44:47], v1, s[4:7], s50 offen offset:128 nt
    buffer_load_dwordx4 v[48:51], v1, s[4:7], s50 offen offset:256 nt
    s_add_u32 s50, s48, 1376256
    s_cmp_ge_u32 s50, s53
    s_cselect_b32 s62, 2064384, 0
    s_sub_u32 s50, s50, s62
    v_mfma_f32_16x16x32_bf16 v[20:23], v[52:55], a[240:243], 0
    v_mfma_f32_16x16x32_bf16 v[20:23], v[56:59], a[244:247], v[20:23]
    v_mfma_f32_16x16x32_bf16 v[20:23], v[60:63], a[248:251], v[20:23]
    s_call_b64 s[66:67], L_kst
    ds_write_b16 v8, v31 offset:400
    v_and_b32 v30, 0xffff0000, v31
    v_max_f32 v9, v9, v30
    s_call_b64 s[66:67], L_pack1
    ds_write2st64_b32 v32, v76, v77 offset0:126 offset1:127
    ds_write_b32 v32, v79 offset:32768
    ds_write2st64_b32 v32, v36, v37 offset0:129 offset1:130
    ds_write_b32 v32, v39 offset:33536
    ds_write2st64_b32 v32, v24, v25 offset0:132 offset1:133
    ds_write_b32 v32, v27 offset:34304
    s_movk_i32 s59, 25
    s_cbranch_vccz L_clean_49
    s_call_b64 s[66:67], L_pexc1
L_clean_49:
    s_waitcnt vmcnt(3)
    buffer_load_dwordx4 v[52:55], v1, s[4:7], s50 offen offset:0 nt
    buffer_load_dwordx4 v[56:59], v1, s[4:7], s50 offen offset:128 nt
    buffer_load_dwordx4 v[60:63], v1, s[4:7], s50 offen offset:256 nt
    s_add_u32 s50, s58, 1425408
    s_cmp_ge_u32 s50, s53
    s_cselect_b32 s62, 2064384, 0
    s_sub_u32 s50, s50, s62
    v_mfma_f32_16x16x32_bf16 v[20:23], v[64:67], a[240:243], 0
    v_mfma_f32_16x16x32_bf16 v[20:23], v[68:71], a[244:247], v[20:23]
    v_mfma_f32_16x16x32_bf16 v[20:23], v[72:75], a[248:251], v[20:23]
    s_call_b64 s[66:67], L_kst
    ds_write_b16 v8, v31 offset:416
    v_and_b32 v30, 0xffff0000, v31
    v_max_f32 v9, v9, v30
    s_call_b64 s[66:67], L_pack2
    ds_write2st64_b32 v32, v76, v77 offset0:144 offset1:145
    ds_write_b32 v32, v79 offset:37376
    ds_write2st64_b32 v32, v36, v37 offset0:147 offset1:148
    ds_write_b32 v32, v39 offset:38144
    v_mov_b32 v82, v24
    v_mov_b32 v83, v25
    v_mov_b32 v84, v27
    s_movk_i32 s59, 26
    s_cbranch_vccz L_clean_50
    s_call_b64 s[66:67], L_pexc2
L_clean_50:
    s_waitcnt vmcnt(3)
    buffer_load_dwordx4 v[64:67], v1, s[4:7], s50 offen offset:0 nt
    buffer_load_dwordx4 v[68:71], v1, s[4:7], s50 offen offset:128 nt
    buffer_load_dwordx4 v[72:75], v1, s[4:7], s50 offen offset:256 nt
    s_add_u32 s50, s48, 1474560
    s_cmp_ge_u32 s50, s53
    s_cselect_b32 s62, 2064384, 0
    s_sub_u32 s50, s50, s62
    v_mfma_f32_16x16x32_bf16 v[20:23], v[40:43], a[240:243], 0
    v_mfma_f32_16x16x32_bf16 v[20:23], v[44:47], a[244:247], v[20:23]
    v_mfma_f32_16x16x32_bf16 v[20:23], v[48:51], a[248:251], v[20:23]
    s_call_b64 s[66:67], L_kst
    ds_write_b16 v8, v31 offset:432
    v_and_b32 v30, 0xffff0000, v31
    v_max_f32 v9, v9, v30
    s_call_b64 s[66:67], L_pack0
    v_mov_b32 v94, v76
    v_mov_b32 v95, v77
    v_mov_b32 v96, v79
    v_mov_b32 v97, v36
    v_mov_b32 v98, v37
    v_mov_b32 v99, v39
    v_mov_b32 v100, v24
    v_mov_b32 v101, v25
    v_mov_b32 v102, v27
    s_movk_i32 s59, 27
    s_cbranch_vccz L_clean_51
    s_call_b64 s[66:67], L_pexc0
L_clean_51:
    s_waitcnt vmcnt(3)
    buffer_load_dwordx4 v[40:43], v1, s[4:7], s50 offen offset:0 nt
    buffer_load_dwordx4 v[44:47], v1, s[4:7], s50 offen offset:128 nt
    buffer_load_dwordx4 v[48:51], v1, s[4:7], s50 offen offset:256 nt
    s_add_u32 s50, s58, 1523712
    s_cmp_ge_u32 s50, s53
    s_cselect_b32 s62, 2064384, 0
    s_sub_u32 s50, s50, s62
    v_mfma_f32_16x16x32_bf16 v[20:23], v[52:55], a[240:243], 0
    v_mfma_f32_16x16x32_bf16 v[20:23], v[56:59], a[244:247], v[20:23]
    v_mfma_f32_16x16x32_bf16 v[20:23], v[60:63], a[248:251], v[20:23]
    s_call_b64 s[66:67], L_kst
    ds_write_b16 v8, v31 offset:448
    v_and_b32 v30, 0xffff0000, v31
    v_max_f32 v9, v9, v30
    s_call_b64 s[66:67], L_pack1
    v_mov_b32 v112, v76
    v_mov_b32 v113, v77
    v_mov_b32 v114, v79
    v_mov_b32 v115, v36
    v_mov_b32 v116, v37
    v_mov_b32 v117, v39
    v_mov_b32 v118, v24
    v_mov_b32 v119, v25
    v_mov_b32 v120, v27
    s_movk_i32 s59, 28
    s_cbranch_vccz L_clean_52
    s_call_b64 s[66:67], L_pexc1
L_clean_52:
    s_waitcnt vmcnt(3)
    buffer_load_dwordx4 v[52:55], v1, s[4:7], s50 offen offset:0 nt
    buffer_load_dwordx4 v[56:59], v1, s[4:7], s50 offen offset:128 nt
    buffer_load_dwordx4 v[60:63], v1, s[4:7], s50 offen offset:256 nt
    s_add_u32 s50, s48, 1572864
    s_cmp_ge_u32 s50, s53
    s_cselect_b32 s62, 2064384, 0
    s_sub_u32 s50, s50, s62
    v_mfma_f32_16x16x32_bf16 v[20:23], v[64:67], a[240:243], 0
    v_mfma_f32_16x16x32_bf16 v[20:23], v[68:71], a[244:247], v[20:23]
    v_mfma_f32_16x16x32_bf16 v[20:23], v[72:75], a[248:251], v[20:23]
    s_call_b64 s[66:67], L_kst
    ds_write_b16 v8, v31 offset:464
    v_and_b32 v30, 0xffff0000, v31
    v_max_f32 v9, v9, v30
    s_call_b64 s[66:67], L_pack2
    v_mov_b32 v130, v76
    v_mov_b32 v131, v77
    v_mov_b32 v132, v79
    v_mov_b32 v133, v36
    v_mov_b32 v134, v37
    v_mov_b32 v135, v39
    v_mov_b32 v136, v24
    v_mov_b32 v137, v25
    v_mov_b32 v138, v27
    s_movk_i32 s59, 29
    s_cbranch_vccz L_clean_53
    s_call_b64 s[66:67], L_pexc2
L_clean_53:
    s_waitcnt vmcnt(3)
    buffer_load_dwordx4 v[64:67], v1, s[4:7], s50 offen offset:0 nt
    buffer_load_dwordx4 v[68:71], v1, s[4:7], s50 offen offset:128 nt
    buffer_load_dwordx4 v[72:75], v1, s[4:7], s50 offen offset:256 nt
    s_add_u32 s50, s58, 1622016
    s_cmp_ge_u32 s50, s53
    s_cselect_b32 s62, 2064384, 0
    s_sub_u32 s50, s50, s62
    v_mfma_f32_16x16x32_bf16 v[20:23], v[40:43], a[240:243], 0
    v_mfma_f32_16x16x32_bf16 v[20:23], v[44:47], a[244:247], v[20:23]
    v_mfma_f32_16x16x32_bf16 v[20:23], v[48:51], a[248:251], v[20:23]
    s_call_b64 s[66:67], L_kst
    ds_write_b16 v8, v31 offset:480
    v_and_b32 v30, 0xffff0000, v31
    v_max_f32 v9, v9, v30
    s_call_b64 s[66:67], L_pack0
    v_mov_b32 v148, v76
    v_mov_b32 v149, v77
    v_mov_b32 v150, v79
    v_mov_b32 v151, v36
    v_mov_b32 v152, v37
    v_mov_b32 v153, v39
    v_mov_b32 v154, v24
    v_mov_b32 v155, v25
    v_mov_b32 v156, v27
    s_movk_i32 s59, 30
    s_cbranch_vccz L_clean_54
    s_call_b64 s[66:67], L_pexc0
L_clean_54:
    s_waitcnt vmcnt(3)
    buffer_load_dwordx4 v[40:43], v1, s[4:7], s50 offen offset:0 nt
    buffer_load_dwordx4 v[44:47], v1, s[4:7], s50 offen offset:128 nt
    buffer_load_dwordx4 v[48:51], v1, s[4:7], s50 offen offset:256 nt
    s_add_u32 s50, s48, 1671168
    s_cmp_ge_u32 s50, s53
    s_cselect_b32 s62, 2064384, 0
    s_sub_u32 s50, s50, s62
    v_mfma_f32_16x16x32_bf16 v[20:23], v[52:55], a[240:243], 0
    v_mfma_f32_16x16x32_bf16 v[20:23], v[56:59], a[244:247], v[20:23]
    v_mfma_f32_16x16x32_bf16 v[20:23], v[60:63], a[248:251], v[20:23]
    s_call_b64 s[66:67], L_kst
    ds_write_b16 v8, v31 offset:496
    v_and_b32 v30, 0xffff0000, v31
    v_max_f32 v9, v9, v30
    s_call_b64 s[66:67], L_pack1
    v_mov_b32 v166, v76
    v_mov_b32 v167, v77
    v_mov_b32 v168, v79
    v_mov_b32 v169, v36
    v_mov_b32 v170, v37
    v_mov_b32 v171, v39
    v_mov_b32 v172, v24
    v_mov_b32 v173, v25
    v_mov_b32 v174, v27
    s_movk_i32 s59, 31
    s_cbranch_vccz L_clean_55
    s_call_b64 s[66:67], L_pexc1
L_clean_55:
    s_waitcnt vmcnt(3)
    buffer_load_dwordx4 v[52:55], v1, s[4:7], s50 offen offset:0 nt
    buffer_load_dwordx4 v[56:59], v1, s[4:7], s50 offen offset:128 nt
    buffer_load_dwordx4 v[60:63], v1, s[4:7], s50 offen offset:256 nt
    s_add_u32 s50, s58, 1720320
    s_cmp_ge_u32 s50, s53
    s_cselect_b32 s62, 2064384, 0
    s_sub_u32 s50, s50, s62
    v_mfma_f32_16x16x32_bf16 v[20:23], v[64:67], a[240:243], 0
    v_mfma_f32_16x16x32_bf16 v[20:23], v[68:71], a[244:247], v[20:23]
    v_mfma_f32_16x16x32_bf16 v[20:23], v[72:75], a[248:251], v[20:23]
    s_call_b64 s[66:67], L_kst
    ds_write_b16 v8, v31 offset:512
    v_and_b32 v30, 0xffff0000, v31
    v_max_f32 v9, v9, v30
    s_call_b64 s[66:67], L_pack2
    v_mov_b32 v184, v76
    v_mov_b32 v185, v77
    v_mov_b32 v186, v79
    v_mov_b32 v187, v36
    v_mov_b32 v188, v37
    v_mov_b32 v189, v39
    v_mov_b32 v190, v24
    v_mov_b32 v191, v25
    v_mov_b32 v192, v27
    s_movk_i32 s59, 32
    s_cbranch_vccz L_clean_56
    s_call_b64 s[66:67], L_pexc2
L_clean_56:
    s_waitcnt vmcnt(3)
    buffer_load_dwordx4 v[64:67], v1, s[4:7], s50 offen offset:0 nt
    buffer_load_dwordx4 v[68:71], v1, s[4:7], s50 offen offset:128 nt
    buffer_load_dwordx4 v[72:75], v1, s[4:7], s50 offen offset:256 nt
    s_add_u32 s50, s48, 1769472
    s_cmp_ge_u32 s50, s53
    s_cselect_b32 s62, 2064384, 0
    s_sub_u32 s50, s50, s62
    v_mfma_f32_16x16x32_bf16 v[20:23], v[40:43], a[240:243], 0
    v_mfma_f32_16x16x32_bf16 v[20:23], v[44:47], a[244:247], v[20:23]
    v_mfma_f32_16x16x32_bf16 v[20:23], v[48:51], a[248:251], v[20:23]
    s_call_b64 s[66:67], L_kst
    ds_write_b16 v8, v31 offset:528
    v_and_b32 v30, 0xffff0000, v31
    v_max_f32 v9, v9, v30
    s_call_b64 s[66:67], L_pack0
    v_mov_b32 v202, v76
    v_mov_b32 v203, v77
    v_mov_b32 v204, v79
    v_mov_b32 v205, v36
    v_mov_b32 v206, v37
    v_mov_b32 v207, v39
    v_mov_b32 v208, v24
    v_mov_b32 v209, v25
    v_mov_b32 v210, v27
    s_movk_i32 s59, 33
    s_cbranch_vccz L_clean_57
    s_call_b64 s[66:67], L_pexc0
L_clean_57:
    s_waitcnt vmcnt(3)
    buffer_load_dwordx4 v[40:43], v1, s[4:7], s50 offen offset:0 sc1
    buffer_load_dwordx4 v[44:47], v1, s[4:7], s50 offen offset:128 sc1
    buffer_load_dwordx4 v[48:51], v1, s[4:7], s50 offen offset:256 sc1
    s_add_u32 s50, s58, 1818624
    s_cmp_ge_u32 s50, s53
    s_cselect_b32 s62, 2064384, 0
    s_sub_u32 s50, s50, s62
    v_mfma_f32_16x16x32_bf16 v[20:23], v[52:55], a[240:243], 0
    v_mfma_f32_16x16x32_bf16 v[20:23], v[56:59], a[244:247], v[20:23]
    v_mfma_f32_16x16x32_bf16 v[20:23], v[60:63], a[248:251], v[20:23]
    s_call_b64 s[66:67], L_kst
    ds_write_b16 v8, v31 offset:544
    v_and_b32 v30, 0xffff0000, v31
    v_max_f32 v9, v9, v30
    s_call_b64 s[66:67], L_pack1
    v_mov_b32 v220, v76
    v_mov_b32 v221, v77
    v_mov_b32 v222, v79
    v_mov_b32 v223, v36
    v_mov_b32 v224, v37
    v_mov_b32 v225, v39
    v_mov_b32 v226, v24
    v_mov_b32 v227, v25
    v_mov_b32 v228, v27
    s_movk_i32 s59, 34
    s_cbranch_vccz L_clean_58
    s_call_b64 s[66:67], L_pexc1
L_clean_58:
    s_waitcnt vmcnt(3)
    buffer_load_dwordx4 v[52:55], v1, s[4:7], s50 offen offset:0 sc1
    buffer_load_dwordx4 v[56:59], v1, s[4:7], s50 offen offset:128 sc1
    buffer_load_dwordx4 v[60:63], v1, s[4:7], s50 offen offset:256 sc1
    s_add_u32 s50, s48, 1867776
    s_cmp_ge_u32 s50, s53
    s_cselect_b32 s62, 2064384, 0
    s_sub_u32 s50, s50, s62
    v_mfma_f32_16x16x32_bf16 v[20:23], v[64:67], a[240:243], 0
    v_mfma_f32_16x16x32_bf16 v[20:23], v[68:71], a[244:247], v[20:23]
    v_mfma_f32_16x16x32_bf16 v[20:23], v[72:75], a[248:251], v[20:23]
    s_call_b64 s[66:67], L_kst
    ds_write_b16 v8, v31 offset:560
    v_and_b32 v30, 0xffff0000, v31
    v_max_f32 v9, v9, v30
    s_call_b64 s[66:67], L_pack2
    v_mov_b32 v238, v76
    v_mov_b32 v239, v77
    v_mov_b32 v240, v79
    v_mov_b32 v241, v36
    v_mov_b32 v242, v37
    v_mov_b32 v243, v39
    v_mov_b32 v244, v24
    v_mov_b32 v245, v25
    v_mov_b32 v246, v27
    s_movk_i32 s59, 35
    s_cbranch_vccz L_clean_59
    s_call_b64 s[66:67], L_pexc2
L_clean_59:
    s_waitcnt vmcnt(3)
    buffer_load_dwordx4 v[64:67], v1, s[4:7], s50 offen offset:0 sc1
    buffer_load_dwordx4 v[68:71], v1, s[4:7], s50 offen offset:128 sc1
    buffer_load_dwordx4 v[72:75], v1, s[4:7], s50 offen offset:256 sc1
    s_add_u32 s50, s58, 1916928
    s_cmp_ge_u32 s50, s53
    s_cselect_b32 s62, 2064384, 0
    s_sub_u32 s50, s50, s62
    v_mfma_f32_16x16x32_bf16 v[20:23], v[40:43], a[240:243], 0
    v_mfma_f32_16x16x32_bf16 v[20:23], v[44:47], a[244:247], v[20:23]
    v_mfma_f32_16x16x32_bf16 v[20:23], v[48:51], a[248:251], v[20:23]
    s_call_b64 s[66:67], L_kst
    ds_write_b16 v8, v31 offset:576
    v_and_b32 v30, 0xffff0000, v31
    v_max_f32 v9, v9, v30
    v_accvgpr_read_b32 v76, a0
    v_accvgpr_read_b32 v77, a1
    v_accvgpr_read_b32 v79, a2
    v_accvgpr_read_b32 v36, a3
    v_accvgpr_read_b32 v37, a4
    v_accvgpr_read_b32 v39, a5
    v_accvgpr_read_b32 v24, a6
    v_accvgpr_read_b32 v25, a7
    v_accvgpr_read_b32 v27, a8
    s_movk_i32 s59, 0
    s_call_b64 s[66:67], L_ks
    ds_write_b16 v8, v31 offset:0
    v_and_b32 v30, 0xffff0000, v31
    v_max_f32 v9, v9, v30
    s_waitcnt vmcnt(3)
    buffer_load_dwordx4 v[40:43], v1, s[4:7], s50 offen offset:0 sc1
    buffer_load_dwordx4 v[44:47], v1, s[4:7], s50 offen offset:128 sc1
    buffer_load_dwordx4 v[48:51], v1, s[4:7], s50 offen offset:256 sc1
    s_add_u32 s50, s48, 1966080
    s_cmp_ge_u32 s50, s53
    s_cselect_b32 s62, 2064384, 0
    s_sub_u32 s50, s50, s62
    v_mfma_f32_16x16x32_bf16 v[20:23], v[52:55], a[240:243], 0
    v_mfma_f32_16x16x32_bf16 v[20:23], v[56:59], a[244:247], v[20:23]
    v_mfma_f32_16x16x32_bf16 v[20:23], v[60:63], a[248:251], v[20:23]
    s_call_b64 s[66:67], L_kst
    ds_write_b16 v8, v31 offset:592
    v_and_b32 v30, 0xffff0000, v31
    v_max_f32 v9, v9, v30
    v_accvgpr_read_b32 v76, a45
    v_accvgpr_read_b32 v77, a46
    v_accvgpr_read_b32 v79, a47
    v_accvgpr_read_b32 v36, a48
    v_accvgpr_read_b32 v37, a49
    v_accvgpr_read_b32 v39, a50
    v_accvgpr_read_b32 v24, a51
    v_accvgpr_read_b32 v25, a52
    v_accvgpr_read_b32 v27, a53
    s_movk_i32 s59, 1
    s_call_b64 s[66:67], L_ks
    ds_write_b16 v8, v31 offset:16
    v_and_b32 v30, 0xffff0000, v31
    v_max_f32 v9, v9, v30
    s_waitcnt vmcnt(3)
    buffer_load_dwordx4 v[52:55], v1, s[4:7], s50 offen offset:0 sc1
    buffer_load_dwordx4 v[56:59], v1, s[4:7], s50 offen offset:128 sc1
    buffer_load_dwordx4 v[60:63], v1, s[4:7], s50 offen offset:256 sc1
    s_add_u32 s50, s58, 2015232
    s_cmp_ge_u32 s50, s53
    s_cselect_b32 s62, 2064384, 0
    s_sub_u32 s50, s50, s62
    v_mfma_f32_16x16x32_bf16 v[20:23], v[64:67], a[240:243], 0
    v_mfma_f32_16x16x32_bf16 v[20:23], v[68:71], a[244:247], v[20:23]
    v_mfma_f32_16x16x32_bf16 v[20:23], v[72:75], a[248:251], v[20:23]
    s_call_b64 s[66:67], L_kst
    ds_write_b16 v8, v31 offset:608
    v_and_b32 v30, 0xffff0000, v31
    v_max_f32 v9, v9, v30
    v_accvgpr_read_b32 v76, a54
    v_accvgpr_read_b32 v77, a55
    v_accvgpr_read_b32 v79, a56
    v_accvgpr_read_b32 v36, a57
    v_accvgpr_read_b32 v37, a58
    v_accvgpr_read_b32 v39, a59
    v_accvgpr_read_b32 v24, a60
    v_accvgpr_read_b32 v25, a61
    v_accvgpr_read_b32 v27, a62
    s_movk_i32 s59, 2
    s_call_b64 s[66:67], L_ks
    ds_write_b16 v8, v31 offset:32
    v_and_b32 v30, 0xffff0000, v31
    v_max_f32 v9, v9, v30
    s_waitcnt vmcnt(3)
    buffer_load_dwordx4 v[64:67], v1, s[4:7], s50 offen offset:0 sc1
    buffer_load_dwordx4 v[68:71], v1, s[4:7], s50 offen offset:128 sc1
    buffer_load_dwordx4 v[72:75], v1, s[4:7], s50 offen offset:256 sc1
    s_sub_u32 s50, 128, s49
    s_lshr_b32 s61, s2, 2
    s_xor_b32 s61, s61, s2
    s_bfe_u32 s61, s61, 0x10002
    s_mul_i32 s50, s50, s61
    s_bfe_u32 s61, s2, 0x10003
    s_lshl1_add_u32 s50, s50, s61
    s_lshl2_add_u32 s50, s50, s46
    s_mul_i32 s50, s50, 3072
    s_add_u32 s50, s50, s47
    s_mov_b32 s51, 24576
    s_add_u32 s60, s53, s0
    s_cmp_eq_u32 s49, 43
    s_cselect_b32 s50, s60, s50
    v_mfma_f32_16x16x32_bf16 v[20:23], v[40:43], a[240:243], 0
    v_mfma_f32_16x16x32_bf16 v[20:23], v[44:47], a[244:247], v[20:23]
    v_mfma_f32_16x16x32_bf16 v[20:23], v[48:51], a[248:251], v[20:23]
    s_call_b64 s[66:67], L_kst
    ds_write_b16 v8, v31 offset:624
    v_and_b32 v30, 0xffff0000, v31
    v_max_f32 v9, v9, v30
    v_accvgpr_read_b32 v76, a63
    v_accvgpr_read_b32 v77, a64
    v_accvgpr_read_b32 v79, a65
    v_accvgpr_read_b32 v36, a66
    v_accvgpr_read_b32 v37, a67
    v_accvgpr_read_b32 v39, a68
    v_accvgpr_read_b32 v24, a69
    v_accvgpr_read_b32 v25, a70
    v_accvgpr_read_b32 v27, a71
    s_movk_i32 s59, 3
    s_call_b64 s[66:67], L_ks
    ds_write_b16 v8, v31 offset:48
    v_and_b32 v30, 0xffff0000, v31
    v_max_f32 v9, v9, v30
    s_waitcnt vmcnt(3)
    buffer_load_dwordx4 v[40:43], v1, s[4:7], s50 offen offset:0 sc1
    buffer_load_dwordx4 v[44:47], v1, s[4:7], s50 offen offset:128 sc1
    buffer_load_dwordx4 v[48:51], v1, s[4:7], s50 offen offset:256 sc1
    s_sub_u32 s60, 128, s49
    s_lshr_b32 s61, s2, 2
    s_xor_b32 s61, s61, s2
    s_bfe_u32 s61, s61, 0x10002
    s_mul_i32 s60, s60, s61
    s_bfe_u32 s61, s2, 0x10003
    s_lshl1_add_u32 s60, s60, s61
    s_lshl2_add_u32 s60, s60, s46
    s_mul_i32 s60, s60, 3072
    s_add_u32 s60, s60, s47
    s_add_u32 s50, s50, s51
    s_sub_u32 s61, 98304, s51
    s_cmp_eq_u32 s49, 43
    s_cselect_b32 s50, s60, s50
    s_cselect_b32 s51, s51, s61
    v_mfma_f32_16x16x32_bf16 v[20:23], v[52:55], a[240:243], 0
    v_mfma_f32_16x16x32_bf16 v[20:23], v[56:59], a[244:247], v[20:23]
    v_mfma_f32_16x16x32_bf16 v[20:23], v[60:63], a[248:251], v[20:23]
    s_call_b64 s[66:67], L_kst
    ds_write_b16 v8, v31 offset:640
    v_and_b32 v30, 0xffff0000, v31
    v_max_f32 v9, v9, v30
    v_accvgpr_read_b32 v76, a72
    v_accvgpr_read_b32 v77, a73
    v_accvgpr_read_b32 v79, a74
    v_accvgpr_read_b32 v36, a75
    v_accvgpr_read_b32 v37, a76
    v_accvgpr_read_b32 v39, a77
    v_accvgpr_read_b32 v24, a78
    v_accvgpr_read_b32 v25, a79
    v_accvgpr_read_b32 v27, a80
    s_movk_i32 s59, 4
    s_call_b64 s[66:67], L_ks
    ds_write_b16 v8, v31 offset:64
    v_and_b32 v30, 0xffff0000, v31
    v_max_f32 v9, v9, v30
    s_waitcnt vmcnt(3)
    buffer_load_dwordx4 v[52:55], v1, s[4:7], s50 offen offset:0 sc1
    buffer_load_dwordx4 v[56:59], v1, s[4:7], s50 offen offset:128 nt
    buffer_load_dwordx4 v[60:63], v1, s[4:7], s50 offen offset:256 nt
    s_add_u32 s50, s50, 24576
    v_mfma_f32_16x16x32_bf16 v[20:23], v[64:67], a[240:243], 0
    v_mfma_f32_16x16x32_bf16 v[20:23], v[68:71], a[244:247], v[20:23]
    v_mfma_f32_16x16x32_bf16 v[20:23], v[72:75], a[248:251], v[20:23]
    s_call_b64 s[66:67], L_kst
    ds_write_b16 v8, v31 offset:656
    v_and_b32 v30, 0xffff0000, v31
    v_max_f32 v9, v9, v30
    v_accvgpr_read_b32 v76, a81
    v_accvgpr_read_b32 v77, a82
    v_accvgpr_read_b32 v79, a83
    v_accvgpr_read_b32 v36, a84
    v_accvgpr_read_b32 v37, a85
    v_accvgpr_read_b32 v39, a86
    v_accvgpr_read_b32 v24, a87
    v_accvgpr_read_b32 v25, a88
    v_accvgpr_read_b32 v27, a89
    s_movk_i32 s59, 5
    s_call_b64 s[66:67], L_ks
    ds_write_b16 v8, v31 offset:80
    v_and_b32 v30, 0xffff0000, v31
    v_max_f32 v9, v9, v30
    s_waitcnt vmcnt(3)
    buffer_load_dwordx4 v[64:67], v1, s[4:7], s50 offen offset:0 sc1
    buffer_load_dwordx4 v[68:71], v1, s[4:7], s50 offen offset:128 nt
    buffer_load_dwordx4 v[72:75], v1, s[4:7], s50 offen offset:256 nt
    s_add_u32 s50, s50, 24576
    s_cmp_eq_u32 s49, 42
    s_cbranch_scc1 L_k42a
    v_mfma_f32_16x16x32_bf16 v[20:23], v[40:43], a[240:243], 0
    v_mfma_f32_16x16x32_bf16 v[20:23], v[44:47], a[244:247], v[20:23]
    v_mfma_f32_16x16x32_bf16 v[20:23], v[48:51], a[248:251], v[20:23]
    s_call_b64 s[66:67], L_kst
    ds_write_b16 v8, v31 offset:672
    v_and_b32 v30, 0xffff0000, v31
    v_max_f32 v9, v9, v30
    s_branch L_k42e
L_k42a:
    v_mfma_f32_16x16x32_bf16 v[20:23], v[40:43], a[20:23], 0
    v_mfma_f32_16x16x32_bf16 v[20:23], v[44:47], a[36:39], v[20:23]
    v_mfma_f32_16x16x32_bf16 v[20:23], v[48:51], a[40:43], v[20:23]
    s_call_b64 s[66:67], L_kat
L_k42e:
    s_waitcnt vmcnt(3)
    buffer_load_dwordx4 v[40:43], v1, s[4:7], s50 offen offset:0 sc1
    buffer_load_dwordx4 v[44:47], v1, s[4:7], s50 offen offset:128 nt
    buffer_load_dwordx4 v[48:51], v1, s[4:7], s50 offen offset:256 nt
    s_add_u32 s50, s50, 24576
    v_mfma_f32_16x16x32_bf16 v[20:23], v[52:55], a[20:23], 0
    v_mfma_f32_16x16x32_bf16 v[20:23], v[56:59], a[36:39], v[20:23]
    v_mfma_f32_16x16x32_bf16 v[20:23], v[60:63], a[40:43], v[20:23]
    s_call_b64 s[66:67], L_kat
    v_accvgpr_read_b32 v76, a90
    v_accvgpr_read_b32 v77, a91
    v_accvgpr_read_b32 v79, a92
    v_accvgpr_read_b32 v36, a93
    v_accvgpr_read_b32 v37, a94
    v_accvgpr_read_b32 v39, a95
    v_accvgpr_read_b32 v24, a96
    v_accvgpr_read_b32 v25, a97
    v_accvgpr_read_b32 v27, a98
    s_movk_i32 s59, 6
    s_call_b64 s[66:67], L_ks
    ds_write_b16 v8, v31 offset:96
    v_and_b32 v30, 0xffff0000, v31
    v_max_f32 v9, v9, v30
    s_waitcnt vmcnt(3)
    buffer_load_dwordx4 v[52:55], v1, s[4:7], s50 offen offset:0 sc1
    buffer_load_dwordx4 v[56:59], v1, s[4:7], s50 offen offset:128 nt
    buffer_load_dwordx4 v[60:63], v1, s[4:7], s50 offen offset:256 nt
    s_add_u32 s50, s50, 24576
    v_mfma_f32_16x16x32_bf16 v[20:23], v[64:67], a[20:23], 0
    v_mfma_f32_16x16x32_bf16 v[20:23], v[68:71], a[36:39], v[20:23]
    v_mfma_f32_16x16x32_bf16 v[20:23], v[72:75], a[40:43], v[20:23]
    s_call_b64 s[66:67], L_kat
    v_accvgpr_read_b32 v76, a99
    v_accvgpr_read_b32 v77, a100
    v_accvgpr_read_b32 v79, a101
    v_accvgpr_read_b32 v36, a102
    v_accvgpr_read_b32 v37, a103
    v_accvgpr_read_b32 v39, a104
    v_accvgpr_read_b32 v24, a105
    v_accvgpr_read_b32 v25, a106
    v_accvgpr_read_b32 v27, a107
    s_movk_i32 s59, 7
    s_call_b64 s[66:67], L_ks
    ds_write_b16 v8, v31 offset:112
    v_and_b32 v30, 0xffff0000, v31
    v_max_f32 v9, v9, v30
    s_waitcnt vmcnt(3)
    buffer_load_dwordx4 v[64:67], v1, s[4:7], s50 offen offset:0 sc1
    buffer_load_dwordx4 v[68:71], v1, s[4:7], s50 offen offset:128 nt
    buffer_load_dwordx4 v[72:75], v1, s[4:7], s50 offen offset:256 nt
    s_add_u32 s50, s50, 24576
    v_mfma_f32_16x16x32_bf16 v[20:23], v[40:43], a[20:23], 0
    v_mfma_f32_16x16x32_bf16 v[20:23], v[44:47], a[36:39], v[20:23]
    v_mfma_f32_16x16x32_bf16 v[20:23], v[48:51], a[40:43], v[20:23]
    s_call_b64 s[66:67], L_kat
    v_accvgpr_read_b32 v76, a108
    v_accvgpr_read_b32 v77, a109
    v_accvgpr_read_b32 v79, a110
    v_accvgpr_read_b32 v36, a111
    v_accvgpr_read_b32 v37, a112
    v_accvgpr_read_b32 v39, a113
    v_accvgpr_read_b32 v24, a114
    v_accvgpr_read_b32 v25, a115
    v_accvgpr_read_b32 v27, a116
    s_movk_i32 s59, 8
    s_call_b64 s[66:67], L_ks
    ds_write_b16 v8, v31 offset:128
    v_and_b32 v30, 0xffff0000, v31
    v_max_f32 v9, v9, v30
    s_waitcnt vmcnt(3)
    buffer_load_dwordx4 v[40:43], v1, s[4:7], s50 offen offset:0 sc1
    buffer_load_dwordx4 v[44:47], v1, s[4:7], s50 offen offset:128 sc1
    buffer_load_dwordx4 v[48:51], v1, s[4:7], s50 offen offset:256 nt
    s_add_u32 s50, s50, 24576
    v_mfma_f32_16x16x32_bf16 v[20:23], v[52:55], a[20:23], 0
    v_mfma_f32_16x16x32_bf16 v[20:23], v[56:59], a[36:39], v[20:23]
    v_mfma_f32_16x16x32_bf16 v[20:23], v[60:63], a[40:43], v[20:23]
    s_call_b64 s[66:67], L_kat
    v_accvgpr_read_b32 v76, a9
    v_accvgpr_read_b32 v77, a10
    v_accvgpr_read_b32 v79, a11
    v_accvgpr_read_b32 v36, a12
    v_accvgpr_read_b32 v37, a13
    v_accvgpr_read_b32 v39, a14
    v_accvgpr_read_b32 v24, a15
    v_accvgpr_read_b32 v25, a16
    v_accvgpr_read_b32 v27, a17
    s_movk_i32 s59, 9
    s_call_b64 s[66:67], L_ks
    ds_write_b16 v8, v31 offset:144
    v_and_b32 v30, 0xffff0000, v31
    v_max_f32 v9, v9, v30
    s_waitcnt vmcnt(3)
    buffer_load_dwordx4 v[52:55], v1, s[4:7], s50 offen offset:0 sc1
    buffer_load_dwordx4 v[56:59], v1, s[4:7], s50 offen offset:128 nt
    buffer_load_dwordx4 v[60:63], v1, s[4:7], s50 offen offset:256 nt
    s_add_u32 s50, s50, 24576
    v_mfma_f32_16x16x32_bf16 v[20:23], v[64:67], a[20:23], 0
    v_mfma_f32_16x16x32_bf16 v[20:23], v[68:71], a[36:39], v[20:23]
    v_mfma_f32_16x16x32_bf16 v[20:23], v[72:75], a[40:43], v[20:23]
    s_call_b64 s[66:67], L_kat
    v_accvgpr_read_b32 v76, a27
    v_accvgpr_read_b32 v77, a28
    v_accvgpr_read_b32 v79, a29
    v_accvgpr_read_b32 v36, a30
    v_accvgpr_read_b32 v37, a31
    v_accvgpr_read_b32 v39, a32
    v_accvgpr_read_b32 v24, a33
    v_accvgpr_read_b32 v25, a34
    v_accvgpr_read_b32 v27, a35
    s_movk_i32 s59, 10
    s_call_b64 s[66:67], L_ks
    ds_write_b16 v8, v31 offset:160
    v_and_b32 v30, 0xffff0000, v31
    v_max_f32 v9, v9, v30
    s_waitcnt vmcnt(3)
    buffer_load_dwordx4 v[64:67], v1, s[4:7], s50 offen offset:0 sc1
    buffer_load_dwordx4 v[68:71], v1, s[4:7], s50 offen offset:128 nt
    buffer_load_dwordx4 v[72:75], v1, s[4:7], s50 offen offset:256 nt
    s_add_u32 s50, s50, 24576
    v_mfma_f32_16x16x32_bf16 v[20:23], v[40:43], a[20:23], 0
    v_mfma_f32_16x16x32_bf16 v[20:23], v[44:47], a[36:39], v[20:23]
    v_mfma_f32_16x16x32_bf16 v[20:23], v[48:51], a[40:43], v[20:23]
    s_call_b64 s[66:67], L_kat
    v_accvgpr_read_b32 v76, a117
    v_accvgpr_read_b32 v77, a118
    v_accvgpr_read_b32 v79, a119
    v_accvgpr_read_b32 v36, a120
    v_accvgpr_read_b32 v37, a121
    v_accvgpr_read_b32 v39, a122
    v_accvgpr_read_b32 v24, a123
    v_accvgpr_read_b32 v25, a124
    v_accvgpr_read_b32 v27, a125
    s_movk_i32 s59, 11
    s_call_b64 s[66:67], L_ks
    ds_write_b16 v8, v31 offset:176
    v_and_b32 v30, 0xffff0000, v31
    v_max_f32 v9, v9, v30
    s_waitcnt vmcnt(3)
    buffer_load_dwordx4 v[40:43], v1, s[4:7], s50 offen offset:0 sc1
    buffer_load_dwordx4 v[44:47], v1, s[4:7], s50 offen offset:128 nt
    buffer_load_dwordx4 v[48:51], v1, s[4:7], s50 offen offset:256 nt
    s_add_u32 s50, s50, 24576
    v_mfma_f32_16x16x32_bf16 v[20:23], v[52:55], a[20:23], 0
    v_mfma_f32_16x16x32_bf16 v[20:23], v[56:59], a[36:39], v[20:23]
    v_mfma_f32_16x16x32_bf16 v[20:23], v[60:63], a[40:43], v[20:23]
    s_call_b64 s[66:67], L_kat
    v_accvgpr_read_b32 v76, a135
    v_accvgpr_read_b32 v77, a136
    v_accvgpr_read_b32 v79, a137
    v_accvgpr_read_b32 v36, a138
    v_accvgpr_read_b32 v37, a139
    v_accvgpr_read_b32 v39, a140
    v_accvgpr_read_b32 v24, a141
    v_accvgpr_read_b32 v25, a142
    v_accvgpr_read_b32 v27, a143
    s_movk_i32 s59, 12
    s_call_b64 s[66:67], L_ks
    ds_write_b16 v8, v31 offset:192
    v_and_b32 v30, 0xffff0000, v31
    v_max_f32 v9, v9, v30
    s_waitcnt vmcnt(3)
    buffer_load_dwordx4 v[52:55], v1, s[4:7], s50 offen offset:0 sc1
    buffer_load_dwordx4 v[56:59], v1, s[4:7], s50 offen offset:128 nt
    buffer_load_dwordx4 v[60:63], v1, s[4:7], s50 offen offset:256 nt
    s_add_u32 s50, s50, 24576
    v_mfma_f32_16x16x32_bf16 v[20:23], v[64:67], a[20:23], 0
    v_mfma_f32_16x16x32_bf16 v[20:23], v[68:71], a[36:39], v[20:23]
    v_mfma_f32_16x16x32_bf16 v[20:23], v[72:75], a[40:43], v[20:23]
    s_call_b64 s[66:67], L_kat
    v_accvgpr_read_b32 v76, a153
    v_accvgpr_read_b32 v77, a154
    v_accvgpr_read_b32 v79, a155
    v_accvgpr_read_b32 v36, a156
    v_accvgpr_read_b32 v37, a157
    v_accvgpr_read_b32 v39, a158
    v_accvgpr_read_b32 v24, a159
    v_accvgpr_read_b32 v25, a160
    v_accvgpr_read_b32 v27, a161
    s_movk_i32 s59, 13
    s_call_b64 s[66:67], L_ks
    ds_write_b16 v8, v31 offset:208
    v_and_b32 v30, 0xffff0000, v31
    v_max_f32 v9, v9, v30
    s_waitcnt vmcnt(3)
    buffer_load_dwordx4 v[64:67], v1, s[4:7], s50 offen offset:0 sc1
    buffer_load_dwordx4 v[68:71], v1, s[4:7], s50 offen offset:128 nt
    buffer_load_dwordx4 v[72:75], v1, s[4:7], s50 offen offset:256 nt
    s_add_u32 s50, s50, 24576
    v_mfma_f32_16x16x32_bf16 v[20:23], v[40:43], a[20:23], 0
    v_mfma_f32_16x16x32_bf16 v[20:23], v[44:47], a[36:39], v[20:23]
    v_mfma_f32_16x16x32_bf16 v[20:23], v[48:51], a[40:43], v[20:23]
    s_call_b64 s[66:67], L_kat
    v_accvgpr_read_b32 v76, a171
    v_accvgpr_read_b32 v77, a172
    v_accvgpr_read_b32 v79, a173
    v_accvgpr_read_b32 v36, a174
    v_accvgpr_read_b32 v37, a175
    v_accvgpr_read_b32 v39, a176
    v_accvgpr_read_b32 v24, a177
    v_accvgpr_read_b32 v25, a178
    v_accvgpr_read_b32 v27, a179
    s_movk_i32 s59, 14
    s_call_b64 s[66:67], L_ks
    ds_write_b16 v8, v31 offset:224
    v_and_b32 v30, 0xffff0000, v31
    v_max_f32 v9, v9, v30
    s_waitcnt vmcnt(3)
    buffer_load_dwordx4 v[40:43], v1, s[4:7], s50 offen offset:0 sc1
    buffer_load_dwordx4 v[44:47], v1, s[4:7], s50 offen offset:128 sc1
    buffer_load_dwordx4 v[48:51], v1, s[4:7], s50 offen offset:256 nt
    s_add_u32 s50, s50, 24576
    v_mfma_f32_16x16x32_bf16 v[20:23], v[52:55], a[20:23], 0
    v_mfma_f32_16x16x32_bf16 v[20:23], v[56:59], a[36:39], v[20:23]
    v_mfma_f32_16x16x32_bf16 v[20:23], v[60:63], a[40:43], v[20:23]
    s_call_b64 s[66:67], L_kat
    v_accvgpr_read_b32 v76, a189
    v_accvgpr_read_b32 v77, a190
    v_accvgpr_read_b32 v79, a191
    v_accvgpr_read_b32 v36, a192
    v_accvgpr_read_b32 v37, a193
    v_accvgpr_read_b32 v39, a194
    v_accvgpr_read_b32 v24, a195
    v_accvgpr_read_b32 v25, a196
    v_accvgpr_read_b32 v27, a197
    s_movk_i32 s59, 15
    s_call_b64 s[66:67], L_ks
    ds_write_b16 v8, v31 offset:240
    v_and_b32 v30, 0xffff0000, v31
    v_max_f32 v9, v9, v30
    s_waitcnt vmcnt(3)
    buffer_load_dwordx4 v[52:55], v1, s[4:7], s50 offen offset:0 sc1
    buffer_load_dwordx4 v[56:59], v1, s[4:7], s50 offen offset:128 nt
    buffer_load_dwordx4 v[60:63], v1, s[4:7], s50 offen offset:256 nt
    s_add_u32 s50, s50, 24576
    v_mfma_f32_16x16x32_bf16 v[20:23], v[64:67], a[20:23], 0
    v_mfma_f32_16x16x32_bf16 v[20:23], v[68:71], a[36:39], v[20:23]
    v_mfma_f32_16x16x32_bf16 v[20:23], v[72:75], a[40:43], v[20:23]
    s_call_b64 s[66:67], L_kat
    v_accvgpr_read_b32 v76, a207
    v_accvgpr_read_b32 v77, a208
    v_accvgpr_read_b32 v79, a209
    v_accvgpr_read_b32 v36, a210
    v_accvgpr_read_b32 v37, a211
    v_accvgpr_read_b32 v39, a212
    v_accvgpr_read_b32 v24, a213
    v_accvgpr_read_b32 v25, a214
    v_accvgpr_read_b32 v27, a215
    s_movk_i32 s59, 16
    s_call_b64 s[66:67], L_ks
    ds_write_b16 v8, v31 offset:256
    v_and_b32 v30, 0xffff0000, v31
    v_max_f32 v9, v9, v30
    s_waitcnt vmcnt(3)
    buffer_load_dwordx4 v[64:67], v1, s[4:7], s50 offen offset:0 sc1
    buffer_load_dwordx4 v[68:71], v1, s[4:7], s50 offen offset:128 nt
    buffer_load_dwordx4 v[72:75], v1, s[4:7], s50 offen offset:256 nt
    s_add_u32 s50, s50, 24576
    v_mfma_f32_16x16x32_bf16 v[20:23], v[40:43], a[20:23], 0
    v_mfma_f32_16x16x32_bf16 v[20:23], v[44:47], a[36:39], v[20:23]
    v_mfma_f32_16x16x32_bf16 v[20:23], v[48:51], a[40:43], v[20:23]
    s_call_b64 s[66:67], L_kat
    v_accvgpr_read_b32 v76, a225
    v_accvgpr_read_b32 v77, a226
    v_accvgpr_read_b32 v79, a227
    v_accvgpr_read_b32 v36, a228
    v_accvgpr_read_b32 v37, a229
    v_accvgpr_read_b32 v39, a230
    v_accvgpr_read_b32 v24, a231
    v_accvgpr_read_b32 v25, a232
    v_accvgpr_read_b32 v27, a233
    s_movk_i32 s59, 17
    s_call_b64 s[66:67], L_ks
    ds_write_b16 v8, v31 offset:272
    v_and_b32 v30, 0xffff0000, v31
    v_max_f32 v9, v9, v30
    s_waitcnt vmcnt(3)
    buffer_load_dwordx4 v[40:43], v1, s[4:7], s50 offen offset:0 sc1
    buffer_load_dwordx4 v[44:47], v1, s[4:7], s50 offen offset:128 nt
    buffer_load_dwordx4 v[48:51], v1, s[4:7], s50 offen offset:256 nt
    s_add_u32 s50, s50, 24576
    v_mfma_f32_16x16x32_bf16 v[20:23], v[52:55], a[20:23], 0
    v_mfma_f32_16x16x32_bf16 v[20:23], v[56:59], a[36:39], v[20:23]
    v_mfma_f32_16x16x32_bf16 v[20:23], v[60:63], a[40:43], v[20:23]
    s_call_b64 s[66:67], L_kat
    ds_read2st64_b32 v[76:77], v32 offset0:0 offset1:1
    ds_read_b32 v79, v32 offset:512
    ds_read2st64_b32 v[36:37], v32 offset0:3 offset1:4
    ds_read_b32 v39, v32 offset:1280
    ds_read2st64_b32 v[24:25], v32 offset0:6 offset1:7
    ds_read_b32 v27, v32 offset:2048
    s_movk_i32 s59, 18
    s_waitcnt lgkmcnt(0)
    s_call_b64 s[66:67], L_ks
    ds_write_b16 v8, v31 offset:288
    v_and_b32 v30, 0xffff0000, v31
    v_max_f32 v9, v9, v30
    s_waitcnt vmcnt(3)
    buffer_load_dwordx4 v[52:55], v1, s[4:7], s50 offen offset:0 sc1
    buffer_load_dwordx4 v[56:59], v1, s[4:7], s50 offen offset:128 nt
    buffer_load_dwordx4 v[60:63], v1, s[4:7], s50 offen offset:256 nt
    s_add_u32 s50, s50, 24576
    v_mfma_f32_16x16x32_bf16 v[20:23], v[64:67], a[20:23], 0
    v_mfma_f32_16x16x32_bf16 v[20:23], v[68:71], a[36:39], v[20:23]
    v_mfma_f32_16x16x32_bf16 v[20:23], v[72:75], a[40:43], v[20:23]
    s_call_b64 s[66:67], L_kat
    ds_read2st64_b32 v[76:77], v32 offset0:18 offset1:19
    ds_read_b32 v79, v32 offset:5120
    ds_read2st64_b32 v[36:37], v32 offset0:21 offset1:22
    ds_read_b32 v39, v32 offset:5888
    ds_read2st64_b32 v[24:25], v32 offset0:24 offset1:25
    ds_read_b32 v27, v32 offset:6656
    s_movk_i32 s59, 19
    s_waitcnt lgkmcnt(0)
    s_call_b64 s[66:67], L_ks
    ds_write_b16 v8, v31 offset:304
    v_and_b32 v30, 0xffff0000, v31
    v_max_f32 v9, v9, v30
    s_waitcnt vmcnt(3)
    buffer_load_dwordx4 v[64:67], v1, s[4:7], s50 offen offset:0 sc1
    buffer_load_dwordx4 v[68:71], v1, s[4:7], s50 offen offset:128 nt
    buffer_load_dwordx4 v[72:75], v1, s[4:7], s50 offen offset:256 nt
    s_add_u32 s50, s50, 24576
    v_mfma_f32_16x16x32_bf16 v[20:23], v[40:43], a[20:23], 0
    v_mfma_f32_16x16x32_bf16 v[20:23], v[44:47], a[36:39], v[20:23]
    v_mfma_f32_16x16x32_bf16 v[20:23], v[48:51], a[40:43], v[20:23]
    s_call_b64 s[66:67], L_kat
    ds_read2st64_b32 v[76:77], v32 offset0:36 offset1:37
    ds_read_b32 v79, v32 offset:9728
    ds_read2st64_b32 v[36:37], v32 offset0:39 offset1:40
    ds_read_b32 v39, v32 offset:10496
    ds_read2st64_b32 v[24:25], v32 offset0:42 offset1:43
    ds_read_b32 v27, v32 offset:11264
    s_movk_i32 s59, 20
    s_waitcnt lgkmcnt(0)
    s_call_b64 s[66:67], L_ks
    ds_write_b16 v8, v31 offset:320
    v_and_b32 v30, 0xffff0000, v31
    v_max_f32 v9, v9, v30
    s_waitcnt vmcnt(3)
    buffer_load_dwordx4 v[40:43], v1, s[4:7], s50 offen offset:0 sc1
    buffer_load_dwordx4 v[44:47], v1, s[4:7], s50 offen offset:128 sc1
    buffer_load_dwordx4 v[48:51], v1, s[4:7], s50 offen offset:256 nt
    s_add_u32 s50, s50, 24576
    v_mfma_f32_16x16x32_bf16 v[20:23], v[52:55], a[20:23], 0
    v_mfma_f32_16x16x32_bf16 v[20:23], v[56:59], a[36:39], v[20:23]
    v_mfma_f32_16x16x32_bf16 v[20:23], v[60:63], a[40:43], v[20:23]
    s_call_b64 s[66:67], L_kat
    ds_read2st64_b32 v[76:77], v32 offset0:54 offset1:55
    ds_read_b32 v79, v32 offset:14336
    ds_read2st64_b32 v[36:37], v32 offset0:57 offset1:58
    ds_read_b32 v39, v32 offset:15104
    ds_read2st64_b32 v[24:25], v32 offset0:60 offset1:61
    ds_read_b32 v27, v32 offset:15872
    s_movk_i32 s59, 21
    s_waitcnt lgkmcnt(0)
    s_call_b64 s[66:67], L_ks
    ds_write_b16 v8, v31 offset:336
    v_and_b32 v30, 0xffff0000, v31
    v_max_f32 v9, v9, v30
    ds_write_b16_d16_hi v8, v9 offset:688
    s_mov_b32 s1, 11
    .p2align 6
L_kloop_60:
    s_waitcnt vmcnt(3)
    buffer_load_dwordx4 v[52:55], v1, s[4:7], s50 offen offset:0 sc1
    buffer_load_dwordx4 v[56:59], v1, s[4:7], s50 offen offset:128 nt
    buffer_load_dwordx4 v[60:63], v1, s[4:7], s50 offen offset:256 nt
    s_add_u32 s50, s50, 24576
    v_mfma_f32_16x16x32_bf16 v[20:23], v[64:67], a[20:23], 0
    v_mfma_f32_16x16x32_bf16 v[20:23], v[68:71], a[36:39], v[20:23]
    v_mfma_f32_16x16x32_bf16 v[20:23], v[72:75], a[40:43], v[20:23]
    s_nop 7
    v_add_f32_dpp v30, v21, v20 quad_perm:[1,0,3,2] row_mask:0xf bank_mask:0x3
    s_nop 1
    v_add_f32_dpp v30, v23, v22 quad_perm:[1,0,3,2] row_mask:0xf bank_mask:0xc
    s_nop 1
    v_mov_b32_dpp v31, v30 quad_perm:[0,0,2,2] row_mask:0xf bank_mask:0xf
    v_cvt_pk_bf16_f32 v31, 0, v31
    v_mul_f32 v31, 0x3d93cd3a, v31
    v_cvt_pk_bf16_f32 v31, v31, v31
    ds_write_b16 v33, v31 offset:0
    v_and_b32 v30, 0xffff0000, v31
    v_max_f32 v35, v35, v30
    s_waitcnt vmcnt(3)
    buffer_load_dwordx4 v[64:67], v1, s[4:7], s50 offen offset:0 sc1
    buffer_load_dwordx4 v[68:71], v1, s[4:7], s50 offen offset:128 nt
    buffer_load_dwordx4 v[72:75], v1, s[4:7], s50 offen offset:256 nt
    s_add_u32 s50, s50, 24576
    v_mfma_f32_16x16x32_bf16 v[20:23], v[40:43], a[20:23], 0
    v_mfma_f32_16x16x32_bf16 v[20:23], v[44:47], a[36:39], v[20:23]
    v_mfma_f32_16x16x32_bf16 v[20:23], v[48:51], a[40:43], v[20:23]
    s_nop 7
    v_add_f32_dpp v30, v21, v20 quad_perm:[1,0,3,2] row_mask:0xf bank_mask:0x3
    s_nop 1
    v_add_f32_dpp v30, v23, v22 quad_perm:[1,0,3,2] row_mask:0xf bank_mask:0xc
    s_nop 1
    v_mov_b32_dpp v31, v30 quad_perm:[0,0,2,2] row_mask:0xf bank_mask:0xf
    v_cvt_pk_bf16_f32 v31, 0, v31
    v_mul_f32 v31, 0x3d93cd3a, v31
    v_cvt_pk_bf16_f32 v31, v31, v31
    ds_write_b16 v33, v31 offset:16
    v_and_b32 v30, 0xffff0000, v31
    v_max_f32 v35, v35, v30
    s_waitcnt vmcnt(3)
    buffer_load_dwordx4 v[40:43], v1, s[4:7], s50 offen offset:0 sc1
    buffer_load_dwordx4 v[44:47], v1, s[4:7], s50 offen offset:128 nt
    buffer_load_dwordx4 v[48:51], v1, s[4:7], s50 offen offset:256 nt
    s_add_u32 s50, s50, 24576
    v_mfma_f32_16x16x32_bf16 v[20:23], v[52:55], a[20:23], 0
    v_mfma_f32_16x16x32_bf16 v[20:23], v[56:59], a[36:39], v[20:23]
    v_mfma_f32_16x16x32_bf16 v[20:23], v[60:63], a[40:43], v[20:23]
    s_nop 7
    v_add_f32_dpp v30, v21, v20 quad_perm:[1,0,3,2] row_mask:0xf bank_mask:0x3
    s_nop 1
    v_add_f32_dpp v30, v23, v22 quad_perm:[1,0,3,2] row_mask:0xf bank_mask:0xc
    s_nop 1
    v_mov_b32_dpp v31, v30 quad_perm:[0,0,2,2] row_mask:0xf bank_mask:0xf
    v_cvt_pk_bf16_f32 v31, 0, v31
    v_mul_f32 v31, 0x3d93cd3a, v31
    v_cvt_pk_bf16_f32 v31, v31, v31
    ds_write_b16 v33, v31 offset:32
    v_and_b32 v30, 0xffff0000, v31
    v_max_f32 v35, v35, v30
    s_waitcnt vmcnt(3)
    buffer_load_dwordx4 v[52:55], v1, s[4:7], s50 offen offset:0 sc1
    buffer_load_dwordx4 v[56:59], v1, s[4:7], s50 offen offset:128 nt
    buffer_load_dwordx4 v[60:63], v1, s[4:7], s50 offen offset:256 nt
    s_add_u32 s50, s50, 24576
    v_mfma_f32_16x16x32_bf16 v[20:23], v[64:67], a[20:23], 0
    v_mfma_f32_16x16x32_bf16 v[20:23], v[68:71], a[36:39], v[20:23]
    v_mfma_f32_16x16x32_bf16 v[20:23], v[72:75], a[40:43], v[20:23]
    s_nop 7
    v_add_f32_dpp v30, v21, v20 quad_perm:[1,0,3,2] row_mask:0xf bank_mask:0x3
    s_nop 1
    v_add_f32_dpp v30, v23, v22 quad_perm:[1,0,3,2] row_mask:0xf bank_mask:0xc
    s_nop 1
    v_mov_b32_dpp v31, v30 quad_perm:[0,0,2,2] row_mask:0xf bank_mask:0xf
    v_cvt_pk_bf16_f32 v31, 0, v31
    v_mul_f32 v31, 0x3d93cd3a, v31
    v_cvt_pk_bf16_f32 v31, v31, v31
    ds_write_b16 v33, v31 offset:48
    v_and_b32 v30, 0xffff0000, v31
    v_max_f32 v35, v35, v30
    s_waitcnt vmcnt(3)
    buffer_load_dwordx4 v[64:67], v1, s[4:7], s50 offen offset:0 sc1
    buffer_load_dwordx4 v[68:71], v1, s[4:7], s50 offen offset:128 nt
    buffer_load_dwordx4 v[72:75], v1, s[4:7], s50 offen offset:256 nt
    s_add_u32 s50, s50, 24576
    v_mfma_f32_16x16x32_bf16 v[20:23], v[40:43], a[20:23], 0
    v_mfma_f32_16x16x32_bf16 v[20:23], v[44:47], a[36:39], v[20:23]
    v_mfma_f32_16x16x32_bf16 v[20:23], v[48:51], a[40:43], v[20:23]
    s_nop 7
    v_add_f32_dpp v30, v21, v20 quad_perm:[1,0,3,2] row_mask:0xf bank_mask:0x3
    s_nop 1
    v_add_f32_dpp v30, v23, v22 quad_perm:[1,0,3,2] row_mask:0xf bank_mask:0xc
    s_nop 1
    v_mov_b32_dpp v31, v30 quad_perm:[0,0,2,2] row_mask:0xf bank_mask:0xf
    v_cvt_pk_bf16_f32 v31, 0, v31
    v_mul_f32 v31, 0x3d93cd3a, v31
    v_cvt_pk_bf16_f32 v31, v31, v31
    ds_write_b16 v33, v31 offset:64
    v_and_b32 v30, 0xffff0000, v31
    v_max_f32 v35, v35, v30
    s_waitcnt vmcnt(3)
    buffer_load_dwordx4 v[40:43], v1, s[4:7], s50 offen offset:0 sc1
    buffer_load_dwordx4 v[44:47], v1, s[4:7], s50 offen offset:128 sc1
    buffer_load_dwordx4 v[48:51], v1, s[4:7], s50 offen offset:256 nt
    s_add_u32 s50, s50, 24576
    v_mfma_f32_16x16x32_bf16 v[20:23], v[52:55], a[20:23], 0
    v_mfma_f32_16x16x32_bf16 v[20:23], v[56:59], a[36:39], v[20:23]
    v_mfma_f32_16x16x32_bf16 v[20:23], v[60:63], a[40:43], v[20:23]
    s_nop 7
    v_add_f32_dpp v30, v21, v20 quad_perm:[1,0,3,2] row_mask:0xf bank_mask:0x3
    s_nop 1
    v_add_f32_dpp v30, v23, v22 quad_perm:[1,0,3,2] row_mask:0xf bank_mask:0xc
    s_nop 1
    v_mov_b32_dpp v31, v30 quad_perm:[0,0,2,2] row_mask:0xf bank_mask:0xf
    v_cvt_pk_bf16_f32 v31, 0, v31
    v_mul_f32 v31, 0x3d93cd3a, v31
    v_cvt_pk_bf16_f32 v31, v31, v31
    ds_write_b16 v33, v31 offset:80
    v_and_b32 v30, 0xffff0000, v31
    v_max_f32 v35, v35, v30
    v_add_u32 v33, 96, v33
    s_sub_u32 s1, s1, 1
    s_cmp_lg_u32 s1, 0
    s_cbranch_scc1 L_kloop_60
    s_waitcnt vmcnt(3)
    buffer_load_dwordx4 v[52:55], v1, s[4:7], s50 offen offset:0 sc1
    buffer_load_dwordx4 v[56:59], v1, s[4:7], s50 offen offset:128 nt
    buffer_load_dwordx4 v[60:63], v1, s[4:7], s50 offen offset:256 nt
    s_sub_u32 s50, 128, s49
    s_lshr_b32 s61, s2, 2
    s_xor_b32 s61, s61, s2
    s_bfe_u32 s61, s61, 0x10002
    s_mul_i32 s50, s50, s61
    s_bfe_u32 s61, s2, 0x10003
    s_lshl1_add_u32 s50, s50, s61
    s_lshl2_add_u32 s50, s50, s46
    s_mul_i32 s50, s50, 3072
    s_add_u32 s50, s50, s47
    s_mov_b32 s51, 24576
    v_mfma_f32_16x16x32_bf16 v[20:23], v[64:67], a[20:23], 0
    v_mfma_f32_16x16x32_bf16 v[20:23], v[68:71], a[36:39], v[20:23]
    v_mfma_f32_16x16x32_bf16 v[20:23], v[72:75], a[40:43], v[20:23]
    s_nop 7
    v_add_f32_dpp v30, v21, v20 quad_perm:[1,0,3,2] row_mask:0xf bank_mask:0x3
    s_nop 1
    v_add_f32_dpp v30, v23, v22 quad_perm:[1,0,3,2] row_mask:0xf bank_mask:0xc
    s_nop 1
    v_mov_b32_dpp v31, v30 quad_perm:[0,0,2,2] row_mask:0xf bank_mask:0xf
    v_cvt_pk_bf16_f32 v31, 0, v31
    v_mul_f32 v31, 0x3d93cd3a, v31
    v_cvt_pk_bf16_f32 v31, v31, v31
    ds_write_b16 v33, v31 offset:0
    v_and_b32 v30, 0xffff0000, v31
    v_max_f32 v35, v35, v30
    s_waitcnt vmcnt(3)
    buffer_load_dwordx4 v[64:67], v2, s[8:11], s50 offen offset:0 sc1
    buffer_load_dwordx4 v[68:71], v2, s[8:11], s50 offen offset:128 nt
    buffer_load_dwordx4 v[72:75], v2, s[8:11], s50 offen offset:256 nt
    s_add_u32 s50, s50, 24576
    v_mfma_f32_16x16x32_bf16 v[20:23], v[40:43], a[20:23], 0
    v_mfma_f32_16x16x32_bf16 v[20:23], v[44:47], a[36:39], v[20:23]
    v_mfma_f32_16x16x32_bf16 v[20:23], v[48:51], a[40:43], v[20:23]
    s_nop 7
    v_add_f32_dpp v30, v21, v20 quad_perm:[1,0,3,2] row_mask:0xf bank_mask:0x3
    s_nop 1
    v_add_f32_dpp v30, v23, v22 quad_perm:[1,0,3,2] row_mask:0xf bank_mask:0xc
    s_nop 1
    v_mov_b32_dpp v31, v30 quad_perm:[0,0,2,2] row_mask:0xf bank_mask:0xf
    v_cvt_pk_bf16_f32 v31, 0, v31
    v_mul_f32 v31, 0x3d93cd3a, v31
    v_cvt_pk_bf16_f32 v31, v31, v31
    ds_write_b16 v33, v31 offset:16
    v_and_b32 v30, 0xffff0000, v31
    v_max_f32 v35, v35, v30
    s_waitcnt vmcnt(3)
    buffer_load_dwordx4 v[40:43], v2, s[8:11], s50 offen offset:0 sc1
    buffer_load_dwordx4 v[44:47], v2, s[8:11], s50 offen offset:128 nt
    buffer_load_dwordx4 v[48:51], v2, s[8:11], s50 offen offset:256 nt
    s_add_u32 s50, s50, 24576
    v_mfma_f32_16x16x32_bf16 v[20:23], v[52:55], a[20:23], 0
    v_mfma_f32_16x16x32_bf16 v[20:23], v[56:59], a[36:39], v[20:23]
    v_mfma_f32_16x16x32_bf16 v[20:23], v[60:63], a[40:43], v[20:23]
    s_nop 7
    v_add_f32_dpp v30, v21, v20 quad_perm:[1,0,3,2] row_mask:0xf bank_mask:0x3
    s_nop 1
    v_add_f32_dpp v30, v23, v22 quad_perm:[1,0,3,2] row_mask:0xf bank_mask:0xc
    s_nop 1
    v_mov_b32_dpp v31, v30 quad_perm:[0,0,2,2] row_mask:0xf bank_mask:0xf
    v_cvt_pk_bf16_f32 v31, 0, v31
    v_mul_f32 v31, 0x3d93cd3a, v31
    v_cvt_pk_bf16_f32 v31, v31, v31
    ds_write_b16 v33, v31 offset:32
    v_and_b32 v30, 0xffff0000, v31
    v_max_f32 v35, v35, v30
    v_mov_b32 v8, 0
    v_mov_b32 v9, 0
    v_mov_b32 v10, 0
    v_mov_b32 v11, 0
    v_mov_b32 v12, 0
    v_mov_b32 v13, 0
    v_mov_b32 v14, 0
    v_mov_b32 v15, 0
    v_mov_b32 v16, 0
    v_mov_b32 v17, 0
    v_mov_b32 v18, 0
    v_mov_b32 v19, 0
    v_mov_b32 v29, 0
    v_mov_b32 v28, 0x7f800000
    s_mov_b32 s52, 0xff800000
    s_nop 1
    v_max_f32_dpp v28, v35, v35 row_ror:8 row_mask:0xf bank_mask:0xf
    s_nop 1
    v_max_f32_dpp v28, v28, v28 row_bcast:15 row_mask:0xa bank_mask:0xf
    s_nop 1
    v_max_f32_dpp v28, v28, v28 row_bcast:31 row_mask:0xc bank_mask:0xf
    s_nop 1
    v_readlane_b32 s52, v28, 63
    s_nop 1
    v_mov_b32 v28, s52
    v_mul_f32 v28, 0xbfb8aa3b, v28
    s_mul_i32 s60, s46, 1536
    s_add_u32 s60, s60, 153600
    v_lshrrev_b32 v33, 3, v0
    v_lshl_add_u32 v33, v33, 1, s60
    s_mov_b32 s1, 9
    .p2align 6
L_vloop_61:
    ds_read_u16_d16_hi v34, v33 offset:0
    s_waitcnt lgkmcnt(0)
    v_fmamk_f32 v31, v34, 0x3fb8aa3b, v28
    v_exp_f32 v31, v31
    s_nop 0
    v_add_f32 v29, v29, v31
    v_cvt_pk_bf16_f32 v31, v31, v31
    v_and_b32 v24, v4, v31
    v_and_b32 v25, v5, v31
    v_and_b32 v26, v6, v31
    v_and_b32 v27, v7, v31
    s_waitcnt vmcnt(3)
    buffer_load_dwordx4 v[52:55], v2, s[8:11], s50 offen offset:0 sc1
    buffer_load_dwordx4 v[56:59], v2, s[8:11], s50 offen offset:128 sc1
    buffer_load_dwordx4 v[60:63], v2, s[8:11], s50 offen offset:256 nt
    s_add_u32 s50, s50, 24576
    v_mfma_f32_16x16x32_bf16 v[8:11], v[24:27], v[64:67], v[8:11]
    v_mfma_f32_16x16x32_bf16 v[12:15], v[24:27], v[68:71], v[12:15]
    v_mfma_f32_16x16x32_bf16 v[16:19], v[24:27], v[72:75], v[16:19]
    ds_read_u16_d16_hi v34, v33 offset:16
    s_waitcnt lgkmcnt(0)
    v_fmamk_f32 v31, v34, 0x3fb8aa3b, v28
    v_exp_f32 v31, v31
    s_nop 0
    v_add_f32 v29, v29, v31
    v_cvt_pk_bf16_f32 v31, v31, v31
    v_and_b32 v24, v4, v31
    v_and_b32 v25, v5, v31
    v_and_b32 v26, v6, v31
    v_and_b32 v27, v7, v31
    s_waitcnt vmcnt(3)
    buffer_load_dwordx4 v[64:67], v2, s[8:11], s50 offen offset:0 sc1
    buffer_load_dwordx4 v[68:71], v2, s[8:11], s50 offen offset:128 nt
    buffer_load_dwordx4 v[72:75], v2, s[8:11], s50 offen offset:256 nt
    s_add_u32 s50, s50, 24576
    v_mfma_f32_16x16x32_bf16 v[8:11], v[24:27], v[40:43], v[8:11]
    v_mfma_f32_16x16x32_bf16 v[12:15], v[24:27], v[44:47], v[12:15]
    v_mfma_f32_16x16x32_bf16 v[16:19], v[24:27], v[48:51], v[16:19]
    ds_read_u16_d16_hi v34, v33 offset:32
    s_waitcnt lgkmcnt(0)
    v_fmamk_f32 v31, v34, 0x3fb8aa3b, v28
    v_exp_f32 v31, v31
    s_nop 0
    v_add_f32 v29, v29, v31
    v_cvt_pk_bf16_f32 v31, v31, v31
    v_and_b32 v24, v4, v31
    v_and_b32 v25, v5, v31
    v_and_b32 v26, v6, v31
    v_and_b32 v27, v7, v31
    s_waitcnt vmcnt(3)
    buffer_load_dwordx4 v[40:43], v2, s[8:11], s50 offen offset:0 sc1
    buffer_load_dwordx4 v[44:47], v2, s[8:11], s50 offen offset:128 nt
    buffer_load_dwordx4 v[48:51], v2, s[8:11], s50 offen offset:256 nt
    s_add_u32 s50, s50, 24576
    v_mfma_f32_16x16x32_bf16 v[8:11], v[24:27], v[52:55], v[8:11]
    v_mfma_f32_16x16x32_bf16 v[12:15], v[24:27], v[56:59], v[12:15]
    v_mfma_f32_16x16x32_bf16 v[16:19], v[24:27], v[60:63], v[16:19]
    ds_read_u16_d16_hi v34, v33 offset:48
    s_waitcnt lgkmcnt(0)
    v_fmamk_f32 v31, v34, 0x3fb8aa3b, v28
    v_exp_f32 v31, v31
    s_nop 0
    v_add_f32 v29, v29, v31
    v_cvt_pk_bf16_f32 v31, v31, v31
    v_and_b32 v24, v4, v31
    v_and_b32 v25, v5, v31
    v_and_b32 v26, v6, v31
    v_and_b32 v27, v7, v31
    s_waitcnt vmcnt(3)
    buffer_load_dwordx4 v[52:55], v2, s[8:11], s50 offen offset:0 sc1
    buffer_load_dwordx4 v[56:59], v2, s[8:11], s50 offen offset:128 nt
    buffer_load_dwordx4 v[60:63], v2, s[8:11], s50 offen offset:256 nt
    s_add_u32 s50, s50, 24576
    v_mfma_f32_16x16x32_bf16 v[8:11], v[24:27], v[64:67], v[8:11]
    v_mfma_f32_16x16x32_bf16 v[12:15], v[24:27], v[68:71], v[12:15]
    v_mfma_f32_16x16x32_bf16 v[16:19], v[24:27], v[72:75], v[16:19]
    ds_read_u16_d16_hi v34, v33 offset:64
    s_waitcnt lgkmcnt(0)
    v_fmamk_f32 v31, v34, 0x3fb8aa3b, v28
    v_exp_f32 v31, v31
    s_nop 0
    v_add_f32 v29, v29, v31
    v_cvt_pk_bf16_f32 v31, v31, v31
    v_and_b32 v24, v4, v31
    v_and_b32 v25, v5, v31
    v_and_b32 v26, v6, v31
    v_and_b32 v27, v7, v31
    s_waitcnt vmcnt(3)
    buffer_load_dwordx4 v[64:67], v2, s[8:11], s50 offen offset:0 sc1
    buffer_load_dwordx4 v[68:71], v2, s[8:11], s50 offen offset:128 nt
    buffer_load_dwordx4 v[72:75], v2, s[8:11], s50 offen offset:256 nt
    s_add_u32 s50, s50, 24576
    v_mfma_f32_16x16x32_bf16 v[8:11], v[24:27], v[40:43], v[8:11]
    v_mfma_f32_16x16x32_bf16 v[12:15], v[24:27], v[44:47], v[12:15]
    v_mfma_f32_16x16x32_bf16 v[16:19], v[24:27], v[48:51], v[16:19]
    ds_read_u16_d16_hi v34, v33 offset:80
    s_waitcnt lgkmcnt(0)
    v_fmamk_f32 v31, v34, 0x3fb8aa3b, v28
    v_exp_f32 v31, v31
    s_nop 0
    v_add_f32 v29, v29, v31
    v_cvt_pk_bf16_f32 v31, v31, v31
    v_and_b32 v24, v4, v31
    v_and_b32 v25, v5, v31
    v_and_b32 v26, v6, v31
    v_and_b32 v27, v7, v31
    s_waitcnt vmcnt(3)
    buffer_load_dwordx4 v[40:43], v2, s[8:11], s50 offen offset:0 sc1
    buffer_load_dwordx4 v[44:47], v2, s[8:11], s50 offen offset:128 sc1
    buffer_load_dwordx4 v[48:51], v2, s[8:11], s50 offen offset:256 nt
    s_add_u32 s50, s50, 24576
    v_mfma_f32_16x16x32_bf16 v[8:11], v[24:27], v[52:55], v[8:11]
    v_mfma_f32_16x16x32_bf16 v[12:15], v[24:27], v[56:59], v[12:15]
    v_mfma_f32_16x16x32_bf16 v[16:19], v[24:27], v[60:63], v[16:19]
    ds_read_u16_d16_hi v34, v33 offset:96
    s_waitcnt lgkmcnt(0)
    v_fmamk_f32 v31, v34, 0x3fb8aa3b, v28
    v_exp_f32 v31, v31
    s_nop 0
    v_add_f32 v29, v29, v31
    v_cvt_pk_bf16_f32 v31, v31, v31
    v_and_b32 v24, v4, v31
    v_and_b32 v25, v5, v31
    v_and_b32 v26, v6, v31
    v_and_b32 v27, v7, v31
    s_waitcnt vmcnt(3)
    buffer_load_dwordx4 v[52:55], v2, s[8:11], s50 offen offset:0 sc1
    buffer_load_dwordx4 v[56:59], v2, s[8:11], s50 offen offset:128 nt
    buffer_load_dwordx4 v[60:63], v2, s[8:11], s50 offen offset:256 nt
    s_add_u32 s50, s50, 24576
    v_mfma_f32_16x16x32_bf16 v[8:11], v[24:27], v[64:67], v[8:11]
    v_mfma_f32_16x16x32_bf16 v[12:15], v[24:27], v[68:71], v[12:15]
    v_mfma_f32_16x16x32_bf16 v[16:19], v[24:27], v[72:75], v[16:19]
    ds_read_u16_d16_hi v34, v33 offset:112
    s_waitcnt lgkmcnt(0)
    v_fmamk_f32 v31, v34, 0x3fb8aa3b, v28
    v_exp_f32 v31, v31
    s_nop 0
    v_add_f32 v29, v29, v31
    v_cvt_pk_bf16_f32 v31, v31, v31
    v_and_b32 v24, v4, v31
    v_and_b32 v25, v5, v31
    v_and_b32 v26, v6, v31
    v_and_b32 v27, v7, v31
    s_waitcnt vmcnt(3)
    buffer_load_dwordx4 v[64:67], v2, s[8:11], s50 offen offset:0 sc1
    buffer_load_dwordx4 v[68:71], v2, s[8:11], s50 offen offset:128 nt
    buffer_load_dwordx4 v[72:75], v2, s[8:11], s50 offen offset:256 nt
    s_add_u32 s50, s50, 24576
    v_mfma_f32_16x16x32_bf16 v[8:11], v[24:27], v[40:43], v[8:11]
    v_mfma_f32_16x16x32_bf16 v[12:15], v[24:27], v[44:47], v[12:15]
    v_mfma_f32_16x16x32_bf16 v[16:19], v[24:27], v[48:51], v[16:19]
    ds_read_u16_d16_hi v34, v33 offset:128
    s_waitcnt lgkmcnt(0)
    v_fmamk_f32 v31, v34, 0x3fb8aa3b, v28
    v_exp_f32 v31, v31
    s_nop 0
    v_add_f32 v29, v29, v31
    v_cvt_pk_bf16_f32 v31, v31, v31
    v_and_b32 v24, v4, v31
    v_and_b32 v25, v5, v31
    v_and_b32 v26, v6, v31
    v_and_b32 v27, v7, v31
    s_waitcnt vmcnt(3)
    buffer_load_dwordx4 v[40:43], v2, s[8:11], s50 offen offset:0 sc1
    buffer_load_dwordx4 v[44:47], v2, s[8:11], s50 offen offset:128 nt
    buffer_load_dwordx4 v[48:51], v2, s[8:11], s50 offen offset:256 nt
    s_add_u32 s50, s50, 24576
    v_mfma_f32_16x16x32_bf16 v[8:11], v[24:27], v[52:55], v[8:11]
    v_mfma_f32_16x16x32_bf16 v[12:15], v[24:27], v[56:59], v[12:15]
    v_mfma_f32_16x16x32_bf16 v[16:19], v[24:27], v[60:63], v[16:19]
    v_add_u32 v33, 144, v33
    s_sub_u32 s1, s1, 1
    s_cmp_lg_u32 s1, 0
    s_cbranch_scc1 L_vloop_61
    ds_read_u16_d16_hi v34, v33 offset:0
    s_call_b64 s[66:67], L_prob
    s_waitcnt vmcnt(3)
    buffer_load_dwordx4 v[52:55], v2, s[8:11], s50 offen offset:0 nt
    buffer_load_dwordx4 v[56:59], v2, s[8:11], s50 offen offset:128 nt
    buffer_load_dwordx4 v[60:63], v2, s[8:11], s50 offen offset:256 nt
    s_add_u32 s50, s50, 24576
    v_mfma_f32_16x16x32_bf16 v[8:11], v[24:27], v[64:67], v[8:11]
    v_mfma_f32_16x16x32_bf16 v[12:15], v[24:27], v[68:71], v[12:15]
    v_mfma_f32_16x16x32_bf16 v[16:19], v[24:27], v[72:75], v[16:19]
    ds_read_u16_d16_hi v34, v33 offset:16
    s_call_b64 s[66:67], L_prob
    s_waitcnt vmcnt(3)
    buffer_load_dwordx4 v[64:67], v2, s[8:11], s50 offen offset:0 nt
    buffer_load_dwordx4 v[68:71], v2, s[8:11], s50 offen offset:128 nt
    buffer_load_dwordx4 v[72:75], v2, s[8:11], s50 offen offset:256 nt
    s_add_u32 s50, s50, 24576
    s_add_u32 s60, s53, s0
    s_cmp_eq_u32 s49, 43
    s_cselect_b32 s50, s60, s50
    v_mfma_f32_16x16x32_bf16 v[8:11], v[24:27], v[40:43], v[8:11]
    v_mfma_f32_16x16x32_bf16 v[12:15], v[24:27], v[44:47], v[12:15]
    v_mfma_f32_16x16x32_bf16 v[16:19], v[24:27], v[48:51], v[16:19]
    ds_read_u16_d16_hi v34, v33 offset:32
    s_call_b64 s[66:67], L_prob
    s_waitcnt vmcnt(3)
    buffer_load_dwordx4 v[40:43], v2, s[8:11], s50 offen offset:0 sc1
    buffer_load_dwordx4 v[44:47], v2, s[8:11], s50 offen offset:128 sc1
    buffer_load_dwordx4 v[48:51], v2, s[8:11], s50 offen offset:256 sc1
    s_add_u32 s50, s58, 2015232
    s_cmp_ge_u32 s50, s53
    s_cselect_b32 s62, 2064384, 0
    s_sub_u32 s50, s50, s62
    v_mfma_f32_16x16x32_bf16 v[8:11], v[24:27], v[52:55], v[8:11]
    v_mfma_f32_16x16x32_bf16 v[12:15], v[24:27], v[56:59], v[12:15]
    v_mfma_f32_16x16x32_bf16 v[16:19], v[24:27], v[60:63], v[16:19]
    ds_read_u16_d16_hi v34, v33 offset:48
    s_call_b64 s[66:67], L_prob
    s_waitcnt vmcnt(3)
    buffer_load_dwordx4 v[52:55], v2, s[8:11], s50 offen offset:0 sc1
    buffer_load_dwordx4 v[56:59], v2, s[8:11], s50 offen offset:128 sc1
    buffer_load_dwordx4 v[60:63], v2, s[8:11], s50 offen offset:256 sc1
    s_add_u32 s50, s48, 1966080
    s_cmp_ge_u32 s50, s53
    s_cselect_b32 s62, 2064384, 0
    s_sub_u32 s50, s50, s62
    v_mfma_f32_16x16x32_bf16 v[8:11], v[24:27], v[64:67], v[8:11]
    v_mfma_f32_16x16x32_bf16 v[12:15], v[24:27], v[68:71], v[12:15]
    v_mfma_f32_16x16x32_bf16 v[16:19], v[24:27], v[72:75], v[16:19]
    s_cmp_eq_u32 s49, 43
    s_cbranch_scc1 L_p1b42
    ds_read_u16_d16_hi v34, v33 offset:64
    s_call_b64 s[66:67], L_prob
    s_waitcnt vmcnt(3)
    buffer_load_dwordx4 v[64:67], v2, s[8:11], s50 offen offset:0 sc1
    buffer_load_dwordx4 v[68:71], v2, s[8:11], s50 offen offset:128 sc1
    buffer_load_dwordx4 v[72:75], v2, s[8:11], s50 offen offset:256 sc1
    v_mfma_f32_16x16x32_bf16 v[8:11], v[24:27], v[40:43], v[8:11]
    v_mfma_f32_16x16x32_bf16 v[12:15], v[24:27], v[44:47], v[12:15]
    v_mfma_f32_16x16x32_bf16 v[16:19], v[24:27], v[48:51], v[16:19]
    s_call_b64 s[66:67], L_switch
    s_branch L_p1b41
L_p1b42:
    s_call_b64 s[66:67], L_switch
    ds_read_u16_d16_hi v34, v33 offset:672
    s_call_b64 s[66:67], L_prob
    s_waitcnt vmcnt(3)
    buffer_load_dwordx4 v[64:67], v2, s[8:11], s50 offen offset:0 sc1
    buffer_load_dwordx4 v[68:71], v2, s[8:11], s50 offen offset:128 sc1
    buffer_load_dwordx4 v[72:75], v2, s[8:11], s50 offen offset:256 sc1
    v_mfma_f32_16x16x32_bf16 v[8:11], v[24:27], v[40:43], v[8:11]
    v_mfma_f32_16x16x32_bf16 v[12:15], v[24:27], v[44:47], v[12:15]
    v_mfma_f32_16x16x32_bf16 v[16:19], v[24:27], v[48:51], v[16:19]
L_p1b41:
    s_add_u32 s50, s58, 1916928
    s_cmp_ge_u32 s50, s53
    s_cselect_b32 s62, 2064384, 0
    s_sub_u32 s50, s50, s62
    ds_read_u16_d16_hi v34, v33 offset:656
    s_call_b64 s[66:67], L_prob
    s_waitcnt vmcnt(3)
    buffer_load_dwordx4 v[40:43], v2, s[8:11], s50 offen offset:0 sc1
    buffer_load_dwordx4 v[44:47], v2, s[8:11], s50 offen offset:128 sc1
    buffer_load_dwordx4 v[48:51], v2, s[8:11], s50 offen offset:256 sc1
    v_mfma_f32_16x16x32_bf16 v[8:11], v[24:27], v[52:55], v[8:11]
    v_mfma_f32_16x16x32_bf16 v[12:15], v[24:27], v[56:59], v[12:15]
    v_mfma_f32_16x16x32_bf16 v[16:19], v[24:27], v[60:63], v[16:19]
    s_add_u32 s50, s48, 1867776
    s_cmp_ge_u32 s50, s53
    s_cselect_b32 s62, 2064384, 0
    s_sub_u32 s50, s50, s62
    ds_read_u16_d16_hi v34, v33 offset:640
    s_call_b64 s[66:67], L_prob
    s_waitcnt vmcnt(3)
    buffer_load_dwordx4 v[52:55], v2, s[8:11], s50 offen offset:0 sc1
    buffer_load_dwordx4 v[56:59], v2, s[8:11], s50 offen offset:128 sc1
    buffer_load_dwordx4 v[60:63], v2, s[8:11], s50 offen offset:256 sc1
    v_mfma_f32_16x16x32_bf16 v[8:11], v[24:27], v[64:67], v[8:11]
    v_mfma_f32_16x16x32_bf16 v[12:15], v[24:27], v[68:71], v[12:15]
    v_mfma_f32_16x16x32_bf16 v[16:19], v[24:27], v[72:75], v[16:19]
    s_add_u32 s50, s58, 1818624
    s_cmp_ge_u32 s50, s53
    s_cselect_b32 s62, 2064384, 0
    s_sub_u32 s50, s50, s62
    ds_read_u16_d16_hi v34, v33 offset:624
    s_call_b64 s[66:67], L_prob
    s_waitcnt vmcnt(3)
    buffer_load_dwordx4 v[64:67], v2, s[8:11], s50 offen offset:0 sc1
    buffer_load_dwordx4 v[68:71], v2, s[8:11], s50 offen offset:128 sc1
    buffer_load_dwordx4 v[72:75], v2, s[8:11], s50 offen offset:256 sc1
    v_mfma_f32_16x16x32_bf16 v[8:11], v[24:27], v[40:43], v[8:11]
    v_mfma_f32_16x16x32_bf16 v[12:15], v[24:27], v[44:47], v[12:15]
    v_mfma_f32_16x16x32_bf16 v[16:19], v[24:27], v[48:51], v[16:19]
    v_and_b32 v76, 3, v0
    v_lshlrev_b32 v76, 6, v76
    buffer_load_dword v35, v76, s[40:43], 0 offen offset:4 sc1
    s_add_u32 s50, s48, 1769472
    s_cmp_ge_u32 s50, s53
    s_cselect_b32 s62, 2064384, 0
    s_sub_u32 s50, s50, s62
    ds_read_u16_d16_hi v34, v33 offset:608
    s_call_b64 s[66:67], L_prob
    s_waitcnt vmcnt(4)
    buffer_load_dwordx4 v[40:43], v2, s[8:11], s50 offen offset:0 sc1
    buffer_load_dwordx4 v[44:47], v2, s[8:11], s50 offen offset:128 sc1
    buffer_load_dwordx4 v[48:51], v2, s[8:11], s50 offen offset:256 sc1
    v_mfma_f32_16x16x32_bf16 v[8:11], v[24:27], v[52:55], v[8:11]
    v_mfma_f32_16x16x32_bf16 v[12:15], v[24:27], v[56:59], v[12:15]
    v_mfma_f32_16x16x32_bf16 v[16:19], v[24:27], v[60:63], v[16:19]
    s_add_u32 s50, s58, 1720320
    s_cmp_ge_u32 s50, s53
    s_cselect_b32 s62, 2064384, 0
    s_sub_u32 s50, s50, s62
    ds_read_u16_d16_hi v34, v33 offset:592
    s_call_b64 s[66:67], L_prob
    s_waitcnt vmcnt(4)
    buffer_load_dwordx4 v[52:55], v2, s[8:11], s50 offen offset:0 nt
    buffer_load_dwordx4 v[56:59], v2, s[8:11], s50 offen offset:128 nt
    buffer_load_dwordx4 v[60:63], v2, s[8:11], s50 offen offset:256 nt
    v_mfma_f32_16x16x32_bf16 v[8:11], v[24:27], v[64:67], v[8:11]
    v_mfma_f32_16x16x32_bf16 v[12:15], v[24:27], v[68:71], v[12:15]
    v_mfma_f32_16x16x32_bf16 v[16:19], v[24:27], v[72:75], v[16:19]
    s_add_u32 s50, s48, 1671168
    s_cmp_ge_u32 s50, s53
    s_cselect_b32 s62, 2064384, 0
    s_sub_u32 s50, s50, s62
    ds_read_u16_d16_hi v34, v33 offset:576
    s_call_b64 s[66:67], L_prob
    s_waitcnt vmcnt(3)
    buffer_load_dwordx4 v[64:67], v2, s[8:11], s50 offen offset:0 nt
    buffer_load_dwordx4 v[68:71], v2, s[8:11], s50 offen offset:128 nt
    buffer_load_dwordx4 v[72:75], v2, s[8:11], s50 offen offset:256 nt
    v_mfma_f32_16x16x32_bf16 v[8:11], v[24:27], v[40:43], v[8:11]
    v_mfma_f32_16x16x32_bf16 v[12:15], v[24:27], v[44:47], v[12:15]
    v_mfma_f32_16x16x32_bf16 v[16:19], v[24:27], v[48:51], v[16:19]
    s_mov_b32 s59, 400000
    s_branch L_decc_63
L_dec_62:
    buffer_load_dword v35, v76, s[40:43], 0 offen offset:4 sc1
    s_waitcnt vmcnt(0)
L_decc_63:
    v_and_b32 v77, 64, v35
    v_cmp_eq_u32 vcc, 0, v77
    s_cbranch_vccz L_decd_64
    s_sub_u32 s59, s59, 1
    s_cbranch_scc0 L_dec_62
L_decd_64:
    v_add_u32 v77, 0x5f5f5ec0, v35
    v_cmp_gt_i32 vcc, 0, v77
    v_readlane_b32 s98, v77, s45
    s_and_b32 s60, vcc_lo, 0xff
    s_xor_b32 s60, s60, 0xf0
    s_or_b32 s98, s98, s60
    s_add_u32 s50, s58, 1622016
    s_cmp_ge_u32 s50, s53
    s_cselect_b32 s62, 2064384, 0
    s_sub_u32 s50, s50, s62
    buffer_load_dwordx4 v[40:43], v2, s[8:11], s50 offen offset:0 nt
    buffer_load_dwordx4 v[44:47], v2, s[8:11], s50 offen offset:128 nt
    buffer_load_dwordx4 v[48:51], v2, s[8:11], s50 offen offset:256 nt
    ds_read_u16_d16_hi v34, v33 offset:560
    s_call_b64 s[66:67], L_prob
    s_waitcnt vmcnt(6)
    v_mfma_f32_16x16x32_bf16 v[8:11], v[24:27], v[52:55], v[8:11]
    v_mfma_f32_16x16x32_bf16 v[12:15], v[24:27], v[56:59], v[12:15]
    v_mfma_f32_16x16x32_bf16 v[16:19], v[24:27], v[60:63], v[16:19]
    v_and_b32 v76, 0x7fff7fff, v52
    v_and_b32 v77, 0x7fff7fff, v53
    v_and_b32 v78, 0x7fff7fff, v54
    v_and_b32 v79, 0x7fff7fff, v55
    v_and_b32 v36, 0x7fff7fff, v56
    v_and_b32 v37, 0x7fff7fff, v57
    v_and_b32 v38, 0x7fff7fff, v58
    v_and_b32 v39, 0x7fff7fff, v59
    v_and_b32 v24, 0x7fff7fff, v60
    v_and_b32 v25, 0x7fff7fff, v61
    v_and_b32 v26, 0x7fff7fff, v62
    v_and_b32 v27, 0x7fff7fff, v63
    v_pk_max_u16 v76, v76, v38
    v_pk_max_u16 v77, v77, v39
    v_pk_max_u16 v78, v78, v24
    v_pk_max_u16 v79, v79, v25
    v_pk_max_u16 v36, v36, v26
    v_pk_max_u16 v37, v37, v27
    v_pk_max_u16 v76, v76, v79
    v_pk_max_u16 v77, v77, v36
    v_pk_max_u16 v78, v78, v37
    v_pk_max_u16 v76, v76, v77
    v_pk_max_u16 v76, v76, v78
    v_lshlrev_b32 v77, 16, v76
    v_max_u32 v76, v76, v77
    s_nop 1
    v_max_u32_dpp v76, v76, v76 quad_perm:[1,0,3,2] row_mask:0xf bank_mask:0xf
    s_nop 1
    v_max_u32_dpp v76, v76, v76 quad_perm:[2,3,0,1] row_mask:0xf bank_mask:0xf
    s_nop 1
    v_max_u32_dpp v76, v76, v76 row_half_mirror row_mask:0xf bank_mask:0xf
    s_nop 1
    v_max_u32_dpp v76, v76, v76 row_mirror row_mask:0xf bank_mask:0xf
    s_nop 1
    v_max_u32_dpp v76, v76, v76 row_bcast:15 row_mask:0xa bank_mask:0xf
    s_nop 1
    v_max_u32_dpp v76, v76, v76 row_bcast:31 row_mask:0xc bank_mask:0xf
    s_nop 1
    v_readlane_b32 s99, v76, 63
    s_nop 1
    s_lshr_b32 s99, s99, 16
    s_max_u32 s99, s99, 1967
    s_sub_u32 s99, s99, 1967
    s_mul_i32 s99, s99, 0x10001
    s_call_b64 s[66:67], L_pack1
    v_mov_b32 v247, v76
    v_mov_b32 v248, v77
    v_mov_b32 v249, v79
    v_mov_b32 v250, v36
    v_mov_b32 v251, v37
    v_mov_b32 v252, v39
    v_mov_b32 v253, v24
    v_mov_b32 v254, v25
    v_mov_b32 v255, v27
    s_movk_i32 s59, 62
    s_cbranch_vccz L_clean_65
    s_call_b64 s[66:67], L_pexc1
L_clean_65:
    s_add_u32 s50, s48, 1572864
    s_cmp_ge_u32 s50, s53
    s_cselect_b32 s62, 2064384, 0
    s_sub_u32 s50, s50, s62
    buffer_load_dwordx4 v[52:55], v2, s[8:11], s50 offen offset:0 nt
    buffer_load_dwordx4 v[56:59], v2, s[8:11], s50 offen offset:128 nt
    buffer_load_dwordx4 v[60:63], v2, s[8:11], s50 offen offset:256 nt
    ds_read_u16_d16_hi v34, v33 offset:544
    s_call_b64 s[66:67], L_prob
    s_waitcnt vmcnt(6)
    v_mfma_f32_16x16x32_bf16 v[8:11], v[24:27], v[64:67], v[8:11]
    v_mfma_f32_16x16x32_bf16 v[12:15], v[24:27], v[68:71], v[12:15]
    v_mfma_f32_16x16x32_bf16 v[16:19], v[24:27], v[72:75], v[16:19]
    s_call_b64 s[66:67], L_pack2
    v_mov_b32 v229, v76
    v_mov_b32 v230, v77
    v_mov_b32 v231, v79
    v_mov_b32 v232, v36
    v_mov_b32 v233, v37
    v_mov_b32 v234, v39
    v_mov_b32 v235, v24
    v_mov_b32 v236, v25
    v_mov_b32 v237, v27
    s_movk_i32 s59, 61
    s_cbranch_vccz L_clean_66
    s_call_b64 s[66:67], L_pexc2
L_clean_66:
    s_add_u32 s50, s58, 1523712
    s_cmp_ge_u32 s50, s53
    s_cselect_b32 s62, 2064384, 0
    s_sub_u32 s50, s50, s62
    buffer_load_dwordx4 v[64:67], v2, s[8:11], s50 offen offset:0 nt
    buffer_load_dwordx4 v[68:71], v2, s[8:11], s50 offen offset:128 nt
    buffer_load_dwordx4 v[72:75], v2, s[8:11], s50 offen offset:256 nt
    ds_read_u16_d16_hi v34, v33 offset:528
    s_call_b64 s[66:67], L_prob
    s_waitcnt vmcnt(6)
    v_mfma_f32_16x16x32_bf16 v[8:11], v[24:27], v[40:43], v[8:11]
    v_mfma_f32_16x16x32_bf16 v[12:15], v[24:27], v[44:47], v[12:15]
    v_mfma_f32_16x16x32_bf16 v[16:19], v[24:27], v[48:51], v[16:19]
    s_call_b64 s[66:67], L_pack0
    v_mov_b32 v211, v76
    v_mov_b32 v212, v77
    v_mov_b32 v213, v79
    v_mov_b32 v214, v36
    v_mov_b32 v215, v37
    v_mov_b32 v216, v39
    v_mov_b32 v217, v24
    v_mov_b32 v218, v25
    v_mov_b32 v219, v27
    s_movk_i32 s59, 60
    s_cbranch_vccz L_clean_67
    s_call_b64 s[66:67], L_pexc0
L_clean_67:
    s_add_u32 s50, s48, 1474560
    s_cmp_ge_u32 s50, s53
    s_cselect_b32 s62, 2064384, 0
    s_sub_u32 s50, s50, s62
    buffer_load_dwordx4 v[40:43], v2, s[8:11], s50 offen offset:0 nt
    buffer_load_dwordx4 v[44:47], v2, s[8:11], s50 offen offset:128 nt
    buffer_load_dwordx4 v[48:51], v2, s[8:11], s50 offen offset:256 nt
    ds_read_u16_d16_hi v34, v33 offset:512
    s_call_b64 s[66:67], L_prob
    s_waitcnt vmcnt(6)
    v_mfma_f32_16x16x32_bf16 v[8:11], v[24:27], v[52:55], v[8:11]
    v_mfma_f32_16x16x32_bf16 v[12:15], v[24:27], v[56:59], v[12:15]
    v_mfma_f32_16x16x32_bf16 v[16:19], v[24:27], v[60:63], v[16:19]
    s_call_b64 s[66:67], L_pack1
    v_mov_b32 v193, v76
    v_mov_b32 v194, v77
    v_mov_b32 v195, v79
    v_mov_b32 v196, v36
    v_mov_b32 v197, v37
    v_mov_b32 v198, v39
    v_mov_b32 v199, v24
    v_mov_b32 v200, v25
    v_mov_b32 v201, v27
    s_movk_i32 s59, 59
    s_cbranch_vccz L_clean_68
    s_call_b64 s[66:67], L_pexc1
L_clean_68:
    s_add_u32 s50, s58, 1425408
    s_cmp_ge_u32 s50, s53
    s_cselect_b32 s62, 2064384, 0
    s_sub_u32 s50, s50, s62
    buffer_load_dwordx4 v[52:55], v2, s[8:11], s50 offen offset:0 nt
    buffer_load_dwordx4 v[56:59], v2, s[8:11], s50 offen offset:128 nt
    buffer_load_dwordx4 v[60:63], v2, s[8:11], s50 offen offset:256 nt
    ds_read_u16_d16_hi v34, v33 offset:496
    s_call_b64 s[66:67], L_prob
    s_waitcnt vmcnt(6)
    v_mfma_f32_16x16x32_bf16 v[8:11], v[24:27], v[64:67], v[8:11]
    v_mfma_f32_16x16x32_bf16 v[12:15], v[24:27], v[68:71], v[12:15]
    v_mfma_f32_16x16x32_bf16 v[16:19], v[24:27], v[72:75], v[16:19]
    s_call_b64 s[66:67], L_pack2
    v_mov_b32 v175, v76
    v_mov_b32 v176, v77
    v_mov_b32 v177, v79
    v_mov_b32 v178, v36
    v_mov_b32 v179, v37
    v_mov_b32 v180, v39
    v_mov_b32 v181, v24
    v_mov_b32 v182, v25
    v_mov_b32 v183, v27
    s_movk_i32 s59, 58
    s_cbranch_vccz L_clean_69
    s_call_b64 s[66:67], L_pexc2
L_clean_69:
    s_add_u32 s50, s48, 1376256
    s_cmp_ge_u32 s50, s53
    s_cselect_b32 s62, 2064384, 0
    s_sub_u32 s50, s50, s62
    buffer_load_dwordx4 v[64:67], v2, s[8:11], s50 offen offset:0 nt
    buffer_load_dwordx4 v[68:71], v2, s[8:11], s50 offen offset:128 nt
    buffer_load_dwordx4 v[72:75], v2, s[8:11], s50 offen offset:256 nt
    ds_read_u16_d16_hi v34, v33 offset:480
    s_call_b64 s[66:67], L_prob
    s_waitcnt vmcnt(6)
    v_mfma_f32_16x16x32_bf16 v[8:11], v[24:27], v[40:43], v[8:11]
    v_mfma_f32_16x16x32_bf16 v[12:15], v[24:27], v[44:47], v[12:15]
    v_mfma_f32_16x16x32_bf16 v[16:19], v[24:27], v[48:51], v[16:19]
    s_call_b64 s[66:67], L_pack0
    v_mov_b32 v157, v76
    v_mov_b32 v158, v77
    v_mov_b32 v159, v79
    v_mov_b32 v160, v36
    v_mov_b32 v161, v37
    v_mov_b32 v162, v39
    v_mov_b32 v163, v24
    v_mov_b32 v164, v25
    v_mov_b32 v165, v27
    s_movk_i32 s59, 57
    s_cbranch_vccz L_clean_70
    s_call_b64 s[66:67], L_pexc0
L_clean_70:
    s_add_u32 s50, s58, 1327104
    s_cmp_ge_u32 s50, s53
    s_cselect_b32 s62, 2064384, 0
    s_sub_u32 s50, s50, s62
    buffer_load_dwordx4 v[40:43], v2, s[8:11], s50 offen offset:0 nt
    buffer_load_dwordx4 v[44:47], v2, s[8:11], s50 offen offset:128 nt
    buffer_load_dwordx4 v[48:51], v2, s[8:11], s50 offen offset:256 nt
    ds_read_u16_d16_hi v34, v33 offset:464
    s_call_b64 s[66:67], L_prob
    s_waitcnt vmcnt(6)
    v_mfma_f32_16x16x32_bf16 v[8:11], v[24:27], v[52:55], v[8:11]
    v_mfma_f32_16x16x32_bf16 v[12:15], v[24:27], v[56:59], v[12:15]
    v_mfma_f32_16x16x32_bf16 v[16:19], v[24:27], v[60:63], v[16:19]
    s_call_b64 s[66:67], L_pack1
    v_mov_b32 v139, v76
    v_mov_b32 v140, v77
    v_mov_b32 v141, v79
    v_mov_b32 v142, v36
    v_mov_b32 v143, v37
    v_mov_b32 v144, v39
    v_mov_b32 v145, v24
    v_mov_b32 v146, v25
    v_mov_b32 v147, v27
    s_movk_i32 s59, 56
    s_cbranch_vccz L_clean_71
    s_call_b64 s[66:67], L_pexc1
L_clean_71:
    s_add_u32 s50, s48, 1277952
    s_cmp_ge_u32 s50, s53
    s_cselect_b32 s62, 2064384, 0
    s_sub_u32 s50, s50, s62
    buffer_load_dwordx4 v[52:55], v2, s[8:11], s50 offen offset:0 nt
    buffer_load_dwordx4 v[56:59], v2, s[8:11], s50 offen offset:128 nt
    buffer_load_dwordx4 v[60:63], v2, s[8:11], s50 offen offset:256 nt
    ds_read_u16_d16_hi v34, v33 offset:448
    s_call_b64 s[66:67], L_prob
    s_waitcnt vmcnt(6)
    v_mfma_f32_16x16x32_bf16 v[8:11], v[24:27], v[64:67], v[8:11]
    v_mfma_f32_16x16x32_bf16 v[12:15], v[24:27], v[68:71], v[12:15]
    v_mfma_f32_16x16x32_bf16 v[16:19], v[24:27], v[72:75], v[16:19]
    s_call_b64 s[66:67], L_pack2
    v_mov_b32 v121, v76
    v_mov_b32 v122, v77
    v_mov_b32 v123, v79
    v_mov_b32 v124, v36
    v_mov_b32 v125, v37
    v_mov_b32 v126, v39
    v_mov_b32 v127, v24
    v_mov_b32 v128, v25
    v_mov_b32 v129, v27
    s_movk_i32 s59, 55
    s_cbranch_vccz L_clean_72
    s_call_b64 s[66:67], L_pexc2
L_clean_72:
    s_add_u32 s50, s58, 1228800
    s_cmp_ge_u32 s50, s53
    s_cselect_b32 s62, 2064384, 0
    s_sub_u32 s50, s50, s62
    buffer_load_dwordx4 v[64:67], v2, s[8:11], s50 offen offset:0 nt
    buffer_load_dwordx4 v[68:71], v2, s[8:11], s50 offen offset:128 nt
    buffer_load_dwordx4 v[72:75], v2, s[8:11], s50 offen offset:256 nt
    ds_read_u16_d16_hi v34, v33 offset:432
    s_call_b64 s[66:67], L_prob
    s_waitcnt vmcnt(6)
    v_mfma_f32_16x16x32_bf16 v[8:11], v[24:27], v[40:43], v[8:11]
    v_mfma_f32_16x16x32_bf16 v[12:15], v[24:27], v[44:47], v[12:15]
    v_mfma_f32_16x16x32_bf16 v[16:19], v[24:27], v[48:51], v[16:19]
    s_call_b64 s[66:67], L_pack0
    v_mov_b32 v103, v76
    v_mov_b32 v104, v77
    v_mov_b32 v105, v79
    v_mov_b32 v106, v36
    v_mov_b32 v107, v37
    v_mov_b32 v108, v39
    v_mov_b32 v109, v24
    v_mov_b32 v110, v25
    v_mov_b32 v111, v27
    s_movk_i32 s59, 54
    s_cbranch_vccz L_clean_73
    s_call_b64 s[66:67], L_pexc0
L_clean_73:
    s_add_u32 s50, s48, 1179648
    s_cmp_ge_u32 s50, s53
    s_cselect_b32 s62, 2064384, 0
    s_sub_u32 s50, s50, s62
    buffer_load_dwordx4 v[40:43], v2, s[8:11], s50 offen offset:0 nt
    buffer_load_dwordx4 v[44:47], v2, s[8:11], s50 offen offset:128 nt
    buffer_load_dwordx4 v[48:51], v2, s[8:11], s50 offen offset:256 nt
    ds_read_u16_d16_hi v34, v33 offset:416
    s_call_b64 s[66:67], L_prob
    s_waitcnt vmcnt(6)
    v_mfma_f32_16x16x32_bf16 v[8:11], v[24:27], v[52:55], v[8:11]
    v_mfma_f32_16x16x32_bf16 v[12:15], v[24:27], v[56:59], v[12:15]
    v_mfma_f32_16x16x32_bf16 v[16:19], v[24:27], v[60:63], v[16:19]
    s_call_b64 s[66:67], L_pack1
    v_mov_b32 v85, v76
    v_mov_b32 v86, v77
    v_mov_b32 v87, v79
    v_mov_b32 v88, v36
    v_mov_b32 v89, v37
    v_mov_b32 v90, v39
    v_mov_b32 v91, v24
    v_mov_b32 v92, v25
    v_mov_b32 v93, v27
    s_movk_i32 s59, 53
    s_cbranch_vccz L_clean_74
    s_call_b64 s[66:67], L_pexc1
L_clean_74:
    s_add_u32 s50, s58, 1130496
    s_cmp_ge_u32 s50, s53
    s_cselect_b32 s62, 2064384, 0
    s_sub_u32 s50, s50, s62
    buffer_load_dwordx4 v[52:55], v2, s[8:11], s50 offen offset:0 nt
    buffer_load_dwordx4 v[56:59], v2, s[8:11], s50 offen offset:128 nt
    buffer_load_dwordx4 v[60:63], v2, s[8:11], s50 offen offset:256 nt
    ds_read_u16_d16_hi v34, v33 offset:400
    s_call_b64 s[66:67], L_prob
    s_waitcnt vmcnt(6)
    v_mfma_f32_16x16x32_bf16 v[8:11], v[24:27], v[64:67], v[8:11]
    v_mfma_f32_16x16x32_bf16 v[12:15], v[24:27], v[68:71], v[12:15]
    v_mfma_f32_16x16x32_bf16 v[16:19], v[24:27], v[72:75], v[16:19]
    s_call_b64 s[66:67], L_pack2
    ds_write2st64_b32 v32, v76, v77 offset0:135 offset1:136
    ds_write_b32 v32, v79 offset:35072
    ds_write2st64_b32 v32, v36, v37 offset0:138 offset1:139
    ds_write_b32 v32, v39 offset:35840
    ds_write2st64_b32 v32, v24, v25 offset0:141 offset1:142
    ds_write_b32 v32, v27 offset:36608
    s_movk_i32 s59, 52
    s_cbranch_vccz L_clean_75
    s_call_b64 s[66:67], L_pexc2
L_clean_75:
    s_add_u32 s50, s48, 1081344
    s_cmp_ge_u32 s50, s53
    s_cselect_b32 s62, 2064384, 0
    s_sub_u32 s50, s50, s62
    buffer_load_dwordx4 v[64:67], v2, s[8:11], s50 offen offset:0 nt
    buffer_load_dwordx4 v[68:71], v2, s[8:11], s50 offen offset:128 nt
    buffer_load_dwordx4 v[72:75], v2, s[8:11], s50 offen offset:256 nt
    ds_read_u16_d16_hi v34, v33 offset:384
    s_call_b64 s[66:67], L_prob
    s_waitcnt vmcnt(6)
    v_mfma_f32_16x16x32_bf16 v[8:11], v[24:27], v[40:43], v[8:11]
    v_mfma_f32_16x16x32_bf16 v[12:15], v[24:27], v[44:47], v[12:15]
    v_mfma_f32_16x16x32_bf16 v[16:19], v[24:27], v[48:51], v[16:19]
    s_call_b64 s[66:67], L_pack0
    ds_write2st64_b32 v32, v76, v77 offset0:117 offset1:118
    ds_write_b32 v32, v79 offset:30464
    ds_write2st64_b32 v32, v36, v37 offset0:120 offset1:121
    ds_write_b32 v32, v39 offset:31232
    ds_write2st64_b32 v32, v24, v25 offset0:123 offset1:124
    ds_write_b32 v32, v27 offset:32000
    s_movk_i32 s59, 51
    s_cbranch_vccz L_clean_76
    s_call_b64 s[66:67], L_pexc0
L_clean_76:
    s_add_u32 s50, s58, 1032192
    s_cmp_ge_u32 s50, s53
    s_cselect_b32 s62, 2064384, 0
    s_sub_u32 s50, s50, s62
    buffer_load_dwordx4 v[40:43], v2, s[8:11], s50 offen offset:0 nt
    buffer_load_dwordx4 v[44:47], v2, s[8:11], s50 offen offset:128 nt
    buffer_load_dwordx4 v[48:51], v2, s[8:11], s50 offen offset:256 nt
    ds_read_u16_d16_hi v34, v33 offset:368
    s_call_b64 s[66:67], L_prob
    s_waitcnt vmcnt(6)
    v_mfma_f32_16x16x32_bf16 v[8:11], v[24:27], v[52:55], v[8:11]
    v_mfma_f32_16x16x32_bf16 v[12:15], v[24:27], v[56:59], v[12:15]
    v_mfma_f32_16x16x32_bf16 v[16:19], v[24:27], v[60:63], v[16:19]
    s_call_b64 s[66:67], L_pack1
    ds_write2st64_b32 v32, v76, v77 offset0:99 offset1:100
    ds_write_b32 v32, v79 offset:25856
    ds_write2st64_b32 v32, v36, v37 offset0:102 offset1:103
    ds_write_b32 v32, v39 offset:26624
    ds_write2st64_b32 v32, v24, v25 offset0:105 offset1:106
    ds_write_b32 v32, v27 offset:27392
    s_movk_i32 s59, 50
    s_cbranch_vccz L_clean_77
    s_call_b64 s[66:67], L_pexc1
L_clean_77:
    s_add_u32 s50, s48, 983040
    s_cmp_ge_u32 s50, s53
    s_cselect_b32 s62, 2064384, 0
    s_sub_u32 s50, s50, s62
    buffer_load_dwordx4 v[52:55], v2, s[8:11], s50 offen offset:0 nt
    buffer_load_dwordx4 v[56:59], v2, s[8:11], s50 offen offset:128 nt
    buffer_load_dwordx4 v[60:63], v2, s[8:11], s50 offen offset:256 nt
    ds_read_u16_d16_hi v34, v33 offset:352
    s_call_b64 s[66:67], L_prob
    s_waitcnt vmcnt(6)
    v_mfma_f32_16x16x32_bf16 v[8:11], v[24:27], v[64:67], v[8:11]
    v_mfma_f32_16x16x32_bf16 v[12:15], v[24:27], v[68:71], v[12:15]
    v_mfma_f32_16x16x32_bf16 v[16:19], v[24:27], v[72:75], v[16:19]
    s_call_b64 s[66:67], L_pack2
    ds_write2st64_b32 v32, v76, v77 offset0:81 offset1:82
    ds_write_b32 v32, v79 offset:21248
    ds_write2st64_b32 v32, v36, v37 offset0:84 offset1:85
    ds_write_b32 v32, v39 offset:22016
    ds_write2st64_b32 v32, v24, v25 offset0:87 offset1:88
    ds_write_b32 v32, v27 offset:22784
    s_movk_i32 s59, 49
    s_cbranch_vccz L_clean_78
    s_call_b64 s[66:67], L_pexc2
L_clean_78:
    s_add_u32 s50, s58, 933888
    s_cmp_ge_u32 s50, s53
    s_cselect_b32 s62, 2064384, 0
    s_sub_u32 s50, s50, s62
    buffer_load_dwordx4 v[64:67], v2, s[8:11], s50 offen offset:0 nt
    buffer_load_dwordx4 v[68:71], v2, s[8:11], s50 offen offset:128 nt
    buffer_load_dwordx4 v[72:75], v2, s[8:11], s50 offen offset:256 nt
    ds_read_u16_d16_hi v34, v33 offset:336
    s_call_b64 s[66:67], L_prob
    s_waitcnt vmcnt(6)
    v_mfma_f32_16x16x32_bf16 v[8:11], v[24:27], v[40:43], v[8:11]
    v_mfma_f32_16x16x32_bf16 v[12:15], v[24:27], v[44:47], v[12:15]
    v_mfma_f32_16x16x32_bf16 v[16:19], v[24:27], v[48:51], v[16:19]
    s_call_b64 s[66:67], L_pack0
    ds_write2st64_b32 v32, v76, v77 offset0:63 offset1:64
    ds_write_b32 v32, v79 offset:16640
    ds_write2st64_b32 v32, v36, v37 offset0:66 offset1:67
    ds_write_b32 v32, v39 offset:17408
    ds_write2st64_b32 v32, v24, v25 offset0:69 offset1:70
    ds_write_b32 v32, v27 offset:18176
    s_movk_i32 s59, 48
    s_cbranch_vccz L_clean_79
    s_call_b64 s[66:67], L_pexc0
L_clean_79:
    s_add_u32 s50, s48, 884736
    s_cmp_ge_u32 s50, s53
    s_cselect_b32 s62, 2064384, 0
    s_sub_u32 s50, s50, s62
    buffer_load_dwordx4 v[40:43], v2, s[8:11], s50 offen offset:0 nt
    buffer_load_dwordx4 v[44:47], v2, s[8:11], s50 offen offset:128 nt
    buffer_load_dwordx4 v[48:51], v2, s[8:11], s50 offen offset:256 nt
    ds_read_u16_d16_hi v34, v33 offset:320
    s_call_b64 s[66:67], L_prob
    s_waitcnt vmcnt(6)
    v_mfma_f32_16x16x32_bf16 v[8:11], v[24:27], v[52:55], v[8:11]
    v_mfma_f32_16x16x32_bf16 v[12:15], v[24:27], v[56:59], v[12:15]
    v_mfma_f32_16x16x32_bf16 v[16:19], v[24:27], v[60:63], v[16:19]
    s_call_b64 s[66:67], L_pack1
    ds_write2st64_b32 v32, v76, v77 offset0:45 offset1:46
    ds_write_b32 v32, v79 offset:12032
    ds_write2st64_b32 v32, v36, v37 offset0:48 offset1:49
    ds_write_b32 v32, v39 offset:12800
    ds_write2st64_b32 v32, v24, v25 offset0:51 offset1:52
    ds_write_b32 v32, v27 offset:13568
    s_movk_i32 s59, 47
    s_cbranch_vccz L_clean_80
    s_call_b64 s[66:67], L_pexc1
L_clean_80:
    s_add_u32 s50, s58, 835584
    s_cmp_ge_u32 s50, s53
    s_cselect_b32 s62, 2064384, 0
    s_sub_u32 s50, s50, s62
    buffer_load_dwordx4 v[52:55], v2, s[8:11], s50 offen offset:0 nt
    buffer_load_dwordx4 v[56:59], v2, s[8:11], s50 offen offset:128 nt
    buffer_load_dwordx4 v[60:63], v2, s[8:11], s50 offen offset:256 nt
    ds_read_u16_d16_hi v34, v33 offset:304
    s_call_b64 s[66:67], L_prob
    s_waitcnt vmcnt(6)
    v_mfma_f32_16x16x32_bf16 v[8:11], v[24:27], v[64:67], v[8:11]
    v_mfma_f32_16x16x32_bf16 v[12:15], v[24:27], v[68:71], v[12:15]
    v_mfma_f32_16x16x32_bf16 v[16:19], v[24:27], v[72:75], v[16:19]
    s_call_b64 s[66:67], L_pack2
    ds_write2st64_b32 v32, v76, v77 offset0:27 offset1:28
    ds_write_b32 v32, v79 offset:7424
    ds_write2st64_b32 v32, v36, v37 offset0:30 offset1:31
    ds_write_b32 v32, v39 offset:8192
    ds_write2st64_b32 v32, v24, v25 offset0:33 offset1:34
    ds_write_b32 v32, v27 offset:8960
    s_movk_i32 s59, 46
    s_cbranch_vccz L_clean_81
    s_call_b64 s[66:67], L_pexc2
L_clean_81:
    s_add_u32 s50, s48, 786432
    s_cmp_ge_u32 s50, s53
    s_cselect_b32 s62, 2064384, 0
    s_sub_u32 s50, s50, s62
    buffer_load_dwordx4 v[64:67], v2, s[8:11], s50 offen offset:0 nt
    buffer_load_dwordx4 v[68:71], v2, s[8:11], s50 offen offset:128 nt
    buffer_load_dwordx4 v[72:75], v2, s[8:11], s50 offen offset:256 nt
    ds_read_u16_d16_hi v34, v33 offset:288
    s_call_b64 s[66:67], L_prob
    s_waitcnt vmcnt(6)
    v_mfma_f32_16x16x32_bf16 v[8:11], v[24:27], v[40:43], v[8:11]
    v_mfma_f32_16x16x32_bf16 v[12:15], v[24:27], v[44:47], v[12:15]
    v_mfma_f32_16x16x32_bf16 v[16:19], v[24:27], v[48:51], v[16:19]
    s_call_b64 s[66:67], L_pack0
    ds_write2st64_b32 v32, v76, v77 offset0:9 offset1:10
    ds_write_b32 v32, v79 offset:2816
    ds_write2st64_b32 v32, v36, v37 offset0:12 offset1:13
    ds_write_b32 v32, v39 offset:3584
    ds_write2st64_b32 v32, v24, v25 offset0:15 offset1:16
    ds_write_b32 v32, v27 offset:4352
    s_movk_i32 s59, 45
    s_cbranch_vccz L_clean_82
    s_call_b64 s[66:67], L_pexc0
L_clean_82:
    s_add_u32 s50, s58, 737280
    s_cmp_ge_u32 s50, s53
    s_cselect_b32 s62, 2064384, 0
    s_sub_u32 s50, s50, s62
    buffer_load_dwordx4 v[40:43], v2, s[8:11], s50 offen offset:0 nt
    buffer_load_dwordx4 v[44:47], v2, s[8:11], s50 offen offset:128 nt
    buffer_load_dwordx4 v[48:51], v2, s[8:11], s50 offen offset:256 nt
    ds_read_u16_d16_hi v34, v33 offset:272
    s_call_b64 s[66:67], L_prob
    s_waitcnt vmcnt(6)
    v_mfma_f32_16x16x32_bf16 v[8:11], v[24:27], v[52:55], v[8:11]
    v_mfma_f32_16x16x32_bf16 v[12:15], v[24:27], v[56:59], v[12:15]
    v_mfma_f32_16x16x32_bf16 v[16:19], v[24:27], v[60:63], v[16:19]
    s_call_b64 s[66:67], L_pack1
    v_accvgpr_write_b32 a234, v76
    v_accvgpr_write_b32 a235, v77
    v_accvgpr_write_b32 a236, v79
    v_accvgpr_write_b32 a237, v36
    v_accvgpr_write_b32 a238, v37
    v_accvgpr_write_b32 a239, v39
    v_accvgpr_write_b32 a252, v24
    v_accvgpr_write_b32 a253, v25
    v_accvgpr_write_b32 a254, v27
    s_movk_i32 s59, 44
    s_cbranch_vccz L_clean_83
    s_call_b64 s[66:67], L_pexc1
L_clean_83:
    s_add_u32 s50, s48, 688128
    s_cmp_ge_u32 s50, s53
    s_cselect_b32 s62, 2064384, 0
    s_sub_u32 s50, s50, s62
    buffer_load_dwordx4 v[52:55], v2, s[8:11], s50 offen offset:0 nt
    buffer_load_dwordx4 v[56:59], v2, s[8:11], s50 offen offset:128 nt
    buffer_load_dwordx4 v[60:63], v2, s[8:11], s50 offen offset:256 nt
    ds_read_u16_d16_hi v34, v33 offset:256
    s_call_b64 s[66:67], L_prob
    s_waitcnt vmcnt(6)
    v_mfma_f32_16x16x32_bf16 v[8:11], v[24:27], v[64:67], v[8:11]
    v_mfma_f32_16x16x32_bf16 v[12:15], v[24:27], v[68:71], v[12:15]
    v_mfma_f32_16x16x32_bf16 v[16:19], v[24:27], v[72:75], v[16:19]
    s_call_b64 s[66:67], L_pack2
    v_accvgpr_write_b32 a216, v76
    v_accvgpr_write_b32 a217, v77
    v_accvgpr_write_b32 a218, v79
    v_accvgpr_write_b32 a219, v36
    v_accvgpr_write_b32 a220, v37
    v_accvgpr_write_b32 a221, v39
    v_accvgpr_write_b32 a222, v24
    v_accvgpr_write_b32 a223, v25
    v_accvgpr_write_b32 a224, v27
    s_movk_i32 s59, 43
    s_cbranch_vccz L_clean_84
    s_call_b64 s[66:67], L_pexc2
L_clean_84:
    s_add_u32 s50, s58, 638976
    s_cmp_ge_u32 s50, s53
    s_cselect_b32 s62, 2064384, 0
    s_sub_u32 s50, s50, s62
    buffer_load_dwordx4 v[64:67], v2, s[8:11], s50 offen offset:0 nt
    buffer_load_dwordx4 v[68:71], v2, s[8:11], s50 offen offset:128 nt
    buffer_load_dwordx4 v[72:75], v2, s[8:11], s50 offen offset:256 nt
    ds_read_u16_d16_hi v34, v33 offset:240
    s_call_b64 s[66:67], L_prob
    s_waitcnt vmcnt(6)
    v_mfma_f32_16x16x32_bf16 v[8:11], v[24:27], v[40:43], v[8:11]
    v_mfma_f32_16x16x32_bf16 v[12:15], v[24:27], v[44:47], v[12:15]
    v_mfma_f32_16x16x32_bf16 v[16:19], v[24:27], v[48:51], v[16:19]
    s_call_b64 s[66:67], L_pack0
    v_accvgpr_write_b32 a198, v76
    v_accvgpr_write_b32 a199, v77
    v_accvgpr_write_b32 a200, v79
    v_accvgpr_write_b32 a201, v36
    v_accvgpr_write_b32 a202, v37
    v_accvgpr_write_b32 a203, v39
    v_accvgpr_write_b32 a204, v24
    v_accvgpr_write_b32 a205, v25
    v_accvgpr_write_b32 a206, v27
    s_movk_i32 s59, 42
    s_cbranch_vccz L_clean_85
    s_call_b64 s[66:67], L_pexc0
L_clean_85:
    s_add_u32 s50, s48, 589824
    s_cmp_ge_u32 s50, s53
    s_cselect_b32 s62, 2064384, 0
    s_sub_u32 s50, s50, s62
    buffer_load_dwordx4 v[40:43], v2, s[8:11], s50 offen offset:0 nt
    buffer_load_dwordx4 v[44:47], v2, s[8:11], s50 offen offset:128 nt
    buffer_load_dwordx4 v[48:51], v2, s[8:11], s50 offen offset:256 nt
    ds_read_u16_d16_hi v34, v33 offset:224
    s_call_b64 s[66:67], L_prob
    s_waitcnt vmcnt(6)
    v_mfma_f32_16x16x32_bf16 v[8:11], v[24:27], v[52:55], v[8:11]
    v_mfma_f32_16x16x32_bf16 v[12:15], v[24:27], v[56:59], v[12:15]
    v_mfma_f32_16x16x32_bf16 v[16:19], v[24:27], v[60:63], v[16:19]
    s_call_b64 s[66:67], L_pack1
    v_accvgpr_write_b32 a180, v76
    v_accvgpr_write_b32 a181, v77
    v_accvgpr_write_b32 a182, v79
    v_accvgpr_write_b32 a183, v36
    v_accvgpr_write_b32 a184, v37
    v_accvgpr_write_b32 a185, v39
    v_accvgpr_write_b32 a186, v24
    v_accvgpr_write_b32 a187, v25
    v_accvgpr_write_b32 a188, v27
    s_movk_i32 s59, 41
    s_cbranch_vccz L_clean_86
    s_call_b64 s[66:67], L_pexc1
L_clean_86:
    s_add_u32 s50, s58, 540672
    s_cmp_ge_u32 s50, s53
    s_cselect_b32 s62, 2064384, 0
    s_sub_u32 s50, s50, s62
    buffer_load_dwordx4 v[52:55], v2, s[8:11], s50 offen offset:0 nt
    buffer_load_dwordx4 v[56:59], v2, s[8:11], s50 offen offset:128 nt
    buffer_load_dwordx4 v[60:63], v2, s[8:11], s50 offen offset:256 nt
    ds_read_u16_d16_hi v34, v33 offset:208
    s_call_b64 s[66:67], L_prob
    s_waitcnt vmcnt(6)
    v_mfma_f32_16x16x32_bf16 v[8:11], v[24:27], v[64:67], v[8:11]
    v_mfma_f32_16x16x32_bf16 v[12:15], v[24:27], v[68:71], v[12:15]
    v_mfma_f32_16x16x32_bf16 v[16:19], v[24:27], v[72:75], v[16:19]
    s_call_b64 s[66:67], L_pack2
    v_accvgpr_write_b32 a162, v76
    v_accvgpr_write_b32 a163, v77
    v_accvgpr_write_b32 a164, v79
    v_accvgpr_write_b32 a165, v36
    v_accvgpr_write_b32 a166, v37
    v_accvgpr_write_b32 a167, v39
    v_accvgpr_write_b32 a168, v24
    v_accvgpr_write_b32 a169, v25
    v_accvgpr_write_b32 a170, v27
    s_movk_i32 s59, 40
    s_cbranch_vccz L_clean_87
    s_call_b64 s[66:67], L_pexc2
L_clean_87:
    s_add_u32 s50, s48, 491520
    s_cmp_ge_u32 s50, s53
    s_cselect_b32 s62, 2064384, 0
    s_sub_u32 s50, s50, s62
    buffer_load_dwordx4 v[64:67], v2, s[8:11], s50 offen offset:0 nt
    buffer_load_dwordx4 v[68:71], v2, s[8:11], s50 offen offset:128 nt
    buffer_load_dwordx4 v[72:75], v2, s[8:11], s50 offen offset:256 nt
    ds_read_u16_d16_hi v34, v33 offset:192
    s_call_b64 s[66:67], L_prob
    s_waitcnt vmcnt(6)
    v_mfma_f32_16x16x32_bf16 v[8:11], v[24:27], v[40:43], v[8:11]
    v_mfma_f32_16x16x32_bf16 v[12:15], v[24:27], v[44:47], v[12:15]
    v_mfma_f32_16x16x32_bf16 v[16:19], v[24:27], v[48:51], v[16:19]
    s_call_b64 s[66:67], L_pack0
    v_accvgpr_write_b32 a144, v76
    v_accvgpr_write_b32 a145, v77
    v_accvgpr_write_b32 a146, v79
    v_accvgpr_write_b32 a147, v36
    v_accvgpr_write_b32 a148, v37
    v_accvgpr_write_b32 a149, v39
    v_accvgpr_write_b32 a150, v24
    v_accvgpr_write_b32 a151, v25
    v_accvgpr_write_b32 a152, v27
    s_movk_i32 s59, 39
    s_cbranch_vccz L_clean_88
    s_call_b64 s[66:67], L_pexc0
L_clean_88:
    s_add_u32 s50, s58, 442368
    s_cmp_ge_u32 s50, s53
    s_cselect_b32 s62, 2064384, 0
    s_sub_u32 s50, s50, s62
    buffer_load_dwordx4 v[40:43], v2, s[8:11], s50 offen offset:0 nt
    buffer_load_dwordx4 v[44:47], v2, s[8:11], s50 offen offset:128 nt
    buffer_load_dwordx4 v[48:51], v2, s[8:11], s50 offen offset:256 nt
    ds_read_u16_d16_hi v34, v33 offset:176
    s_call_b64 s[66:67], L_prob
    s_waitcnt vmcnt(6)
    v_mfma_f32_16x16x32_bf16 v[8:11], v[24:27], v[52:55], v[8:11]
    v_mfma_f32_16x16x32_bf16 v[12:15], v[24:27], v[56:59], v[12:15]
    v_mfma_f32_16x16x32_bf16 v[16:19], v[24:27], v[60:63], v[16:19]
    s_call_b64 s[66:67], L_pack1
    v_accvgpr_write_b32 a126, v76
    v_accvgpr_write_b32 a127, v77
    v_accvgpr_write_b32 a128, v79
    v_accvgpr_write_b32 a129, v36
    v_accvgpr_write_b32 a130, v37
    v_accvgpr_write_b32 a131, v39
    v_accvgpr_write_b32 a132, v24
    v_accvgpr_write_b32 a133, v25
    v_accvgpr_write_b32 a134, v27
    s_movk_i32 s59, 38
    s_cbranch_vccz L_clean_89
    s_call_b64 s[66:67], L_pexc1
L_clean_89:
    s_add_u32 s50, s48, 393216
    s_cmp_ge_u32 s50, s53
    s_cselect_b32 s62, 2064384, 0
    s_sub_u32 s50, s50, s62
    buffer_load_dwordx4 v[52:55], v2, s[8:11], s50 offen offset:0 sc1
    buffer_load_dwordx4 v[56:59], v2, s[8:11], s50 offen offset:128 sc1
    buffer_load_dwordx4 v[60:63], v2, s[8:11], s50 offen offset:256 sc1
    ds_read_u16_d16_hi v34, v33 offset:160
    s_call_b64 s[66:67], L_prob
    s_waitcnt vmcnt(6)
    v_mfma_f32_16x16x32_bf16 v[8:11], v[24:27], v[64:67], v[8:11]
    v_mfma_f32_16x16x32_bf16 v[12:15], v[24:27], v[68:71], v[12:15]
    v_mfma_f32_16x16x32_bf16 v[16:19], v[24:27], v[72:75], v[16:19]
    s_call_b64 s[66:67], L_pack2
    v_accvgpr_write_b32 a36, v76
    v_accvgpr_write_b32 a37, v77
    v_accvgpr_write_b32 a38, v79
    v_accvgpr_write_b32 a39, v36
    v_accvgpr_write_b32 a40, v37
    v_accvgpr_write_b32 a41, v39
    v_accvgpr_write_b32 a42, v24
    v_accvgpr_write_b32 a43, v25
    v_accvgpr_write_b32 a44, v27
    s_movk_i32 s59, 37
    s_cbranch_vccz L_clean_90
    s_call_b64 s[66:67], L_pexc2
L_clean_90:
    s_add_u32 s50, s58, 344064
    s_cmp_ge_u32 s50, s53
    s_cselect_b32 s62, 2064384, 0
    s_sub_u32 s50, s50, s62
    buffer_load_dwordx4 v[64:67], v2, s[8:11], s50 offen offset:0 sc1
    buffer_load_dwordx4 v[68:71], v2, s[8:11], s50 offen offset:128 sc1
    buffer_load_dwordx4 v[72:75], v2, s[8:11], s50 offen offset:256 sc1
    ds_read_u16_d16_hi v34, v33 offset:144
    s_call_b64 s[66:67], L_prob
    s_waitcnt vmcnt(6)
    v_mfma_f32_16x16x32_bf16 v[8:11], v[24:27], v[40:43], v[8:11]
    v_mfma_f32_16x16x32_bf16 v[12:15], v[24:27], v[44:47], v[12:15]
    v_mfma_f32_16x16x32_bf16 v[16:19], v[24:27], v[48:51], v[16:19]
    s_call_b64 s[66:67], L_pack0
    v_accvgpr_write_b32 a18, v76
    v_accvgpr_write_b32 a19, v77
    v_accvgpr_write_b32 a20, v79
    v_accvgpr_write_b32 a21, v36
    v_accvgpr_write_b32 a22, v37
    v_accvgpr_write_b32 a23, v39
    v_accvgpr_write_b32 a24, v24
    v_accvgpr_write_b32 a25, v25
    v_accvgpr_write_b32 a26, v27
    s_movk_i32 s59, 36
    s_cbranch_vccz L_clean_91
    s_call_b64 s[66:67], L_pexc0
L_clean_91:
    s_add_u32 s50, s48, 294912
    s_cmp_ge_u32 s50, s53
    s_cselect_b32 s62, 2064384, 0
    s_sub_u32 s50, s50, s62
    buffer_load_dwordx4 v[40:43], v2, s[8:11], s50 offen offset:0 sc1
    buffer_load_dwordx4 v[44:47], v2, s[8:11], s50 offen offset:128 sc1
    buffer_load_dwordx4 v[48:51], v2, s[8:11], s50 offen offset:256 sc1
    ds_read_u16_d16_hi v34, v33 offset:128
    s_call_b64 s[66:67], L_prob
    s_waitcnt vmcnt(6)
    v_mfma_f32_16x16x32_bf16 v[8:11], v[24:27], v[52:55], v[8:11]
    v_mfma_f32_16x16x32_bf16 v[12:15], v[24:27], v[56:59], v[12:15]
    v_mfma_f32_16x16x32_bf16 v[16:19], v[24:27], v[60:63], v[16:19]
    s_add_u32 s50, s58, 245760
    s_cmp_ge_u32 s50, s53
    s_cselect_b32 s62, 2064384, 0
    s_sub_u32 s50, s50, s62
    buffer_load_dwordx4 v[52:55], v2, s[8:11], s50 offen offset:0 sc1
    buffer_load_dwordx4 v[56:59], v2, s[8:11], s50 offen offset:128 sc1
    buffer_load_dwordx4 v[60:63], v2, s[8:11], s50 offen offset:256 sc1
    ds_read_u16_d16_hi v34, v33 offset:112
    s_call_b64 s[66:67], L_prob
    s_waitcnt vmcnt(6)
    v_mfma_f32_16x16x32_bf16 v[8:11], v[24:27], v[64:67], v[8:11]
    v_mfma_f32_16x16x32_bf16 v[12:15], v[24:27], v[68:71], v[12:15]
    v_mfma_f32_16x16x32_bf16 v[16:19], v[24:27], v[72:75], v[16:19]
    s_add_u32 s50, s48, 196608
    s_cmp_ge_u32 s50, s53
    s_cselect_b32 s62, 2064384, 0
    s_sub_u32 s50, s50, s62
    buffer_load_dwordx4 v[64:67], v2, s[8:11], s50 offen offset:0 sc1
    buffer_load_dwordx4 v[68:71], v2, s[8:11], s50 offen offset:128 sc1
    buffer_load_dwordx4 v[72:75], v2, s[8:11], s50 offen offset:256 sc1
    ds_read_u16_d16_hi v34, v33 offset:96
    s_call_b64 s[66:67], L_prob
    s_waitcnt vmcnt(6)
    v_mfma_f32_16x16x32_bf16 v[8:11], v[24:27], v[40:43], v[8:11]
    v_mfma_f32_16x16x32_bf16 v[12:15], v[24:27], v[44:47], v[12:15]
    v_mfma_f32_16x16x32_bf16 v[16:19], v[24:27], v[48:51], v[16:19]
    s_add_u32 s50, s58, 147456
    s_cmp_ge_u32 s50, s53
    s_cselect_b32 s62, 2064384, 0
    s_sub_u32 s50, s50, s62
    buffer_load_dwordx4 v[40:43], v2, s[8:11], s50 offen offset:0 sc1
    buffer_load_dwordx4 v[44:47], v2, s[8:11], s50 offen offset:128 sc1
    buffer_load_dwordx4 v[48:51], v2, s[8:11], s50 offen offset:256 sc1
    ds_read_u16_d16_hi v34, v33 offset:80
    s_call_b64 s[66:67], L_prob
    s_waitcnt vmcnt(6)
    v_mfma_f32_16x16x32_bf16 v[8:11], v[24:27], v[52:55], v[8:11]
    v_mfma_f32_16x16x32_bf16 v[12:15], v[24:27], v[56:59], v[12:15]
    v_mfma_f32_16x16x32_bf16 v[16:19], v[24:27], v[60:63], v[16:19]
    s_add_u32 s50, s48, 98304
    s_cmp_ge_u32 s50, s53
    s_cselect_b32 s62, 2064384, 0
    s_sub_u32 s50, s50, s62
    buffer_load_dwordx4 v[52:55], v2, s[8:11], s50 offen offset:0 sc1
    buffer_load_dwordx4 v[56:59], v2, s[8:11], s50 offen offset:128 sc1
    buffer_load_dwordx4 v[60:63], v2, s[8:11], s50 offen offset:256 sc1
    ds_read_u16_d16_hi v34, v33 offset:64
    s_call_b64 s[66:67], L_prob
    s_waitcnt vmcnt(6)
    v_mfma_f32_16x16x32_bf16 v[8:11], v[24:27], v[64:67], v[8:11]
    v_mfma_f32_16x16x32_bf16 v[12:15], v[24:27], v[68:71], v[12:15]
    v_mfma_f32_16x16x32_bf16 v[16:19], v[24:27], v[72:75], v[16:19]
    s_add_u32 s50, s58, 49152
    s_cmp_ge_u32 s50, s53
    s_cselect_b32 s62, 2064384, 0
    s_sub_u32 s50, s50, s62
    buffer_load_dwordx4 v[64:67], v2, s[8:11], s50 offen offset:0 sc1
    buffer_load_dwordx4 v[68:71], v2, s[8:11], s50 offen offset:128 sc1
    buffer_load_dwordx4 v[72:75], v2, s[8:11], s50 offen offset:256 sc1
    ds_read_u16_d16_hi v34, v33 offset:48
    s_call_b64 s[66:67], L_prob
    s_waitcnt vmcnt(6)
    v_mfma_f32_16x16x32_bf16 v[8:11], v[24:27], v[40:43], v[8:11]
    v_mfma_f32_16x16x32_bf16 v[12:15], v[24:27], v[44:47], v[12:15]
    v_mfma_f32_16x16x32_bf16 v[16:19], v[24:27], v[48:51], v[16:19]
    s_add_u32 s50, s48, 0
    s_cmp_ge_u32 s50, s53
    s_cselect_b32 s62, 2064384, 0
    s_sub_u32 s50, s50, s62
    buffer_load_dwordx4 v[40:43], v2, s[8:11], s50 offen offset:0 nt
    buffer_load_dwordx4 v[44:47], v2, s[8:11], s50 offen offset:128 nt
    buffer_load_dwordx4 v[48:51], v2, s[8:11], s50 offen offset:256 nt
    ds_read_u16_d16_hi v34, v33 offset:32
    s_call_b64 s[66:67], L_prob
    s_waitcnt vmcnt(6)
    v_mfma_f32_16x16x32_bf16 v[8:11], v[24:27], v[52:55], v[8:11]
    v_mfma_f32_16x16x32_bf16 v[12:15], v[24:27], v[56:59], v[12:15]
    v_mfma_f32_16x16x32_bf16 v[16:19], v[24:27], v[60:63], v[16:19]
    s_lshl2_add_u32 s60, s44, s46
    s_mul_i32 s61, s60, 15360
    s_mul_i32 s62, s45, 384
    s_add_u32 s61, s61, s62
    v_mul_u32_u24 v76, 43, v0
    v_lshrrev_b32 v76, 7, v76
    v_mul_u32_u24 v76, 2688, v76
    v_lshl_add_u32 v76, v0, 7, v76
    v_lshlrev_b32 v77, 7, v0
    s_mul_i32 s60, s60, 1920
    s_mul_i32 s62, s45, 245760
    s_add_u32 s60, s60, s62
    s_mov_b64 exec, 0x7fff
    buffer_load_dword v78, v76, s[24:27], s61 offen
    buffer_load_dword v79, v77, s[28:31], s60 offen
    s_mov_b64 exec, -1
    ds_read_u16_d16_hi v34, v33 offset:16
    s_call_b64 s[66:67], L_prob
    s_waitcnt vmcnt(5)
    v_lshrrev_b32 v38, 3, v0
    v_mul_u32_u24 v38, 1280, v38
    v_and_b32 v39, 7, v0
    v_lshl_add_u32 v38, v39, 4, v38
    s_mul_i32 s61, s44, 24
    s_add_u32 s61, s61, s45
    s_mul_i32 s61, s61, 10240
    s_lshl_b32 s62, s46, 7
    s_add_u32 s61, s61, s62
    s_add_u32 s61, s61, 0
    buffer_load_dwordx4 v[52:55], v38, s[20:23], s61 offen offset:0 nt
    buffer_load_dwordx4 v[56:59], v38, s[20:23], s61 offen offset:512 nt
    s_cmp_lt_u32 s46, 2
    s_cselect_b64 exec, -1, 1
    buffer_load_dwordx4 v[60:63], v38, s[20:23], s61 offen offset:1024 nt
    s_mov_b64 exec, -1
    v_mfma_f32_16x16x32_bf16 v[8:11], v[24:27], v[64:67], v[8:11]
    v_mfma_f32_16x16x32_bf16 v[12:15], v[24:27], v[68:71], v[12:15]
    v_mfma_f32_16x16x32_bf16 v[16:19], v[24:27], v[72:75], v[16:19]
    ds_read_u16_d16_hi v34, v33 offset:0
    s_call_b64 s[66:67], L_prob
    v_lshrrev_b32 v38, 3, v0
    v_mul_u32_u24 v38, 1280, v38
    v_and_b32 v39, 7, v0
    v_lshl_add_u32 v38, v39, 4, v38
    s_mul_i32 s61, s44, 24
    s_add_u32 s61, s61, s45
    s_mul_i32 s61, s61, 10240
    s_lshl_b32 s62, s46, 7
    s_add_u32 s61, s61, s62
    s_add_u32 s61, s61, 81920
    buffer_load_dwordx4 v[64:67], v38, s[20:23], s61 offen offset:0 nt
    buffer_load_dwordx4 v[68:71], v38, s[20:23], s61 offen offset:512 nt
    s_cmp_lt_u32 s46, 2
    s_cselect_b64 exec, -1, 1
    buffer_load_dwordx4 v[72:75], v38, s[20:23], s61 offen offset:1024 nt
    s_mov_b64 exec, -1
    v_lshrrev_b32 v38, 3, v0
    v_mul_u32_u24 v38, 1280, v38
    v_and_b32 v39, 7, v0
    v_lshl_add_u32 v38, v39, 4, v38
    s_mul_i32 s61, s44, 24
    s_add_u32 s61, s61, s45
    s_mul_i32 s61, s61, 10240
    s_lshl_b32 s62, s46, 7
    s_add_u32 s61, s61, s62
    s_add_u32 s61, s61, 163840
    buffer_load_dwordx4 a[240:243], v38, s[20:23], s61 offen offset:0 nt
    buffer_load_dwordx4 a[244:247], v38, s[20:23], s61 offen offset:512 nt
    s_cmp_lt_u32 s46, 2
    s_cselect_b64 exec, -1, 1
    buffer_load_dwordx4 a[248:251], v38, s[20:23], s61 offen offset:1024 nt
    s_mov_b64 exec, -1
    s_mov_b32 s64, 1
    v_add_f32_dpp v29, v29, v29 row_ror:8 row_mask:0xf bank_mask:0xf
    v_sub_f32 v28, 0, v28
    s_lshl_b32 s60, s64, 2
    v_add_f32_dpp v29, v29, v29 row_bcast:15 row_mask:0xa bank_mask:0xf
    s_add_u32 s60, s60, s46
    s_lshl_b32 s60, s60, 3
    v_add_f32_dpp v29, v29, v29 row_bcast:31 row_mask:0xc bank_mask:0xf
    s_add_u32 s60, s60, 159744
    v_mov_b32 v30, s60
    s_mov_b32 exec_lo, 0
    s_mov_b32 exec_hi, 0x80000000
    ds_write_b64 v30, v[28:29]
    s_mov_b64 exec, -1
    s_lshl_b32 s60, s46, 1
    s_add_u32 s60, s60, s64
    s_mul_i32 s60, s60, 768
    s_add_u32 s60, s60, 153600
    v_lshrrev_b32 v31, 5, v0
    v_lshl_add_u32 v31, v31, 8, s60
    v_and_b32 v39, 7, v0
    v_lshl_add_u32 v31, v39, 5, v31
    v_and_b32 v39, 16, v0
    v_add_u32 v31, v31, v39
    s_waitcnt vmcnt(11)
    v_mfma_f32_16x16x32_bf16 v[8:11], v[24:27], v[40:43], v[8:11]
    v_mfma_f32_16x16x32_bf16 v[12:15], v[24:27], v[44:47], v[12:15]
    v_mfma_f32_16x16x32_bf16 v[16:19], v[24:27], v[48:51], v[16:19]
    s_branch L_passend
L_switch:
    s_mov_b32 s64, 0
    v_add_f32_dpp v29, v29, v29 row_ror:8 row_mask:0xf bank_mask:0xf
    v_sub_f32 v28, 0, v28
    s_lshl_b32 s60, s64, 2
    v_add_f32_dpp v29, v29, v29 row_bcast:15 row_mask:0xa bank_mask:0xf
    s_add_u32 s60, s60, s46
    s_lshl_b32 s60, s60, 3
    v_add_f32_dpp v29, v29, v29 row_bcast:31 row_mask:0xc bank_mask:0xf
    s_add_u32 s60, s60, 159744
    v_mov_b32 v30, s60
    s_mov_b32 exec_lo, 0
    s_mov_b32 exec_hi, 0x80000000
    ds_write_b64 v30, v[28:29]
    s_mov_b64 exec, -1
    s_lshl_b32 s60, s46, 1
    s_add_u32 s60, s60, s64
    s_mul_i32 s60, s60, 768
    s_add_u32 s60, s60, 153600
    v_lshrrev_b32 v31, 5, v0
    v_lshl_add_u32 v31, v31, 8, s60
    v_and_b32 v39, 7, v0
    v_lshl_add_u32 v31, v39, 5, v31
    v_and_b32 v39, 16, v0
    v_add_u32 v31, v31, v39
    v_permlane32_swap_b32 v8, v12
    v_permlane32_swap_b32 v9, v13
    v_permlane32_swap_b32 v10, v14
    v_permlane32_swap_b32 v11, v15
    v_permlane32_swap_b32 v16, v20
    v_permlane32_swap_b32 v17, v21
    v_permlane32_swap_b32 v18, v22
    v_permlane32_swap_b32 v19, v23
    v_add_f32_dpp v8, v12, v8 row_ror:8 row_mask:0xf bank_mask:0xf
    v_add_f32_dpp v9, v13, v9 row_ror:8 row_mask:0xf bank_mask:0xf
    v_add_f32_dpp v10, v14, v10 row_ror:8 row_mask:0xf bank_mask:0xf
    v_add_f32_dpp v11, v15, v11 row_ror:8 row_mask:0xf bank_mask:0xf
    v_add_f32_dpp v16, v20, v16 row_ror:8 row_mask:0xf bank_mask:0xf
    v_add_f32_dpp v17, v21, v17 row_ror:8 row_mask:0xf bank_mask:0xf
    v_add_f32_dpp v18, v22, v18 row_ror:8 row_mask:0xf bank_mask:0xf
    v_add_f32_dpp v19, v23, v19 row_ror:8 row_mask:0xf bank_mask:0xf
    s_mov_b32 exec_lo, 0x00ff00ff
    s_mov_b32 exec_hi, 0x00ff00ff
    ds_write_b128 v31, v[8:11]
    s_mov_b32 exec_hi, 0
    ds_write_b128 v31, v[16:19] offset:512
    s_mov_b64 exec, -1
    s_mul_i32 s60, s46, 38400
    s_mul_i32 s61, s46, 1536
    s_add_u32 s61, s61, 154368
    v_add_u32 v30, s60, v3
    v_add_u32 v31, s61, v3
    s_mov_b32 exec_hi, 0xffff
    ds_read_b128 v[20:23], v30 offset:2304
    s_waitcnt lgkmcnt(0)
    ds_write_b128 v31, v[20:23]
    s_mov_b64 exec, -1
    s_mul_i32 s60, s46, 1536
    s_add_u32 s60, s60, 154368
    v_lshrrev_b32 v33, 3, v0
    v_lshl_add_u32 v33, v33, 1, s60
    ds_read_u16_d16_hi v34, v33 offset:688
    v_mov_b32 v8, 0
    v_mov_b32 v9, 0
    v_mov_b32 v10, 0
    v_mov_b32 v11, 0
    v_mov_b32 v12, 0
    v_mov_b32 v13, 0
    v_mov_b32 v14, 0
    v_mov_b32 v15, 0
    v_mov_b32 v16, 0
    v_mov_b32 v17, 0
    v_mov_b32 v18, 0
    v_mov_b32 v19, 0
    v_mov_b32 v29, 0
    v_mov_b32 v28, 0x7f800000
    s_mov_b32 s52, 0xff800000
    s_waitcnt lgkmcnt(0)
    s_nop 1
    v_max_f32_dpp v28, v34, v34 row_ror:8 row_mask:0xf bank_mask:0xf
    s_nop 1
    v_max_f32_dpp v28, v28, v28 row_bcast:15 row_mask:0xa bank_mask:0xf
    s_nop 1
    v_max_f32_dpp v28, v28, v28 row_bcast:31 row_mask:0xc bank_mask:0xf
    s_nop 1
    v_readlane_b32 s52, v28, 63
    s_nop 1
    v_mov_b32 v28, s52
    v_mul_f32 v28, 0xbfb8aa3b, v28
    s_setpc_b64 s[66:67]
    .p2align 12
L_getx2:
    s_mul_i32 s60, s46, 768
    s_add_u32 s60, s60, 153600
    v_lshrrev_b32 v39, 5, v0
    v_lshl_add_u32 v39, v39, 8, s60
    v_and_b32 v35, 7, v0
    v_lshl_add_u32 v39, v35, 5, v39
    v_and_b32 v35, 16, v0
    v_add_u32 v39, v39, v35
    v_add_u32 v32, s45, v0
    v_and_b32 v32, 7, v32
    v_and_or_b32 v32, v0, 56, v32
    v_lshlrev_b32 v33, 3, v32
    v_lshlrev_b32 v32, 4, v32
    s_and_b32 s61, s2, 1
    s_mul_i32 s61, s61, 2560
    s_bfe_u32 s60, s2, 0x10001
    s_lshl_b32 s60, s60, 14
    s_add_u32 s61, s61, s60
    s_add_u32 s61, s61, s56
    s_add_u32 s61, s61, 2048000
    s_bitcmp1_b32 s98, s45
    s_cselect_b32 s59, 8192, 0
    s_add_u32 s61, s61, s59
    s_mov_b64 s[32:33], -1
    s_mov_b64 s[34:35], -1
    s_mov_b64 s[40:41], -1
    s_bitcmp1_b32 s46, 0
    s_cselect_b64 s[42:43], -1, 0
    s_bitcmp1_b32 s46, 1
    s_cselect_b64 s[54:55], -1, 0
    s_mov_b32 s59, 400000
L_poll_113:
    s_mov_b64 exec, s[32:33]
    buffer_load_dwordx4 v[8:11], v32, s[12:15], s61 offen sc1
    s_mov_b64 exec, s[34:35]
    buffer_load_dwordx4 v[12:15], v32, s[12:15], s61 offen offset:1024 sc1
    s_mov_b64 exec, s[40:41]
    buffer_load_dwordx2 v[16:17], v33, s[12:15], s61 offen offset:2048 sc1
    s_mov_b64 exec, -1
    s_waitcnt vmcnt(0)
    v_max_u32 v36, v8, v9
    v_max3_u32 v36, v36, v10, v11
    v_cmp_eq_u32 s[32:33], -1, v36
    v_max_u32 v37, v12, v13
    v_max3_u32 v37, v37, v14, v15
    v_cmp_eq_u32 s[34:35], -1, v37
    v_max_u32 v36, v16, v17
    v_cmp_eq_u32 s[40:41], -1, v36
    s_or_b64 vcc, s[32:33], s[34:35]
    s_or_b64 vcc, vcc, s[40:41]
    s_cbranch_scc0 L_got_114
    s_sub_u32 s59, s59, 1
    s_cbranch_scc0 L_poll_113
L_got_114:
    v_cndmask_b32 v36, v8, v9, s[42:43]
    v_cndmask_b32 v34, v10, v11, s[42:43]
    v_cndmask_b32 v37, v12, v13, s[42:43]
    v_cndmask_b32 v35, v14, v15, s[42:43]
    v_cndmask_b32 v38, v16, v17, s[42:43]
    v_cndmask_b32 v36, v36, v34, s[54:55]
    v_cndmask_b32 v37, v37, v35, s[54:55]
    s_nop 0
    v_mov_b32_dpp v38, v38 row_newbcast:0 row_mask:0xf bank_mask:0x3
    v_mov_b32_dpp v36, v36 row_newbcast:0 row_mask:0xf bank_mask:0x3
    v_mov_b32_dpp v37, v37 row_newbcast:0 row_mask:0xf bank_mask:0x3
    v_mov_b32_dpp v38, v38 row_newbcast:8 row_mask:0xf bank_mask:0xc
    v_mov_b32_dpp v36, v36 row_newbcast:8 row_mask:0xf bank_mask:0xc
    v_mov_b32_dpp v37, v37 row_newbcast:8 row_mask:0xf bank_mask:0xc
    v_readfirstlane_b32 s60, v8
    s_nop 1
    v_pk_add_f32 v[8:9], v[8:9], s[60:61] op_sel_hi:[1,0] neg_lo:[0,1] neg_hi:[0,1]
    v_pk_add_f32 v[10:11], v[10:11], s[60:61] op_sel_hi:[1,0] neg_lo:[0,1] neg_hi:[0,1]
    v_pk_add_f32 v[12:13], v[12:13], s[60:61] op_sel_hi:[1,0] neg_lo:[0,1] neg_hi:[0,1]
    v_pk_add_f32 v[14:15], v[14:15], s[60:61] op_sel_hi:[1,0] neg_lo:[0,1] neg_hi:[0,1]
    v_pk_add_f32 v[16:17], v[16:17], s[60:61] op_sel_hi:[1,0] neg_lo:[0,1] neg_hi:[0,1]
    v_pk_mul_f32 v[18:19], v[8:9], v[8:9]
    v_pk_fma_f32 v[18:19], v[10:11], v[10:11], v[18:19]
    v_pk_add_f32 v[8:9], v[8:9], v[10:11]
    v_pk_fma_f32 v[18:19], v[12:13], v[12:13], v[18:19]
    v_pk_add_f32 v[8:9], v[8:9], v[12:13]
    v_pk_fma_f32 v[18:19], v[14:15], v[14:15], v[18:19]
    v_pk_add_f32 v[8:9], v[8:9], v[14:15]
    v_pk_fma_f32 v[18:19], v[16:17], v[16:17], v[18:19]
    v_pk_add_f32 v[8:9], v[8:9], v[16:17]
    v_add_f32 v19, v18, v19
    v_add_f32 v18, v8, v9
    s_nop 0
    s_nop 0
    v_add_f32_dpp v18, v18, v18 quad_perm:[1,0,3,2] row_mask:0xf bank_mask:0xf
    v_add_f32_dpp v19, v19, v19 quad_perm:[1,0,3,2] row_mask:0xf bank_mask:0xf
    s_nop 0
    v_add_f32_dpp v18, v18, v18 quad_perm:[2,3,0,1] row_mask:0xf bank_mask:0xf
    v_add_f32_dpp v19, v19, v19 quad_perm:[2,3,0,1] row_mask:0xf bank_mask:0xf
    s_nop 0
    v_add_f32_dpp v18, v18, v18 row_half_mirror row_mask:0xf bank_mask:0xf
    v_add_f32_dpp v19, v19, v19 row_half_mirror row_mask:0xf bank_mask:0xf
    s_nop 0
    v_add_f32_dpp v18, v18, v18 row_mirror row_mask:0xf bank_mask:0xf
    v_add_f32_dpp v19, v19, v19 row_mirror row_mask:0xf bank_mask:0xf
    s_nop 0
    v_add_f32_dpp v18, v18, v18 row_bcast:15 row_mask:0xa bank_mask:0xf
    v_add_f32_dpp v19, v19, v19 row_bcast:15 row_mask:0xa bank_mask:0xf
    s_nop 0
    v_add_f32_dpp v18, v18, v18 row_bcast:31 row_mask:0xc bank_mask:0xf
    v_add_f32_dpp v19, v19, v19 row_bcast:31 row_mask:0xc bank_mask:0xf
    s_nop 0
    v_readlane_b32 s61, v18, 63
    v_readlane_b32 s62, v19, 63
    v_mov_b32 v32, 0x3acccccd
    s_nop 0
    v_mul_f32 v18, s61, v32
    v_mul_f32 v19, s62, v32
    v_fma_f32 v19, -v18, v18, v19
    v_max_f32 v19, 0, v19
    v_add_f32 v18, s60, v18
    v_cvt_pk_bf16_f32 v18, 0, v18
    v_cvt_pk_bf16_f32 v19, 0, v19
    v_add_f32 v19, 0x3727c5ac, v19
    v_cvt_pk_bf16_f32 v19, 0, v19
    v_sqrt_f32 v19, v19
    s_nop 0
    v_cvt_pk_bf16_f32 v19, 0, v19
    v_rcp_f32 v19, v19
    v_sub_f32 v36, v36, v18
    v_cvt_pk_bf16_f32 v36, 0, v36
    v_sub_f32 v37, v37, v18
    v_cvt_pk_bf16_f32 v37, 0, v37
    v_sub_f32 v38, v38, v18
    v_cvt_pk_bf16_f32 v38, 0, v38
    v_mul_f32 v36, v36, v19
    v_cvt_pk_bf16_f32 v36, v36, v36
    v_mul_f32 v37, v37, v19
    v_cvt_pk_bf16_f32 v37, v37, v37
    v_mul_f32 v38, v38, v19
    v_cvt_pk_bf16_f32 v38, v38, v38
    v_and_b32 v32, v4, v36
    v_and_b32 v33, v5, v36
    v_and_b32 v34, v6, v36
    v_and_b32 v35, v7, v36
    v_and_b32 v24, v4, v37
    v_and_b32 v25, v5, v37
    v_and_b32 v26, v6, v37
    v_and_b32 v27, v7, v37
    v_mfma_f32_16x16x32_bf16 v[8:11], v[32:35], v[52:55], 0
    v_mfma_f32_16x16x32_bf16 v[12:15], v[32:35], v[56:59], 0
    v_mfma_f32_16x16x32_bf16 v[16:19], v[32:35], v[60:63], 0
    v_and_b32 v28, v4, v38
    v_and_b32 v29, v5, v38
    v_and_b32 v30, v6, v38
    v_and_b32 v31, v7, v38
    v_mfma_f32_16x16x32_bf16 v[8:11], v[24:27], v[64:67], v[8:11]
    v_mfma_f32_16x16x32_bf16 v[12:15], v[24:27], v[68:71], v[12:15]
    v_mfma_f32_16x16x32_bf16 v[16:19], v[24:27], v[72:75], v[16:19]
    s_cmp_ge_u32 s46, 2
    s_cbranch_scc1 L_q2_115
    v_mfma_f32_16x16x32_bf16 v[8:11], v[28:31], a[240:243], v[8:11]
    v_mfma_f32_16x16x32_bf16 v[12:15], v[28:31], a[244:247], v[12:15]
    v_mfma_f32_16x16x32_bf16 v[16:19], v[28:31], a[248:251], v[16:19]
L_q2_115:
    s_nop 7
    v_permlane32_swap_b32 v8, v12
    v_permlane32_swap_b32 v9, v13
    v_permlane32_swap_b32 v10, v14
    v_permlane32_swap_b32 v11, v15
    v_permlane32_swap_b32 v16, v20
    v_permlane32_swap_b32 v17, v21
    v_permlane32_swap_b32 v18, v22
    v_permlane32_swap_b32 v19, v23
    v_add_f32_dpp v8, v12, v8 row_ror:8 row_mask:0xf bank_mask:0xf
    v_add_f32_dpp v9, v13, v9 row_ror:8 row_mask:0xf bank_mask:0xf
    v_add_f32_dpp v10, v14, v10 row_ror:8 row_mask:0xf bank_mask:0xf
    v_add_f32_dpp v11, v15, v11 row_ror:8 row_mask:0xf bank_mask:0xf
    v_add_f32_dpp v16, v20, v16 row_ror:8 row_mask:0xf bank_mask:0xf
    v_add_f32_dpp v17, v21, v17 row_ror:8 row_mask:0xf bank_mask:0xf
    v_add_f32_dpp v18, v22, v18 row_ror:8 row_mask:0xf bank_mask:0xf
    v_add_f32_dpp v19, v23, v19 row_ror:8 row_mask:0xf bank_mask:0xf
    s_mov_b32 exec_lo, 0x00ff00ff
    s_mov_b32 exec_hi, 0x00ff00ff
    ds_write_b128 v39, v[8:11]
    s_mov_b32 exec_hi, 0
    ds_write_b128 v39, v[16:19] offset:512
    s_mov_b64 exec, -1
    v_add_u32 v32, 153600, v3
    s_waitcnt lgkmcnt(0)
    s_barrier
    s_cmp_lg_u32 s46, 0
    s_cbranch_scc1 L_q1_117
    ds_read_b128 v[8:11], v32 offset:0
    ds_read_b128 v[12:15], v32 offset:768
    ds_read_b128 v[16:19], v32 offset:1536
    ds_read_b128 v[20:23], v32 offset:2304
    s_mul_i32 s61, s45, 768
    s_lshl_b32 s62, s44, 14
    s_add_u32 s61, s61, s62
    s_add_u32 s61, s61, 4194304
    s_add_u32 s62, s61, 8192
    s_mov_b32 exec_hi, 0xffff
    s_waitcnt lgkmcnt(0)
    v_pk_add_f32 v[8:9], v[8:9], v[16:17]
    v_pk_add_f32 v[10:11], v[10:11], v[18:19]
    v_pk_add_f32 v[12:13], v[12:13], v[20:21]
    v_pk_add_f32 v[14:15], v[14:15], v[22:23]
    v_pk_add_f32 v[8:9], v[8:9], v[12:13]
    v_pk_add_f32 v[10:11], v[10:11], v[14:15]
    buffer_store_dwordx4 v[8:11], v3, s[12:15], s61 offen sc1
    buffer_store_dwordx4 v[8:11], v3, s[12:15], s62 offen sc1
    s_mov_b64 exec, -1
    s_branch L_qjoin_116
L_q3:
    s_sub_u32 s63, s44, 24
    s_and_b32 s60, s2, 3
    s_lshl2_add_u32 s63, s63, s60
    s_lshr_b32 s60, s45, 2
    s_lshl1_add_u32 s63, s63, s60
    s_cmp_lt_i32 s63, 20
    s_cbranch_scc1 L_qjoin_116
    v_mov_b32 v8, 1
    s_mov_b32 s60, 2080768
    s_mov_b64 exec, 1
    buffer_atomic_add v8, off, s[12:15], s60 sc1
    s_mov_b64 exec, -1
    s_branch L_qjoin_116
L_q1_117:
    s_cmp_eq_u32 s46, 3
    s_cbranch_scc1 L_q3
    s_lshl_b32 s63, s57, 14
    s_add_u32 s63, s63, 4194304
    s_bitcmp1_b32 s98, s45
    s_cselect_b32 s59, 8192, 0
    s_add_u32 s63, s63, s59
    s_add_u32 s1, s63, 3072
    s_mov_b32 s32, -1
    s_mov_b32 s33, 0xffff
    s_mov_b32 s34, -1
    s_mov_b32 s35, 0xffff
    s_mov_b32 s40, -1
    s_mov_b32 s41, 0xffff
    s_mov_b32 s42, -1
    s_mov_b32 s43, 0xffff
    s_mov_b32 s54, -1
    s_mov_b32 s55, 0xffff
    s_mov_b32 s66, -1
    s_mov_b32 s67, 0xffff
    s_mov_b32 s38, -1
    s_mov_b32 s39, 0xffff
    s_mov_b32 s50, -1
    s_mov_b32 s51, 0xffff
    s_sleep 10
    s_mov_b32 s59, 400000
L_poll_118:
    s_mov_b64 exec, s[32:33]
    buffer_load_dwordx4 v[8:11], v3, s[12:15], s63 offen offset:0 sc1
    s_mov_b64 exec, s[34:35]
    buffer_load_dwordx4 v[12:15], v3, s[12:15], s63 offen offset:768 sc1
    s_mov_b64 exec, s[40:41]
    buffer_load_dwordx4 v[16:19], v3, s[12:15], s63 offen offset:1536 sc1
    s_mov_b64 exec, s[42:43]
    buffer_load_dwordx4 v[20:23], v3, s[12:15], s63 offen offset:2304 sc1
    s_mov_b64 exec, s[54:55]
    buffer_load_dwordx4 v[24:27], v3, s[12:15], s1 offen offset:0 sc1
    s_mov_b64 exec, s[66:67]
    buffer_load_dwordx4 v[28:31], v3, s[12:15], s1 offen offset:768 sc1
    s_mov_b64 exec, s[38:39]
    buffer_load_dwordx4 v[32:35], v3, s[12:15], s1 offen offset:1536 sc1
    s_mov_b64 exec, s[50:51]
    buffer_load_dwordx4 v[36:39], v3, s[12:15], s1 offen offset:2304 sc1
    s_mov_b64 exec, -1
    s_mov_b32 exec_hi, 0xffff
    s_waitcnt vmcnt(5)
    v_max_u32 v52, v8, v9
    v_max3_u32 v52, v52, v10, v11
    v_cmp_eq_u32 s[32:33], -1, v52
    v_max_u32 v53, v12, v13
    v_max3_u32 v53, v53, v14, v15
    v_cmp_eq_u32 s[34:35], -1, v53
    v_max_u32 v52, v16, v17
    v_max3_u32 v52, v52, v18, v19
    v_cmp_eq_u32 s[40:41], -1, v52
    s_or_b64 vcc, s[32:33], s[34:35]
    s_waitcnt vmcnt(0)
    v_max_u32 v53, v20, v21
    v_max3_u32 v53, v53, v22, v23
    v_cmp_eq_u32 s[42:43], -1, v53
    s_or_b64 vcc, vcc, s[40:41]
    v_max_u32 v52, v24, v25
    v_max3_u32 v52, v52, v26, v27
    v_cmp_eq_u32 s[54:55], -1, v52
    s_or_b64 vcc, vcc, s[42:43]
    v_max_u32 v53, v28, v29
    v_max3_u32 v53, v53, v30, v31
    v_cmp_eq_u32 s[66:67], -1, v53
    s_or_b64 vcc, vcc, s[54:55]
    v_max_u32 v52, v32, v33
    v_max3_u32 v52, v52, v34, v35
    v_cmp_eq_u32 s[38:39], -1, v52
    s_or_b64 vcc, vcc, s[66:67]
    v_max_u32 v53, v36, v37
    v_max3_u32 v53, v53, v38, v39
    v_cmp_eq_u32 s[50:51], -1, v53
    s_or_b64 vcc, vcc, s[38:39]
    s_or_b64 vcc, vcc, s[50:51]
    s_cbranch_scc0 L_got_119
    s_sub_u32 s59, s59, 1
    s_cbranch_scc0 L_poll_118
L_got_119:
    v_pk_add_f32 v[8:9], v[8:9], v[24:25]
    v_pk_add_f32 v[10:11], v[10:11], v[26:27]
    v_pk_add_f32 v[12:13], v[12:13], v[28:29]
    v_pk_add_f32 v[14:15], v[14:15], v[30:31]
    v_pk_add_f32 v[16:17], v[16:17], v[32:33]
    v_pk_add_f32 v[18:19], v[18:19], v[34:35]
    v_pk_add_f32 v[20:21], v[20:21], v[36:37]
    v_pk_add_f32 v[22:23], v[22:23], v[38:39]
    s_and_b32 s60, s46, 1
    s_mul_i32 s60, s60, 384
    s_add_u32 s60, s60, 159872
    v_lshl_add_u32 v24, v0, 3, s60
    v_pk_add_f32 v[8:9], v[8:9], v[16:17]
    v_pk_add_f32 v[10:11], v[10:11], v[18:19]
    v_pk_add_f32 v[12:13], v[12:13], v[20:21]
    v_pk_add_f32 v[14:15], v[14:15], v[22:23]
    v_pk_add_f32 v[8:9], v[8:9], v[12:13]
    v_pk_add_f32 v[10:11], v[10:11], v[14:15]
    v_cvt_pk_bf16_f32 v8, v8, v9
    v_cvt_pk_bf16_f32 v9, v10, v11
    ds_write_b64 v24, v[8:9]
    s_mov_b64 exec, -1
L_qjoin_116:
L_early:
    s_mov_b32 s56, 8388608
    s_waitcnt lgkmcnt(0)
    s_barrier
L_pass2:
    s_bfe_u32 s60, s98, 0x1000f
    s_xor_b32 s60, s60, s46
    s_and_b32 s60, s60, 1
    s_lshl_b32 s60, s60, 21
    s_add_u32 s60, s60, 24576
    s_add_u32 s51, s47, s60
    s_sub_u32 s1, s0, s60
    s_sub_u32 s63, s58, s48
    s_add_u32 s63, s63, s1
    s_bitcmp1_b32 s51, 21
    s_cselect_b32 s50, s63, s1
    s_add_u32 s50, s50, s51
    s_add_u32 s51, s51, 49152
    buffer_load_dwordx4 v[64:67], v1, s[4:7], s50 offen offset:0 nt
    buffer_load_dwordx4 v[68:71], v1, s[4:7], s50 offen offset:128 nt
    buffer_load_dwordx4 v[72:75], v1, s[4:7], s50 offen offset:256 nt
    s_bitcmp1_b32 s51, 21
    s_cselect_b32 s50, s63, s1
    s_add_u32 s50, s50, s51
    s_add_u32 s51, s51, 49152
    buffer_load_dwordx4 v[52:55], v1, s[4:7], s50 offen offset:0 nt
    buffer_load_dwordx4 v[56:59], v1, s[4:7], s50 offen offset:128 nt
    buffer_load_dwordx4 v[60:63], v1, s[4:7], s50 offen offset:256 nt
    s_bitcmp1_b32 s51, 21
    s_cselect_b32 s50, s63, s1
    s_add_u32 s50, s50, s51
    s_add_u32 s51, s51, 49152
L_first:
    v_and_b32 v30, 1, v0
    v_lshlrev_b32 v30, 6, v30
    v_and_b32 v31, 48, v0
    v_add_u32 v30, v30, v31
    v_add_u32 v30, 159872, v30
    ds_read_b128 a[240:243], v30 offset:384
    ds_read_b128 a[244:247], v30 offset:512
    ds_read_b128 a[248:251], v30 offset:640
    v_mov_b32 v8, 0
    v_mov_b32 v9, 0
    v_mov_b32 v10, 0
    v_mov_b32 v11, 0
    v_mov_b32 v12, 0
    v_mov_b32 v13, 0
    v_mov_b32 v14, 0
    v_mov_b32 v15, 0
    v_mov_b32 v16, 0
    v_mov_b32 v17, 0
    v_mov_b32 v18, 0
    v_mov_b32 v19, 0
    v_mov_b32 v29, 0
    v_mov_b32 v28, 0x7f800000
    s_mov_b32 s52, 0xff800000
    s_mul_i32 s60, s46, 38400
    v_lshl_add_u32 v32, v0, 2, s60
    s_mul_i32 s60, s46, 1536
    s_add_u32 s60, s60, 153600
    v_lshrrev_b32 v33, 3, v0
    v_lshl_add_u32 v33, v33, 1, s60
    v_mov_b32 v35, 0xff800000
    s_waitcnt lgkmcnt(0)
    v_accvgpr_read_b32 v76, a0
    v_accvgpr_read_b32 v77, a1
    v_accvgpr_read_b32 v79, a2
    v_accvgpr_read_b32 v36, a3
    v_accvgpr_read_b32 v37, a4
    v_accvgpr_read_b32 v39, a5
    v_accvgpr_read_b32 v24, a6
    v_accvgpr_read_b32 v25, a7
    v_accvgpr_read_b32 v27, a8
    s_movk_i32 s59, 0
    s_call_b64 s[66:67], L_ko
    v_and_b32 v24, v4, v34
    v_and_b32 v25, v5, v34
    v_and_b32 v26, v6, v34
    v_and_b32 v27, v7, v34
    s_nop 1
    v_mfma_f32_16x16x32_bf16 v[8:11], v[24:27], v[40:43], v[8:11]
    v_mfma_f32_16x16x32_bf16 v[12:15], v[24:27], v[44:47], v[12:15]
    v_mfma_f32_16x16x32_bf16 v[16:19], v[24:27], v[48:51], v[16:19]
    buffer_load_dwordx4 v[40:43], v1, s[4:7], s50 offen offset:0 nt
    buffer_load_dwordx4 v[44:47], v1, s[4:7], s50 offen offset:128 nt
    buffer_load_dwordx4 v[48:51], v1, s[4:7], s50 offen offset:256 nt
    s_bitcmp1_b32 s51, 21
    s_cselect_b32 s50, s63, s1
    s_add_u32 s50, s50, s51
    s_add_u32 s51, s51, 49152
    v_accvgpr_read_b32 v76, a9
    v_accvgpr_read_b32 v77, a10
    v_accvgpr_read_b32 v79, a11
    v_accvgpr_read_b32 v36, a12
    v_accvgpr_read_b32 v37, a13
    v_accvgpr_read_b32 v39, a14
    v_accvgpr_read_b32 v24, a15
    v_accvgpr_read_b32 v25, a16
    v_accvgpr_read_b32 v27, a17
    s_movk_i32 s59, 9
    s_call_b64 s[66:67], L_ko
    v_and_b32 v30, 1, v0
    v_lshlrev_b32 v30, 6, v30
    v_and_b32 v31, 48, v0
    v_add_u32 v30, v30, v31
    v_add_u32 v30, 159872, v30
    ds_read_b128 a[0:3], v30 offset:0
    ds_read_b128 a[4:7], v30 offset:128
    ds_read_b128 a[8:11], v30 offset:256
    s_waitcnt vmcnt(6)
    s_waitcnt lgkmcnt(0)
    v_mfma_f32_16x16x32_bf16 v[20:23], v[64:67], a[0:3], 0
    v_mfma_f32_16x16x32_bf16 v[20:23], v[68:71], a[4:7], v[20:23]
    v_mfma_f32_16x16x32_bf16 v[20:23], v[72:75], a[8:11], v[20:23]
    buffer_load_dwordx4 v[64:67], v1, s[4:7], s50 offen offset:0 nt
    buffer_load_dwordx4 v[68:71], v1, s[4:7], s50 offen offset:128 nt
    buffer_load_dwordx4 v[72:75], v1, s[4:7], s50 offen offset:256 nt
    s_bitcmp1_b32 s51, 21
    s_cselect_b32 s50, s63, s1
    s_add_u32 s50, s50, s51
    s_add_u32 s51, s51, 49152
    s_call_b64 s[66:67], L_kat
    v_accvgpr_read_b32 v76, a18
    v_accvgpr_read_b32 v77, a19
    v_accvgpr_read_b32 v79, a20
    v_accvgpr_read_b32 v36, a21
    v_accvgpr_read_b32 v37, a22
    v_accvgpr_read_b32 v39, a23
    v_accvgpr_read_b32 v24, a24
    v_accvgpr_read_b32 v25, a25
    v_accvgpr_read_b32 v27, a26
    s_movk_i32 s59, 36
    s_call_b64 s[66:67], L_vo
    s_waitcnt vmcnt(6)
    buffer_load_dwordx4 a[12:15], v1, s[4:7], s50 offen offset:0 nt
    buffer_load_dwordx4 a[16:19], v1, s[4:7], s50 offen offset:128 nt
    buffer_load_dwordx4 a[20:23], v1, s[4:7], s50 offen offset:256 nt
    s_bitcmp1_b32 s51, 21
    s_cselect_b32 s50, s63, s1
    s_add_u32 s50, s50, s51
    s_add_u32 s51, s51, 49152
    v_mfma_f32_16x16x32_bf16 v[20:23], v[52:55], a[0:3], 0
    v_mfma_f32_16x16x32_bf16 v[20:23], v[56:59], a[4:7], v[20:23]
    v_mfma_f32_16x16x32_bf16 v[20:23], v[60:63], a[8:11], v[20:23]
    s_call_b64 s[66:67], L_kat
    s_waitcnt vmcnt(6)
    buffer_load_dwordx4 v[52:55], v1, s[4:7], s50 offen offset:0 nt
    buffer_load_dwordx4 v[56:59], v1, s[4:7], s50 offen offset:128 nt
    buffer_load_dwordx4 v[60:63], v1, s[4:7], s50 offen offset:256 nt
    s_bitcmp1_b32 s51, 21
    s_cselect_b32 s50, s63, s1
    s_add_u32 s50, s50, s51
    s_add_u32 s51, s51, 49152
    v_mfma_f32_16x16x32_bf16 v[20:23], v[40:43], a[0:3], 0
    v_mfma_f32_16x16x32_bf16 v[20:23], v[44:47], a[4:7], v[20:23]
    v_mfma_f32_16x16x32_bf16 v[20:23], v[48:51], a[8:11], v[20:23]
    s_call_b64 s[66:67], L_kat
    v_accvgpr_read_b32 v76, a27
    v_accvgpr_read_b32 v77, a28
    v_accvgpr_read_b32 v79, a29
    v_accvgpr_read_b32 v36, a30
    v_accvgpr_read_b32 v37, a31
    v_accvgpr_read_b32 v39, a32
    v_accvgpr_read_b32 v24, a33
    v_accvgpr_read_b32 v25, a34
    v_accvgpr_read_b32 v27, a35
    s_movk_i32 s59, 10
    s_call_b64 s[66:67], L_ko
    s_waitcnt vmcnt(6)
    buffer_load_dwordx4 a[24:27], v1, s[4:7], s50 offen offset:0 nt
    buffer_load_dwordx4 a[28:31], v1, s[4:7], s50 offen offset:128 nt
    buffer_load_dwordx4 a[32:35], v1, s[4:7], s50 offen offset:256 nt
    s_add_u32 s50, s58, 49152
    s_cmp_ge_u32 s50, s53
    s_cselect_b32 s62, 2064384, 0
    s_sub_u32 s50, s50, s62
    buffer_load_dwordx4 v[40:43], v2, s[8:11], s50 offen offset:0 nt
    buffer_load_dwordx4 v[44:47], v2, s[8:11], s50 offen offset:128 nt
    buffer_load_dwordx4 v[48:51], v2, s[8:11], s50 offen offset:256 nt
    s_bitcmp1_b32 s51, 21
    s_cselect_b32 s50, s63, s1
    s_add_u32 s50, s50, s51
    s_add_u32 s51, s51, 49152
    v_mfma_f32_16x16x32_bf16 v[20:23], v[64:67], a[0:3], 0
    v_mfma_f32_16x16x32_bf16 v[20:23], v[68:71], a[4:7], v[20:23]
    v_mfma_f32_16x16x32_bf16 v[20:23], v[72:75], a[8:11], v[20:23]
    s_call_b64 s[66:67], L_kat
    s_waitcnt vmcnt(9)
    buffer_load_dwordx4 v[64:67], v1, s[4:7], s50 offen offset:0 nt
    buffer_load_dwordx4 v[68:71], v1, s[4:7], s50 offen offset:128 nt
    buffer_load_dwordx4 v[72:75], v1, s[4:7], s50 offen offset:256 nt
    s_bitcmp1_b32 s51, 21
    s_cselect_b32 s50, s63, s1
    s_add_u32 s50, s50, s51
    s_add_u32 s51, s51, 49152
    v_mfma_f32_16x16x32_bf16 v[20:23], a[12:15], a[0:3], 0
    v_mfma_f32_16x16x32_bf16 v[20:23], a[16:19], a[4:7], v[20:23]
    v_mfma_f32_16x16x32_bf16 v[20:23], a[20:23], a[8:11], v[20:23]
    s_call_b64 s[66:67], L_kat
    v_accvgpr_read_b32 v76, a36
    v_accvgpr_read_b32 v77, a37
    v_accvgpr_read_b32 v79, a38
    v_accvgpr_read_b32 v36, a39
    v_accvgpr_read_b32 v37, a40
    v_accvgpr_read_b32 v39, a41
    v_accvgpr_read_b32 v24, a42
    v_accvgpr_read_b32 v25, a43
    v_accvgpr_read_b32 v27, a44
    s_movk_i32 s59, 37
    s_call_b64 s[66:67], L_vo
    s_waitcnt vmcnt(9)
    buffer_load_dwordx4 a[12:15], v1, s[4:7], s50 offen offset:0 nt
    buffer_load_dwordx4 a[16:19], v1, s[4:7], s50 offen offset:128 nt
    buffer_load_dwordx4 a[20:23], v1, s[4:7], s50 offen offset:256 nt
    s_add_u32 s50, s48, 98304
    s_cmp_ge_u32 s50, s53
    s_cselect_b32 s62, 2064384, 0
    s_sub_u32 s50, s50, s62
    v_mfma_f32_16x16x32_bf16 v[20:23], v[52:55], a[0:3], 0
    v_mfma_f32_16x16x32_bf16 v[20:23], v[56:59], a[4:7], v[20:23]
    v_mfma_f32_16x16x32_bf16 v[20:23], v[60:63], a[8:11], v[20:23]
    buffer_load_dwordx4 v[52:55], v2, s[8:11], s50 offen offset:0 nt
    buffer_load_dwordx4 v[56:59], v2, s[8:11], s50 offen offset:128 nt
    buffer_load_dwordx4 v[60:63], v2, s[8:11], s50 offen offset:256 nt
    s_bitcmp1_b32 s51, 21
    s_cselect_b32 s50, s63, s1
    s_add_u32 s50, s50, s51
    s_add_u32 s51, s51, 49152
    s_call_b64 s[66:67], L_kat
    v_accvgpr_read_b32 v76, a45
    v_accvgpr_read_b32 v77, a46
    v_accvgpr_read_b32 v79, a47
    v_accvgpr_read_b32 v36, a48
    v_accvgpr_read_b32 v37, a49
    v_accvgpr_read_b32 v39, a50
    v_accvgpr_read_b32 v24, a51
    v_accvgpr_read_b32 v25, a52
    v_accvgpr_read_b32 v27, a53
    s_movk_i32 s59, 1
    s_call_b64 s[66:67], L_ko
    s_waitcnt vmcnt(12)
    buffer_load_dwordx4 a[36:39], v1, s[4:7], s50 offen offset:0 nt
    buffer_load_dwordx4 a[40:43], v1, s[4:7], s50 offen offset:128 nt
    buffer_load_dwordx4 a[44:47], v1, s[4:7], s50 offen offset:256 nt
    s_bitcmp1_b32 s51, 21
    s_cselect_b32 s50, s63, s1
    s_add_u32 s50, s50, s51
    s_add_u32 s51, s51, 49152
    v_mfma_f32_16x16x32_bf16 v[20:23], a[24:27], a[0:3], 0
    v_mfma_f32_16x16x32_bf16 v[20:23], a[28:31], a[4:7], v[20:23]
    v_mfma_f32_16x16x32_bf16 v[20:23], a[32:35], a[8:11], v[20:23]
    s_call_b64 s[66:67], L_kat
    v_and_b32 v24, v4, v34
    v_and_b32 v25, v5, v34
    v_and_b32 v26, v6, v34
    v_and_b32 v27, v7, v34
    s_waitcnt vmcnt(12)
    s_nop 1
    v_mfma_f32_16x16x32_bf16 v[8:11], v[24:27], v[40:43], v[8:11]
    v_mfma_f32_16x16x32_bf16 v[12:15], v[24:27], v[44:47], v[12:15]
    v_mfma_f32_16x16x32_bf16 v[16:19], v[24:27], v[48:51], v[16:19]
    s_waitcnt vmcnt(9)
    buffer_load_dwordx4 a[24:27], v1, s[4:7], s50 offen offset:0 nt
    buffer_load_dwordx4 a[28:31], v1, s[4:7], s50 offen offset:128 nt
    buffer_load_dwordx4 a[32:35], v1, s[4:7], s50 offen offset:256 nt
    s_add_u32 s50, s58, 147456
    s_cmp_ge_u32 s50, s53
    s_cselect_b32 s62, 2064384, 0
    s_sub_u32 s50, s50, s62
    buffer_load_dwordx4 v[40:43], v2, s[8:11], s50 offen offset:0 nt
    buffer_load_dwordx4 v[44:47], v2, s[8:11], s50 offen offset:128 nt
    buffer_load_dwordx4 v[48:51], v2, s[8:11], s50 offen offset:256 nt
    s_bfe_u32 s60, s98, 0x1000f
    s_xor_b32 s60, s60, s46
    s_and_b32 s60, s60, 1
    s_lshl_b32 s60, s60, 21
    s_add_u32 s60, s60, 24576
    s_add_u32 s61, s46, 1
    s_and_b32 s61, s61, 3
    s_and_b32 s62, s2, 8
    s_lshl1_add_u32 s61, s61, s62
    s_lshl_b32 s61, s61, 1
    s_lshr_b32 s61, 0xc571b260, s61
    s_lshr_b32 s62, s2, 2
    s_xor_b32 s62, s62, s46
    s_lshl_b32 s62, s62, 3
    s_xor_b32 s61, s61, s62
    s_and_b32 s61, s61, 15
    s_xor_b32 s62, s61, 8
    s_mul_i32 s61, s61, 3072
    s_mul_i32 s62, s62, 3072
    s_sub_u32 s1, s61, s60
    s_sub_u32 s63, s62, s60
    s_bitcmp1_b32 s51, 21
    s_cselect_b32 s50, s63, s1
    s_add_u32 s50, s50, s51
    s_add_u32 s51, s51, 49152
    v_mfma_f32_16x16x32_bf16 v[20:23], v[64:67], a[0:3], 0
    v_mfma_f32_16x16x32_bf16 v[20:23], v[68:71], a[4:7], v[20:23]
    v_mfma_f32_16x16x32_bf16 v[20:23], v[72:75], a[8:11], v[20:23]
    s_call_b64 s[66:67], L_kat
    v_accvgpr_read_b32 v76, a54
    v_accvgpr_read_b32 v77, a55
    v_accvgpr_read_b32 v79, a56
    v_accvgpr_read_b32 v36, a57
    v_accvgpr_read_b32 v37, a58
    v_accvgpr_read_b32 v39, a59
    v_accvgpr_read_b32 v24, a60
    v_accvgpr_read_b32 v25, a61
    v_accvgpr_read_b32 v27, a62
    s_movk_i32 s59, 2
    s_call_b64 s[66:67], L_ko
    s_waitcnt vmcnt(12)
    buffer_load_dwordx4 a[48:51], v1, s[4:7], s50 offen offset:0 nt
    buffer_load_dwordx4 a[52:55], v1, s[4:7], s50 offen offset:128 nt
    buffer_load_dwordx4 a[56:59], v1, s[4:7], s50 offen offset:256 nt
    s_bitcmp1_b32 s51, 21
    s_cselect_b32 s50, s63, s1
    s_add_u32 s50, s50, s51
    s_add_u32 s51, s51, 49152
    v_mfma_f32_16x16x32_bf16 v[20:23], a[12:15], a[0:3], 0
    v_mfma_f32_16x16x32_bf16 v[20:23], a[16:19], a[4:7], v[20:23]
    v_mfma_f32_16x16x32_bf16 v[20:23], a[20:23], a[8:11], v[20:23]
    s_call_b64 s[66:67], L_kat
    v_and_b32 v24, v4, v34
    v_and_b32 v25, v5, v34
    v_and_b32 v26, v6, v34
    v_and_b32 v27, v7, v34
    s_waitcnt vmcnt(12)
    s_nop 1
    v_mfma_f32_16x16x32_bf16 v[8:11], v[24:27], v[52:55], v[8:11]
    v_mfma_f32_16x16x32_bf16 v[12:15], v[24:27], v[56:59], v[12:15]
    v_mfma_f32_16x16x32_bf16 v[16:19], v[24:27], v[60:63], v[16:19]
    s_waitcnt vmcnt(9)
    buffer_load_dwordx4 a[12:15], v1, s[4:7], s50 offen offset:0 nt
    buffer_load_dwordx4 a[16:19], v1, s[4:7], s50 offen offset:128 nt
    buffer_load_dwordx4 a[20:23], v1, s[4:7], s50 offen offset:256 nt
    s_add_u32 s50, s48, 196608
    s_cmp_ge_u32 s50, s53
    s_cselect_b32 s62, 2064384, 0
    s_sub_u32 s50, s50, s62
    buffer_load_dwordx4 v[64:67], v2, s[8:11], s50 offen offset:0 nt
    buffer_load_dwordx4 v[68:71], v2, s[8:11], s50 offen offset:128 nt
    buffer_load_dwordx4 v[72:75], v2, s[8:11], s50 offen offset:256 nt
    s_bitcmp1_b32 s51, 21
    s_cselect_b32 s50, s63, s1
    s_add_u32 s50, s50, s51
    s_add_u32 s51, s51, 49152
    v_mfma_f32_16x16x32_bf16 v[20:23], a[36:39], a[0:3], 0
    v_mfma_f32_16x16x32_bf16 v[20:23], a[40:43], a[4:7], v[20:23]
    v_mfma_f32_16x16x32_bf16 v[20:23], a[44:47], a[8:11], v[20:23]
    s_call_b64 s[66:67], L_kat
    v_accvgpr_read_b32 v76, a63
    v_accvgpr_read_b32 v77, a64
    v_accvgpr_read_b32 v79, a65
    v_accvgpr_read_b32 v36, a66
    v_accvgpr_read_b32 v37, a67
    v_accvgpr_read_b32 v39, a68
    v_accvgpr_read_b32 v24, a69
    v_accvgpr_read_b32 v25, a70
    v_accvgpr_read_b32 v27, a71
    s_movk_i32 s59, 3
    s_call_b64 s[66:67], L_ko
    s_waitcnt vmcnt(12)
    buffer_load_dwordx4 a[60:63], v1, s[4:7], s50 offen offset:0 nt
    buffer_load_dwordx4 a[64:67], v1, s[4:7], s50 offen offset:128 nt
    buffer_load_dwordx4 a[68:71], v1, s[4:7], s50 offen offset:256 nt
    s_bitcmp1_b32 s51, 21
    s_cselect_b32 s50, s63, s1
    s_add_u32 s50, s50, s51
    s_add_u32 s51, s51, 49152
    v_mfma_f32_16x16x32_bf16 v[20:23], a[24:27], a[0:3], 0
    v_mfma_f32_16x16x32_bf16 v[20:23], a[28:31], a[4:7], v[20:23]
    v_mfma_f32_16x16x32_bf16 v[20:23], a[32:35], a[8:11], v[20:23]
    s_call_b64 s[66:67], L_kat
    v_and_b32 v24, v4, v34
    v_and_b32 v25, v5, v34
    v_and_b32 v26, v6, v34
    v_and_b32 v27, v7, v34
    s_waitcnt vmcnt(12)
    s_nop 1
    v_mfma_f32_16x16x32_bf16 v[8:11], v[24:27], v[40:43], v[8:11]
    v_mfma_f32_16x16x32_bf16 v[12:15], v[24:27], v[44:47], v[12:15]
    v_mfma_f32_16x16x32_bf16 v[16:19], v[24:27], v[48:51], v[16:19]
    s_waitcnt vmcnt(9)
    buffer_load_dwordx4 a[36:39], v1, s[4:7], s50 offen offset:0 nt
    buffer_load_dwordx4 a[40:43], v1, s[4:7], s50 offen offset:128 nt
    buffer_load_dwordx4 a[44:47], v1, s[4:7], s50 offen offset:256 nt
    s_add_u32 s50, s58, 245760
    s_cmp_ge_u32 s50, s53
    s_cselect_b32 s62, 2064384, 0
    s_sub_u32 s50, s50, s62
    buffer_load_dwordx4 a[24:27], v2, s[8:11], s50 offen offset:0 nt
    buffer_load_dwordx4 a[28:31], v2, s[8:11], s50 offen offset:128 nt
    buffer_load_dwordx4 a[32:35], v2, s[8:11], s50 offen offset:256 nt
    s_bitcmp1_b32 s51, 21
    s_cselect_b32 s50, s63, s1
    s_add_u32 s50, s50, s51
    s_add_u32 s51, s51, 49152
    v_mfma_f32_16x16x32_bf16 v[20:23], a[48:51], a[0:3], 0
    v_mfma_f32_16x16x32_bf16 v[20:23], a[52:55], a[4:7], v[20:23]
    v_mfma_f32_16x16x32_bf16 v[20:23], a[56:59], a[8:11], v[20:23]
    s_call_b64 s[66:67], L_kat
    v_accvgpr_read_b32 v76, a72
    v_accvgpr_read_b32 v77, a73
    v_accvgpr_read_b32 v79, a74
    v_accvgpr_read_b32 v36, a75
    v_accvgpr_read_b32 v37, a76
    v_accvgpr_read_b32 v39, a77
    v_accvgpr_read_b32 v24, a78
    v_accvgpr_read_b32 v25, a79
    v_accvgpr_read_b32 v27, a80
    s_movk_i32 s59, 4
    s_call_b64 s[66:67], L_ko
    s_waitcnt vmcnt(12)
    buffer_load_dwordx4 a[48:51], v1, s[4:7], s50 offen offset:0 nt
    buffer_load_dwordx4 a[52:55], v1, s[4:7], s50 offen offset:128 nt
    buffer_load_dwordx4 a[56:59], v1, s[4:7], s50 offen offset:256 nt
    s_bitcmp1_b32 s51, 21
    s_cselect_b32 s50, s63, s1
    s_add_u32 s50, s50, s51
    s_add_u32 s51, s51, 49152
    v_mfma_f32_16x16x32_bf16 v[20:23], a[12:15], a[0:3], 0
    v_mfma_f32_16x16x32_bf16 v[20:23], a[16:19], a[4:7], v[20:23]
    v_mfma_f32_16x16x32_bf16 v[20:23], a[20:23], a[8:11], v[20:23]
    s_call_b64 s[66:67], L_kat
    v_and_b32 v24, v4, v34
    v_and_b32 v25, v5, v34
    v_and_b32 v26, v6, v34
    v_and_b32 v27, v7, v34
    s_waitcnt vmcnt(12)
    s_nop 1
    v_mfma_f32_16x16x32_bf16 v[8:11], v[24:27], v[64:67], v[8:11]
    v_mfma_f32_16x16x32_bf16 v[12:15], v[24:27], v[68:71], v[12:15]
    v_mfma_f32_16x16x32_bf16 v[16:19], v[24:27], v[72:75], v[16:19]
    s_waitcnt vmcnt(9)
    buffer_load_dwordx4 a[12:15], v1, s[4:7], s50 offen offset:0 nt
    buffer_load_dwordx4 a[16:19], v1, s[4:7], s50 offen offset:128 nt
    buffer_load_dwordx4 a[20:23], v1, s[4:7], s50 offen offset:256 nt
    s_add_u32 s50, s48, 294912
    s_cmp_ge_u32 s50, s53
    s_cselect_b32 s62, 2064384, 0
    s_sub_u32 s50, s50, s62
    buffer_load_dwordx4 v[64:67], v2, s[8:11], s50 offen offset:0 nt
    buffer_load_dwordx4 v[68:71], v2, s[8:11], s50 offen offset:128 nt
    buffer_load_dwordx4 v[72:75], v2, s[8:11], s50 offen offset:256 nt
    s_bitcmp1_b32 s51, 21
    s_cselect_b32 s50, s63, s1
    s_add_u32 s50, s50, s51
    s_add_u32 s51, s51, 49152
    v_mfma_f32_16x16x32_bf16 v[20:23], a[60:63], a[0:3], 0
    v_mfma_f32_16x16x32_bf16 v[20:23], a[64:67], a[4:7], v[20:23]
    v_mfma_f32_16x16x32_bf16 v[20:23], a[68:71], a[8:11], v[20:23]
    s_call_b64 s[66:67], L_kat
    v_accvgpr_read_b32 v76, a81
    v_accvgpr_read_b32 v77, a82
    v_accvgpr_read_b32 v79, a83
    v_accvgpr_read_b32 v36, a84
    v_accvgpr_read_b32 v37, a85
    v_accvgpr_read_b32 v39, a86
    v_accvgpr_read_b32 v24, a87
    v_accvgpr_read_b32 v25, a88
    v_accvgpr_read_b32 v27, a89
    s_movk_i32 s59, 5
    s_call_b64 s[66:67], L_ko
    s_waitcnt vmcnt(12)
    buffer_load_dwordx4 a[72:75], v1, s[4:7], s50 offen offset:0 nt
    buffer_load_dwordx4 a[76:79], v1, s[4:7], s50 offen offset:128 nt
    buffer_load_dwordx4 a[80:83], v1, s[4:7], s50 offen offset:256 nt
    s_bitcmp1_b32 s51, 21
    s_cselect_b32 s50, s63, s1
    s_add_u32 s50, s50, s51
    s_add_u32 s51, s51, 49152
    v_mfma_f32_16x16x32_bf16 v[20:23], a[36:39], a[0:3], 0
    v_mfma_f32_16x16x32_bf16 v[20:23], a[40:43], a[4:7], v[20:23]
    v_mfma_f32_16x16x32_bf16 v[20:23], a[44:47], a[8:11], v[20:23]
    s_call_b64 s[66:67], L_kat
    v_and_b32 v24, v4, v34
    v_and_b32 v25, v5, v34
    v_and_b32 v26, v6, v34
    v_and_b32 v27, v7, v34
    s_waitcnt vmcnt(12)
    s_nop 1
    v_mfma_f32_16x16x32_bf16 v[8:11], v[24:27], a[24:27], v[8:11]
    v_mfma_f32_16x16x32_bf16 v[12:15], v[24:27], a[28:31], v[12:15]
    v_mfma_f32_16x16x32_bf16 v[16:19], v[24:27], a[32:35], v[16:19]
    s_waitcnt vmcnt(9)
    buffer_load_dwordx4 a[60:63], v1, s[4:7], s50 offen offset:0 nt
    buffer_load_dwordx4 a[64:67], v1, s[4:7], s50 offen offset:128 nt
    buffer_load_dwordx4 a[68:71], v1, s[4:7], s50 offen offset:256 nt
    s_add_u32 s50, s58, 344064
    s_cmp_ge_u32 s50, s53
    s_cselect_b32 s62, 2064384, 0
    s_sub_u32 s50, s50, s62
    buffer_load_dwordx4 a[36:39], v2, s[8:11], s50 offen offset:0 nt
    buffer_load_dwordx4 a[40:43], v2, s[8:11], s50 offen offset:128 nt
    buffer_load_dwordx4 a[44:47], v2, s[8:11], s50 offen offset:256 nt
    s_bitcmp1_b32 s51, 21
    s_cselect_b32 s50, s63, s1
    s_add_u32 s50, s50, s51
    s_add_u32 s51, s51, 49152
    v_mfma_f32_16x16x32_bf16 v[20:23], a[48:51], a[0:3], 0
    v_mfma_f32_16x16x32_bf16 v[20:23], a[52:55], a[4:7], v[20:23]
    v_mfma_f32_16x16x32_bf16 v[20:23], a[56:59], a[8:11], v[20:23]
    s_call_b64 s[66:67], L_kat
    v_accvgpr_read_b32 v76, a90
    v_accvgpr_read_b32 v77, a91
    v_accvgpr_read_b32 v79, a92
    v_accvgpr_read_b32 v36, a93
    v_accvgpr_read_b32 v37, a94
    v_accvgpr_read_b32 v39, a95
    v_accvgpr_read_b32 v24, a96
    v_accvgpr_read_b32 v25, a97
    v_accvgpr_read_b32 v27, a98
    s_movk_i32 s59, 6
    s_call_b64 s[66:67], L_ko
    s_waitcnt vmcnt(12)
    buffer_load_dwordx4 a[84:87], v1, s[4:7], s50 offen offset:0 nt
    buffer_load_dwordx4 a[88:91], v1, s[4:7], s50 offen offset:128 nt
    buffer_load_dwordx4 a[92:95], v1, s[4:7], s50 offen offset:256 nt
    s_bitcmp1_b32 s51, 21
    s_cselect_b32 s50, s63, s1
    s_add_u32 s50, s50, s51
    s_add_u32 s51, s51, 49152
    v_mfma_f32_16x16x32_bf16 v[20:23], a[12:15], a[0:3], 0
    v_mfma_f32_16x16x32_bf16 v[20:23], a[16:19], a[4:7], v[20:23]
    v_mfma_f32_16x16x32_bf16 v[20:23], a[20:23], a[8:11], v[20:23]
    s_call_b64 s[66:67], L_kat
    v_and_b32 v24, v4, v34
    v_and_b32 v25, v5, v34
    v_and_b32 v26, v6, v34
    v_and_b32 v27, v7, v34
    s_waitcnt vmcnt(12)
    s_nop 1
    v_mfma_f32_16x16x32_bf16 v[8:11], v[24:27], v[64:67], v[8:11]
    v_mfma_f32_16x16x32_bf16 v[12:15], v[24:27], v[68:71], v[12:15]
    v_mfma_f32_16x16x32_bf16 v[16:19], v[24:27], v[72:75], v[16:19]
    s_waitcnt vmcnt(9)
    buffer_load_dwordx4 a[48:51], v1, s[4:7], s50 offen offset:0 nt
    buffer_load_dwordx4 a[52:55], v1, s[4:7], s50 offen offset:128 nt
    buffer_load_dwordx4 a[56:59], v1, s[4:7], s50 offen offset:256 nt
    s_add_u32 s50, s48, 393216
    s_cmp_ge_u32 s50, s53
    s_cselect_b32 s62, 2064384, 0
    s_sub_u32 s50, s50, s62
    buffer_load_dwordx4 a[24:27], v2, s[8:11], s50 offen offset:0 nt
    buffer_load_dwordx4 a[28:31], v2, s[8:11], s50 offen offset:128 nt
    buffer_load_dwordx4 a[32:35], v2, s[8:11], s50 offen offset:256 nt
    s_bitcmp1_b32 s51, 21
    s_cselect_b32 s50, s63, s1
    s_add_u32 s50, s50, s51
    s_add_u32 s51, s51, 49152
    v_mfma_f32_16x16x32_bf16 v[20:23], a[72:75], a[0:3], 0
    v_mfma_f32_16x16x32_bf16 v[20:23], a[76:79], a[4:7], v[20:23]
    v_mfma_f32_16x16x32_bf16 v[20:23], a[80:83], a[8:11], v[20:23]
    s_call_b64 s[66:67], L_kat
    v_accvgpr_read_b32 v76, a99
    v_accvgpr_read_b32 v77, a100
    v_accvgpr_read_b32 v79, a101
    v_accvgpr_read_b32 v36, a102
    v_accvgpr_read_b32 v37, a103
    v_accvgpr_read_b32 v39, a104
    v_accvgpr_read_b32 v24, a105
    v_accvgpr_read_b32 v25, a106
    v_accvgpr_read_b32 v27, a107
    s_movk_i32 s59, 7
    s_call_b64 s[66:67], L_ko
    s_waitcnt vmcnt(12)
    buffer_load_dwordx4 a[96:99], v1, s[4:7], s50 offen offset:0 nt
    buffer_load_dwordx4 a[100:103], v1, s[4:7], s50 offen offset:128 nt
    buffer_load_dwordx4 a[104:107], v1, s[4:7], s50 offen offset:256 nt
    s_bitcmp1_b32 s51, 21
    s_cselect_b32 s50, s63, s1
    s_add_u32 s50, s50, s51
    s_add_u32 s51, s51, 49152
    v_mfma_f32_16x16x32_bf16 v[20:23], a[60:63], a[0:3], 0
    v_mfma_f32_16x16x32_bf16 v[20:23], a[64:67], a[4:7], v[20:23]
    v_mfma_f32_16x16x32_bf16 v[20:23], a[68:71], a[8:11], v[20:23]
    s_call_b64 s[66:67], L_kat
    v_and_b32 v24, v4, v34
    v_and_b32 v25, v5, v34
    v_and_b32 v26, v6, v34
    v_and_b32 v27, v7, v34
    s_waitcnt vmcnt(12)
    s_nop 1
    v_mfma_f32_16x16x32_bf16 v[8:11], v[24:27], a[36:39], v[8:11]
    v_mfma_f32_16x16x32_bf16 v[12:15], v[24:27], a[40:43], v[12:15]
    v_mfma_f32_16x16x32_bf16 v[16:19], v[24:27], a[44:47], v[16:19]
    s_waitcnt vmcnt(9)
    buffer_load_dwordx4 a[72:75], v1, s[4:7], s50 offen offset:0 nt
    buffer_load_dwordx4 a[76:79], v1, s[4:7], s50 offen offset:128 nt
    buffer_load_dwordx4 a[80:83], v1, s[4:7], s50 offen offset:256 nt
    s_bitcmp1_b32 s51, 21
    s_cselect_b32 s50, s63, s1
    s_add_u32 s50, s50, s51
    s_add_u32 s51, s51, 49152
    v_mfma_f32_16x16x32_bf16 v[20:23], a[84:87], a[0:3], 0
    v_mfma_f32_16x16x32_bf16 v[20:23], a[88:91], a[4:7], v[20:23]
    v_mfma_f32_16x16x32_bf16 v[20:23], a[92:95], a[8:11], v[20:23]
    s_call_b64 s[66:67], L_kat
    v_accvgpr_read_b32 v76, a108
    v_accvgpr_read_b32 v77, a109
    v_accvgpr_read_b32 v79, a110
    v_accvgpr_read_b32 v36, a111
    v_accvgpr_read_b32 v37, a112
    v_accvgpr_read_b32 v39, a113
    v_accvgpr_read_b32 v24, a114
    v_accvgpr_read_b32 v25, a115
    v_accvgpr_read_b32 v27, a116
    s_movk_i32 s59, 8
    s_call_b64 s[66:67], L_ko
    s_waitcnt vmcnt(9)
    buffer_load_dwordx4 a[84:87], v1, s[4:7], s50 offen offset:0 nt
    buffer_load_dwordx4 a[88:91], v1, s[4:7], s50 offen offset:128 nt
    buffer_load_dwordx4 a[92:95], v1, s[4:7], s50 offen offset:256 nt
    s_bitcmp1_b32 s51, 21
    s_cselect_b32 s50, s63, s1
    s_add_u32 s50, s50, s51
    s_add_u32 s51, s51, 49152
    v_mfma_f32_16x16x32_bf16 v[20:23], a[48:51], a[0:3], 0
    v_mfma_f32_16x16x32_bf16 v[20:23], a[52:55], a[4:7], v[20:23]
    v_mfma_f32_16x16x32_bf16 v[20:23], a[56:59], a[8:11], v[20:23]
    s_call_b64 s[66:67], L_kat
    v_and_b32 v24, v4, v34
    v_and_b32 v25, v5, v34
    v_and_b32 v26, v6, v34
    v_and_b32 v27, v7, v34
    s_waitcnt vmcnt(9)
    s_nop 1
    v_mfma_f32_16x16x32_bf16 v[8:11], v[24:27], a[24:27], v[8:11]
    v_mfma_f32_16x16x32_bf16 v[12:15], v[24:27], a[28:31], v[12:15]
    v_mfma_f32_16x16x32_bf16 v[16:19], v[24:27], a[32:35], v[16:19]
    s_waitcnt vmcnt(6)
    buffer_load_dwordx4 a[60:63], v1, s[4:7], s50 offen offset:0 nt
    buffer_load_dwordx4 a[64:67], v1, s[4:7], s50 offen offset:128 nt
    buffer_load_dwordx4 a[68:71], v1, s[4:7], s50 offen offset:256 nt
    s_bitcmp1_b32 s51, 21
    s_cselect_b32 s50, s63, s1
    s_add_u32 s50, s50, s51
    s_add_u32 s51, s51, 49152
    v_mfma_f32_16x16x32_bf16 v[20:23], a[96:99], a[0:3], 0
    v_mfma_f32_16x16x32_bf16 v[20:23], a[100:103], a[4:7], v[20:23]
    v_mfma_f32_16x16x32_bf16 v[20:23], a[104:107], a[8:11], v[20:23]
    s_call_b64 s[66:67], L_kat
    v_accvgpr_read_b32 v76, a117
    v_accvgpr_read_b32 v77, a118
    v_accvgpr_read_b32 v79, a119
    v_accvgpr_read_b32 v36, a120
    v_accvgpr_read_b32 v37, a121
    v_accvgpr_read_b32 v39, a122
    v_accvgpr_read_b32 v24, a123
    v_accvgpr_read_b32 v25, a124
    v_accvgpr_read_b32 v27, a125
    s_movk_i32 s59, 11
    s_call_b64 s[66:67], L_ko
    s_waitcnt vmcnt(6)
    buffer_load_dwordx4 a[108:111], v1, s[4:7], s50 offen offset:0 nt
    buffer_load_dwordx4 a[112:115], v1, s[4:7], s50 offen offset:128 nt
    buffer_load_dwordx4 a[116:119], v1, s[4:7], s50 offen offset:256 nt
    s_bitcmp1_b32 s51, 21
    s_cselect_b32 s50, s63, s1
    s_add_u32 s50, s50, s51
    s_add_u32 s51, s51, 49152
    v_mfma_f32_16x16x32_bf16 v[20:23], a[72:75], a[0:3], 0
    v_mfma_f32_16x16x32_bf16 v[20:23], a[76:79], a[4:7], v[20:23]
    v_mfma_f32_16x16x32_bf16 v[20:23], a[80:83], a[8:11], v[20:23]
    s_call_b64 s[66:67], L_kat
    v_accvgpr_read_b32 v76, a126
    v_accvgpr_read_b32 v77, a127
    v_accvgpr_read_b32 v79, a128
    v_accvgpr_read_b32 v36, a129
    v_accvgpr_read_b32 v37, a130
    v_accvgpr_read_b32 v39, a131
    v_accvgpr_read_b32 v24, a132
    v_accvgpr_read_b32 v25, a133
    v_accvgpr_read_b32 v27, a134
    s_movk_i32 s59, 38
    s_call_b64 s[66:67], L_vo
    s_waitcnt vmcnt(6)
    buffer_load_dwordx4 a[120:123], v1, s[4:7], s50 offen offset:0 nt
    buffer_load_dwordx4 a[124:127], v1, s[4:7], s50 offen offset:128 nt
    buffer_load_dwordx4 a[128:131], v1, s[4:7], s50 offen offset:256 nt
    s_bitcmp1_b32 s51, 21
    s_cselect_b32 s50, s63, s1
    s_add_u32 s50, s50, s51
    s_add_u32 s51, s51, 49152
    v_mfma_f32_16x16x32_bf16 v[20:23], a[84:87], a[0:3], 0
    v_mfma_f32_16x16x32_bf16 v[20:23], a[88:91], a[4:7], v[20:23]
    v_mfma_f32_16x16x32_bf16 v[20:23], a[92:95], a[8:11], v[20:23]
    s_call_b64 s[66:67], L_kat
    s_waitcnt vmcnt(6)
    buffer_load_dwordx4 a[96:99], v1, s[4:7], s50 offen offset:0 nt
    buffer_load_dwordx4 a[100:103], v1, s[4:7], s50 offen offset:128 nt
    buffer_load_dwordx4 a[104:107], v1, s[4:7], s50 offen offset:256 nt
    s_bitcmp1_b32 s51, 21
    s_cselect_b32 s50, s63, s1
    s_add_u32 s50, s50, s51
    s_add_u32 s51, s51, 49152
    v_mfma_f32_16x16x32_bf16 v[20:23], a[60:63], a[0:3], 0
    v_mfma_f32_16x16x32_bf16 v[20:23], a[64:67], a[4:7], v[20:23]
    v_mfma_f32_16x16x32_bf16 v[20:23], a[68:71], a[8:11], v[20:23]
    s_call_b64 s[66:67], L_kat
    v_accvgpr_read_b32 v76, a135
    v_accvgpr_read_b32 v77, a136
    v_accvgpr_read_b32 v79, a137
    v_accvgpr_read_b32 v36, a138
    v_accvgpr_read_b32 v37, a139
    v_accvgpr_read_b32 v39, a140
    v_accvgpr_read_b32 v24, a141
    v_accvgpr_read_b32 v25, a142
    v_accvgpr_read_b32 v27, a143
    s_movk_i32 s59, 12
    s_call_b64 s[66:67], L_ko
    s_waitcnt vmcnt(6)
    buffer_load_dwordx4 a[132:135], v1, s[4:7], s50 offen offset:0 nt
    buffer_load_dwordx4 a[136:139], v1, s[4:7], s50 offen offset:128 nt
    buffer_load_dwordx4 a[140:143], v1, s[4:7], s50 offen offset:256 nt
    s_bitcmp1_b32 s51, 21
    s_cselect_b32 s50, s63, s1
    s_add_u32 s50, s50, s51
    s_add_u32 s51, s51, 49152
    v_mfma_f32_16x16x32_bf16 v[20:23], a[108:111], a[0:3], 0
    v_mfma_f32_16x16x32_bf16 v[20:23], a[112:115], a[4:7], v[20:23]
    v_mfma_f32_16x16x32_bf16 v[20:23], a[116:119], a[8:11], v[20:23]
    s_call_b64 s[66:67], L_kat
    s_waitcnt vmcnt(6)
    buffer_load_dwordx4 a[108:111], v1, s[4:7], s50 offen offset:0 nt
    buffer_load_dwordx4 a[112:115], v1, s[4:7], s50 offen offset:128 nt
    buffer_load_dwordx4 a[116:119], v1, s[4:7], s50 offen offset:256 nt
    s_bitcmp1_b32 s51, 21
    s_cselect_b32 s50, s63, s1
    s_add_u32 s50, s50, s51
    s_add_u32 s51, s51, 49152
    v_mfma_f32_16x16x32_bf16 v[20:23], a[120:123], a[0:3], 0
    v_mfma_f32_16x16x32_bf16 v[20:23], a[124:127], a[4:7], v[20:23]
    v_mfma_f32_16x16x32_bf16 v[20:23], a[128:131], a[8:11], v[20:23]
    s_call_b64 s[66:67], L_kat
    v_accvgpr_read_b32 v76, a144
    v_accvgpr_read_b32 v77, a145
    v_accvgpr_read_b32 v79, a146
    v_accvgpr_read_b32 v36, a147
    v_accvgpr_read_b32 v37, a148
    v_accvgpr_read_b32 v39, a149
    v_accvgpr_read_b32 v24, a150
    v_accvgpr_read_b32 v25, a151
    v_accvgpr_read_b32 v27, a152
    s_movk_i32 s59, 39
    s_call_b64 s[66:67], L_vo
    s_waitcnt vmcnt(6)
    buffer_load_dwordx4 a[120:123], v1, s[4:7], s50 offen offset:0 nt
    buffer_load_dwordx4 a[124:127], v1, s[4:7], s50 offen offset:128 nt
    buffer_load_dwordx4 a[128:131], v1, s[4:7], s50 offen offset:256 nt
    s_bitcmp1_b32 s51, 21
    s_cselect_b32 s50, s63, s1
    s_add_u32 s50, s50, s51
    s_add_u32 s51, s51, 49152
    v_mfma_f32_16x16x32_bf16 v[20:23], a[96:99], a[0:3], 0
    v_mfma_f32_16x16x32_bf16 v[20:23], a[100:103], a[4:7], v[20:23]
    v_mfma_f32_16x16x32_bf16 v[20:23], a[104:107], a[8:11], v[20:23]
    s_call_b64 s[66:67], L_kat
    v_accvgpr_read_b32 v76, a153
    v_accvgpr_read_b32 v77, a154
    v_accvgpr_read_b32 v79, a155
    v_accvgpr_read_b32 v36, a156
    v_accvgpr_read_b32 v37, a157
    v_accvgpr_read_b32 v39, a158
    v_accvgpr_read_b32 v24, a159
    v_accvgpr_read_b32 v25, a160
    v_accvgpr_read_b32 v27, a161
    s_movk_i32 s59, 13
    s_call_b64 s[66:67], L_ko
    s_waitcnt vmcnt(6)
    buffer_load_dwordx4 a[144:147], v1, s[4:7], s50 offen offset:0 nt
    buffer_load_dwordx4 a[148:151], v1, s[4:7], s50 offen offset:128 nt
    buffer_load_dwordx4 a[152:155], v1, s[4:7], s50 offen offset:256 nt
    s_bfe_u32 s60, s98, 0x1000f
    s_xor_b32 s60, s60, s46
    s_and_b32 s60, s60, 1
    s_lshl_b32 s60, s60, 21
    s_add_u32 s60, s60, 24576
    s_add_u32 s61, s46, 2
    s_and_b32 s61, s61, 3
    s_and_b32 s62, s2, 8
    s_lshl1_add_u32 s61, s61, s62
    s_lshl_b32 s61, s61, 1
    s_lshr_b32 s61, 0xc571b260, s61
    s_lshr_b32 s62, s2, 2
    s_xor_b32 s62, s62, s46
    s_lshl_b32 s62, s62, 3
    s_xor_b32 s61, s61, s62
    s_and_b32 s61, s61, 15
    s_xor_b32 s62, s61, 8
    s_mul_i32 s61, s61, 3072
    s_mul_i32 s62, s62, 3072
    s_sub_u32 s1, s61, s60
    s_sub_u32 s63, s62, s60
    s_bitcmp1_b32 s51, 21
    s_cselect_b32 s50, s63, s1
    s_add_u32 s50, s50, s51
    s_add_u32 s51, s51, 49152
    v_mfma_f32_16x16x32_bf16 v[20:23], a[132:135], a[0:3], 0
    v_mfma_f32_16x16x32_bf16 v[20:23], a[136:139], a[4:7], v[20:23]
    v_mfma_f32_16x16x32_bf16 v[20:23], a[140:143], a[8:11], v[20:23]
    s_call_b64 s[66:67], L_kat
    s_waitcnt vmcnt(6)
    buffer_load_dwordx4 a[132:135], v1, s[4:7], s50 offen offset:0 nt
    buffer_load_dwordx4 a[136:139], v1, s[4:7], s50 offen offset:128 nt
    buffer_load_dwordx4 a[140:143], v1, s[4:7], s50 offen offset:256 nt
    s_bitcmp1_b32 s51, 21
    s_cselect_b32 s50, s63, s1
    s_add_u32 s50, s50, s51
    s_add_u32 s51, s51, 49152
    v_mfma_f32_16x16x32_bf16 v[20:23], a[108:111], a[0:3], 0
    v_mfma_f32_16x16x32_bf16 v[20:23], a[112:115], a[4:7], v[20:23]
    v_mfma_f32_16x16x32_bf16 v[20:23], a[116:119], a[8:11], v[20:23]
    s_call_b64 s[66:67], L_kat
    v_accvgpr_read_b32 v76, a162
    v_accvgpr_read_b32 v77, a163
    v_accvgpr_read_b32 v79, a164
    v_accvgpr_read_b32 v36, a165
    v_accvgpr_read_b32 v37, a166
    v_accvgpr_read_b32 v39, a167
    v_accvgpr_read_b32 v24, a168
    v_accvgpr_read_b32 v25, a169
    v_accvgpr_read_b32 v27, a170
    s_movk_i32 s59, 40
    s_call_b64 s[66:67], L_vo
    s_waitcnt vmcnt(6)
    buffer_load_dwordx4 a[156:159], v1, s[4:7], s50 offen offset:0 nt
    buffer_load_dwordx4 a[160:163], v1, s[4:7], s50 offen offset:128 nt
    buffer_load_dwordx4 a[164:167], v1, s[4:7], s50 offen offset:256 nt
    s_add_u32 s50, s48, 1769472
    s_cmp_ge_u32 s50, s53
    s_cselect_b32 s62, 2064384, 0
    s_sub_u32 s50, s50, s62
    v_mfma_f32_16x16x32_bf16 v[20:23], a[120:123], a[0:3], 0
    v_mfma_f32_16x16x32_bf16 v[20:23], a[124:127], a[4:7], v[20:23]
    v_mfma_f32_16x16x32_bf16 v[20:23], a[128:131], a[8:11], v[20:23]
    s_call_b64 s[66:67], L_kat
    s_waitcnt vmcnt(6)
    buffer_load_dwordx4 a[120:123], v1, s[4:7], s50 offen offset:0 nt
    buffer_load_dwordx4 a[124:127], v1, s[4:7], s50 offen offset:128 nt
    buffer_load_dwordx4 a[128:131], v1, s[4:7], s50 offen offset:256 nt
    s_add_u32 s50, s48, 1769472
    s_cmp_ge_u32 s50, s53
    s_cselect_b32 s62, 2064384, 0
    s_sub_u32 s50, s50, s62
    v_mfma_f32_16x16x32_bf16 v[20:23], a[144:147], a[0:3], 0
    v_mfma_f32_16x16x32_bf16 v[20:23], a[148:151], a[4:7], v[20:23]
    v_mfma_f32_16x16x32_bf16 v[20:23], a[152:155], a[8:11], v[20:23]
    s_call_b64 s[66:67], L_kat
    v_accvgpr_read_b32 v76, a171
    v_accvgpr_read_b32 v77, a172
    v_accvgpr_read_b32 v79, a173
    v_accvgpr_read_b32 v36, a174
    v_accvgpr_read_b32 v37, a175
    v_accvgpr_read_b32 v39, a176
    v_accvgpr_read_b32 v24, a177
    v_accvgpr_read_b32 v25, a178
    v_accvgpr_read_b32 v27, a179
    s_movk_i32 s59, 14
    s_call_b64 s[66:67], L_ko
    s_waitcnt vmcnt(6)
    buffer_load_dwordx4 a[168:171], v2, s[8:11], s50 offen offset:0 nt
    buffer_load_dwordx4 a[172:175], v2, s[8:11], s50 offen offset:128 nt
    buffer_load_dwordx4 a[176:179], v2, s[8:11], s50 offen offset:256 nt
    s_bitcmp1_b32 s51, 21
    s_cselect_b32 s50, s63, s1
    s_add_u32 s50, s50, s51
    s_add_u32 s51, s51, 49152
    v_mfma_f32_16x16x32_bf16 v[20:23], a[132:135], a[0:3], 0
    v_mfma_f32_16x16x32_bf16 v[20:23], a[136:139], a[4:7], v[20:23]
    v_mfma_f32_16x16x32_bf16 v[20:23], a[140:143], a[8:11], v[20:23]
    s_call_b64 s[66:67], L_kat
    s_waitcnt vmcnt(6)
    buffer_load_dwordx4 a[144:147], v1, s[4:7], s50 offen offset:0 nt
    buffer_load_dwordx4 a[148:151], v1, s[4:7], s50 offen offset:128 nt
    buffer_load_dwordx4 a[152:155], v1, s[4:7], s50 offen offset:256 nt
    s_bitcmp1_b32 s51, 21
    s_cselect_b32 s50, s63, s1
    s_add_u32 s50, s50, s51
    s_add_u32 s51, s51, 49152
    v_mfma_f32_16x16x32_bf16 v[20:23], a[156:159], a[0:3], 0
    v_mfma_f32_16x16x32_bf16 v[20:23], a[160:163], a[4:7], v[20:23]
    v_mfma_f32_16x16x32_bf16 v[20:23], a[164:167], a[8:11], v[20:23]
    s_call_b64 s[66:67], L_kat
    v_accvgpr_read_b32 v76, a180
    v_accvgpr_read_b32 v77, a181
    v_accvgpr_read_b32 v79, a182
    v_accvgpr_read_b32 v36, a183
    v_accvgpr_read_b32 v37, a184
    v_accvgpr_read_b32 v39, a185
    v_accvgpr_read_b32 v24, a186
    v_accvgpr_read_b32 v25, a187
    v_accvgpr_read_b32 v27, a188
    s_movk_i32 s59, 41
    s_call_b64 s[66:67], L_vo
    s_waitcnt vmcnt(6)
    buffer_load_dwordx4 a[156:159], v1, s[4:7], s50 offen offset:0 nt
    buffer_load_dwordx4 a[160:163], v1, s[4:7], s50 offen offset:128 nt
    buffer_load_dwordx4 a[164:167], v1, s[4:7], s50 offen offset:256 nt
    s_bitcmp1_b32 s51, 21
    s_cselect_b32 s50, s63, s1
    s_add_u32 s50, s50, s51
    s_add_u32 s51, s51, 49152
    v_mfma_f32_16x16x32_bf16 v[20:23], a[120:123], a[240:243], 0
    v_mfma_f32_16x16x32_bf16 v[20:23], a[124:127], a[244:247], v[20:23]
    v_mfma_f32_16x16x32_bf16 v[20:23], a[128:131], a[248:251], v[20:23]
    s_call_b64 s[66:67], L_kot
    v_and_b32 v24, v4, v34
    v_and_b32 v25, v5, v34
    v_and_b32 v26, v6, v34
    v_and_b32 v27, v7, v34
    s_waitcnt vmcnt(6)
    buffer_load_dwordx4 a[132:135], v1, s[4:7], s50 offen offset:0 nt
    buffer_load_dwordx4 a[136:139], v1, s[4:7], s50 offen offset:128 nt
    buffer_load_dwordx4 a[140:143], v1, s[4:7], s50 offen offset:256 nt
    s_bitcmp1_b32 s51, 21
    s_cselect_b32 s50, s63, s1
    s_add_u32 s50, s50, s51
    s_add_u32 s51, s51, 49152
    s_nop 1
    v_mfma_f32_16x16x32_bf16 v[8:11], v[24:27], a[168:171], v[8:11]
    v_mfma_f32_16x16x32_bf16 v[12:15], v[24:27], a[172:175], v[12:15]
    v_mfma_f32_16x16x32_bf16 v[16:19], v[24:27], a[176:179], v[16:19]
    s_waitcnt vmcnt(6)
    buffer_load_dwordx4 a[168:171], v1, s[4:7], s50 offen offset:0 nt
    buffer_load_dwordx4 a[172:175], v1, s[4:7], s50 offen offset:128 nt
    buffer_load_dwordx4 a[176:179], v1, s[4:7], s50 offen offset:256 nt
    s_bitcmp1_b32 s51, 21
    s_cselect_b32 s50, s63, s1
    s_add_u32 s50, s50, s51
    s_add_u32 s51, s51, 49152
    v_mfma_f32_16x16x32_bf16 v[20:23], a[144:147], a[0:3], 0
    v_mfma_f32_16x16x32_bf16 v[20:23], a[148:151], a[4:7], v[20:23]
    v_mfma_f32_16x16x32_bf16 v[20:23], a[152:155], a[8:11], v[20:23]
    s_call_b64 s[66:67], L_kat
    v_accvgpr_read_b32 v76, a189
    v_accvgpr_read_b32 v77, a190
    v_accvgpr_read_b32 v79, a191
    v_accvgpr_read_b32 v36, a192
    v_accvgpr_read_b32 v37, a193
    v_accvgpr_read_b32 v39, a194
    v_accvgpr_read_b32 v24, a195
    v_accvgpr_read_b32 v25, a196
    v_accvgpr_read_b32 v27, a197
    s_movk_i32 s59, 15
    s_call_b64 s[66:67], L_ko
    s_waitcnt vmcnt(6)
    buffer_load_dwordx4 a[180:183], v1, s[4:7], s50 offen offset:0 nt
    buffer_load_dwordx4 a[184:187], v1, s[4:7], s50 offen offset:128 nt
    buffer_load_dwordx4 a[188:191], v1, s[4:7], s50 offen offset:256 nt
    s_bitcmp1_b32 s51, 21
    s_cselect_b32 s50, s63, s1
    s_add_u32 s50, s50, s51
    s_add_u32 s51, s51, 49152
    v_mfma_f32_16x16x32_bf16 v[20:23], a[156:159], a[0:3], 0
    v_mfma_f32_16x16x32_bf16 v[20:23], a[160:163], a[4:7], v[20:23]
    v_mfma_f32_16x16x32_bf16 v[20:23], a[164:167], a[8:11], v[20:23]
    s_call_b64 s[66:67], L_kat
    s_waitcnt vmcnt(6)
    buffer_load_dwordx4 a[156:159], v1, s[4:7], s50 offen offset:0 nt
    buffer_load_dwordx4 a[160:163], v1, s[4:7], s50 offen offset:128 nt
    buffer_load_dwordx4 a[164:167], v1, s[4:7], s50 offen offset:256 nt
    s_bitcmp1_b32 s51, 21
    s_cselect_b32 s50, s63, s1
    s_add_u32 s50, s50, s51
    s_add_u32 s51, s51, 49152
    v_mfma_f32_16x16x32_bf16 v[20:23], a[132:135], a[0:3], 0
    v_mfma_f32_16x16x32_bf16 v[20:23], a[136:139], a[4:7], v[20:23]
    v_mfma_f32_16x16x32_bf16 v[20:23], a[140:143], a[8:11], v[20:23]
    s_call_b64 s[66:67], L_kat
    v_accvgpr_read_b32 v76, a198
    v_accvgpr_read_b32 v77, a199
    v_accvgpr_read_b32 v79, a200
    v_accvgpr_read_b32 v36, a201
    v_accvgpr_read_b32 v37, a202
    v_accvgpr_read_b32 v39, a203
    v_accvgpr_read_b32 v24, a204
    v_accvgpr_read_b32 v25, a205
    v_accvgpr_read_b32 v27, a206
    s_movk_i32 s59, 42
    s_call_b64 s[66:67], L_vo
    s_waitcnt vmcnt(6)
    buffer_load_dwordx4 a[192:195], v1, s[4:7], s50 offen offset:0 nt
    buffer_load_dwordx4 a[196:199], v1, s[4:7], s50 offen offset:128 nt
    buffer_load_dwordx4 a[200:203], v1, s[4:7], s50 offen offset:256 nt
    s_bitcmp1_b32 s51, 21
    s_cselect_b32 s50, s63, s1
    s_add_u32 s50, s50, s51
    s_add_u32 s51, s51, 49152
    v_mfma_f32_16x16x32_bf16 v[20:23], a[168:171], a[0:3], 0
    v_mfma_f32_16x16x32_bf16 v[20:23], a[172:175], a[4:7], v[20:23]
    v_mfma_f32_16x16x32_bf16 v[20:23], a[176:179], a[8:11], v[20:23]
    s_call_b64 s[66:67], L_kat
    s_waitcnt vmcnt(6)
    buffer_load_dwordx4 a[168:171], v1, s[4:7], s50 offen offset:0 nt
    buffer_load_dwordx4 a[172:175], v1, s[4:7], s50 offen offset:128 nt
    buffer_load_dwordx4 a[176:179], v1, s[4:7], s50 offen offset:256 nt
    s_bitcmp1_b32 s51, 21
    s_cselect_b32 s50, s63, s1
    s_add_u32 s50, s50, s51
    s_add_u32 s51, s51, 49152
    v_mfma_f32_16x16x32_bf16 v[20:23], a[180:183], a[0:3], 0
    v_mfma_f32_16x16x32_bf16 v[20:23], a[184:187], a[4:7], v[20:23]
    v_mfma_f32_16x16x32_bf16 v[20:23], a[188:191], a[8:11], v[20:23]
    s_call_b64 s[66:67], L_kat
    v_accvgpr_read_b32 v76, a207
    v_accvgpr_read_b32 v77, a208
    v_accvgpr_read_b32 v79, a209
    v_accvgpr_read_b32 v36, a210
    v_accvgpr_read_b32 v37, a211
    v_accvgpr_read_b32 v39, a212
    v_accvgpr_read_b32 v24, a213
    v_accvgpr_read_b32 v25, a214
    v_accvgpr_read_b32 v27, a215
    s_movk_i32 s59, 16
    s_call_b64 s[66:67], L_ko
    s_waitcnt vmcnt(6)
    buffer_load_dwordx4 a[204:207], v1, s[4:7], s50 offen offset:0 nt
    buffer_load_dwordx4 a[208:211], v1, s[4:7], s50 offen offset:128 nt
    buffer_load_dwordx4 a[212:215], v1, s[4:7], s50 offen offset:256 nt
    s_bitcmp1_b32 s51, 21
    s_cselect_b32 s50, s63, s1
    s_add_u32 s50, s50, s51
    s_add_u32 s51, s51, 49152
    v_mfma_f32_16x16x32_bf16 v[20:23], a[156:159], a[0:3], 0
    v_mfma_f32_16x16x32_bf16 v[20:23], a[160:163], a[4:7], v[20:23]
    v_mfma_f32_16x16x32_bf16 v[20:23], a[164:167], a[8:11], v[20:23]
    s_call_b64 s[66:67], L_kat
    v_accvgpr_read_b32 v76, a216
    v_accvgpr_read_b32 v77, a217
    v_accvgpr_read_b32 v79, a218
    v_accvgpr_read_b32 v36, a219
    v_accvgpr_read_b32 v37, a220
    v_accvgpr_read_b32 v39, a221
    v_accvgpr_read_b32 v24, a222
    v_accvgpr_read_b32 v25, a223
    v_accvgpr_read_b32 v27, a224
    s_movk_i32 s59, 43
    s_call_b64 s[66:67], L_vo
    s_waitcnt vmcnt(6)
    buffer_load_dwordx4 a[180:183], v1, s[4:7], s50 offen offset:0 nt
    buffer_load_dwordx4 a[184:187], v1, s[4:7], s50 offen offset:128 nt
    buffer_load_dwordx4 a[188:191], v1, s[4:7], s50 offen offset:256 nt
    s_bitcmp1_b32 s51, 21
    s_cselect_b32 s50, s63, s1
    s_add_u32 s50, s50, s51
    s_add_u32 s51, s51, 49152
    v_mfma_f32_16x16x32_bf16 v[20:23], a[192:195], a[0:3], 0
    v_mfma_f32_16x16x32_bf16 v[20:23], a[196:199], a[4:7], v[20:23]
    v_mfma_f32_16x16x32_bf16 v[20:23], a[200:203], a[8:11], v[20:23]
    s_call_b64 s[66:67], L_kat
    s_waitcnt vmcnt(6)
    buffer_load_dwordx4 a[192:195], v1, s[4:7], s50 offen offset:0 nt
    buffer_load_dwordx4 a[196:199], v1, s[4:7], s50 offen offset:128 nt
    buffer_load_dwordx4 a[200:203], v1, s[4:7], s50 offen offset:256 nt
    s_add_u32 s50, s58, 1818624
    s_cmp_ge_u32 s50, s53
    s_cselect_b32 s62, 2064384, 0
    s_sub_u32 s50, s50, s62
    v_mfma_f32_16x16x32_bf16 v[20:23], a[168:171], a[0:3], 0
    v_mfma_f32_16x16x32_bf16 v[20:23], a[172:175], a[4:7], v[20:23]
    v_mfma_f32_16x16x32_bf16 v[20:23], a[176:179], a[8:11], v[20:23]
    s_call_b64 s[66:67], L_kat
    v_accvgpr_read_b32 v76, a225
    v_accvgpr_read_b32 v77, a226
    v_accvgpr_read_b32 v79, a227
    v_accvgpr_read_b32 v36, a228
    v_accvgpr_read_b32 v37, a229
    v_accvgpr_read_b32 v39, a230
    v_accvgpr_read_b32 v24, a231
    v_accvgpr_read_b32 v25, a232
    v_accvgpr_read_b32 v27, a233
    s_movk_i32 s59, 17
    s_call_b64 s[66:67], L_ko
    s_waitcnt vmcnt(6)
    buffer_load_dwordx4 a[216:219], v1, s[4:7], s50 offen offset:0 nt
    buffer_load_dwordx4 a[220:223], v1, s[4:7], s50 offen offset:128 nt
    buffer_load_dwordx4 a[224:227], v1, s[4:7], s50 offen offset:256 nt
    s_add_u32 s50, s58, 1818624
    s_cmp_ge_u32 s50, s53
    s_cselect_b32 s62, 2064384, 0
    s_sub_u32 s50, s50, s62
    v_mfma_f32_16x16x32_bf16 v[20:23], a[204:207], a[0:3], 0
    v_mfma_f32_16x16x32_bf16 v[20:23], a[208:211], a[4:7], v[20:23]
    v_mfma_f32_16x16x32_bf16 v[20:23], a[212:215], a[8:11], v[20:23]
    s_call_b64 s[66:67], L_kat
    s_waitcnt vmcnt(6)
    buffer_load_dwordx4 a[204:207], v2, s[8:11], s50 offen offset:0 nt
    buffer_load_dwordx4 a[208:211], v2, s[8:11], s50 offen offset:128 nt
    buffer_load_dwordx4 a[212:215], v2, s[8:11], s50 offen offset:256 nt
    s_bitcmp1_b32 s51, 21
    s_cselect_b32 s50, s63, s1
    s_add_u32 s50, s50, s51
    s_add_u32 s51, s51, 49152
    v_mfma_f32_16x16x32_bf16 v[20:23], a[180:183], a[0:3], 0
    v_mfma_f32_16x16x32_bf16 v[20:23], a[184:187], a[4:7], v[20:23]
    v_mfma_f32_16x16x32_bf16 v[20:23], a[188:191], a[8:11], v[20:23]
    s_call_b64 s[66:67], L_kat
    v_accvgpr_read_b32 v76, a234
    v_accvgpr_read_b32 v77, a235
    v_accvgpr_read_b32 v79, a236
    v_accvgpr_read_b32 v36, a237
    v_accvgpr_read_b32 v37, a238
    v_accvgpr_read_b32 v39, a239
    v_accvgpr_read_b32 v24, a252
    v_accvgpr_read_b32 v25, a253
    v_accvgpr_read_b32 v27, a254
    s_movk_i32 s59, 44
    s_call_b64 s[66:67], L_vo
    s_waitcnt vmcnt(6)
    buffer_load_dwordx4 a[228:231], v1, s[4:7], s50 offen offset:0 nt
    buffer_load_dwordx4 a[232:235], v1, s[4:7], s50 offen offset:128 nt
    buffer_load_dwordx4 a[236:239], v1, s[4:7], s50 offen offset:256 nt
    s_bitcmp1_b32 s51, 21
    s_cselect_b32 s50, s63, s1
    s_add_u32 s50, s50, s51
    s_add_u32 s51, s51, 49152
    v_mfma_f32_16x16x32_bf16 v[20:23], a[192:195], a[0:3], 0
    v_mfma_f32_16x16x32_bf16 v[20:23], a[196:199], a[4:7], v[20:23]
    v_mfma_f32_16x16x32_bf16 v[20:23], a[200:203], a[8:11], v[20:23]
    s_call_b64 s[66:67], L_kat
    s_waitcnt vmcnt(6)
    buffer_load_dwordx4 a[192:195], v1, s[4:7], s50 offen offset:0 nt
    buffer_load_dwordx4 a[196:199], v1, s[4:7], s50 offen offset:128 nt
    buffer_load_dwordx4 a[200:203], v1, s[4:7], s50 offen offset:256 nt
    s_bitcmp1_b32 s51, 21
    s_cselect_b32 s50, s63, s1
    s_add_u32 s50, s50, s51
    s_add_u32 s51, s51, 49152
    v_mfma_f32_16x16x32_bf16 v[20:23], a[216:219], a[240:243], 0
    v_mfma_f32_16x16x32_bf16 v[20:23], a[220:223], a[244:247], v[20:23]
    v_mfma_f32_16x16x32_bf16 v[20:23], a[224:227], a[248:251], v[20:23]
    s_call_b64 s[66:67], L_kot
    v_and_b32 v24, v4, v34
    v_and_b32 v25, v5, v34
    v_and_b32 v26, v6, v34
    v_and_b32 v27, v7, v34
    s_waitcnt vmcnt(6)
    buffer_load_dwordx4 a[216:219], v1, s[4:7], s50 offen offset:0 nt
    buffer_load_dwordx4 a[220:223], v1, s[4:7], s50 offen offset:128 nt
    buffer_load_dwordx4 a[224:227], v1, s[4:7], s50 offen offset:256 nt
    s_bitcmp1_b32 s51, 21
    s_cselect_b32 s50, s63, s1
    s_add_u32 s50, s50, s51
    s_add_u32 s51, s51, 49152
    s_nop 1
    v_mfma_f32_16x16x32_bf16 v[8:11], v[24:27], a[204:207], v[8:11]
    v_mfma_f32_16x16x32_bf16 v[12:15], v[24:27], a[208:211], v[12:15]
    v_mfma_f32_16x16x32_bf16 v[16:19], v[24:27], a[212:215], v[16:19]
    ds_read2st64_b32 v[76:77], v32 offset0:0 offset1:1
    ds_read_b32 v79, v32 offset:512
    ds_read2st64_b32 v[36:37], v32 offset0:3 offset1:4
    ds_read_b32 v39, v32 offset:1280
    ds_read2st64_b32 v[24:25], v32 offset0:6 offset1:7
    ds_read_b32 v27, v32 offset:2048
    s_movk_i32 s59, 18
    s_waitcnt lgkmcnt(0)
    s_call_b64 s[66:67], L_ko
    s_waitcnt vmcnt(6)
    buffer_load_dwordx4 a[204:207], v1, s[4:7], s50 offen offset:0 nt
    buffer_load_dwordx4 a[208:211], v1, s[4:7], s50 offen offset:128 nt
    buffer_load_dwordx4 a[212:215], v1, s[4:7], s50 offen offset:256 nt
    s_bitcmp1_b32 s51, 21
    s_cselect_b32 s50, s63, s1
    s_add_u32 s50, s50, s51
    s_add_u32 s51, s51, 49152
    v_mfma_f32_16x16x32_bf16 v[20:23], a[228:231], a[0:3], 0
    v_mfma_f32_16x16x32_bf16 v[20:23], a[232:235], a[4:7], v[20:23]
    v_mfma_f32_16x16x32_bf16 v[20:23], a[236:239], a[8:11], v[20:23]
    s_call_b64 s[66:67], L_kat
    s_waitcnt vmcnt(6)
    buffer_load_dwordx4 a[228:231], v1, s[4:7], s50 offen offset:0 nt
    buffer_load_dwordx4 a[232:235], v1, s[4:7], s50 offen offset:128 nt
    buffer_load_dwordx4 a[236:239], v1, s[4:7], s50 offen offset:256 nt
    s_bitcmp1_b32 s51, 21
    s_cselect_b32 s50, s63, s1
    s_add_u32 s50, s50, s51
    s_add_u32 s51, s51, 49152
    v_mfma_f32_16x16x32_bf16 v[20:23], a[192:195], a[0:3], 0
    v_mfma_f32_16x16x32_bf16 v[20:23], a[196:199], a[4:7], v[20:23]
    v_mfma_f32_16x16x32_bf16 v[20:23], a[200:203], a[8:11], v[20:23]
    s_call_b64 s[66:67], L_kat
    ds_read2st64_b32 v[76:77], v32 offset0:9 offset1:10
    ds_read_b32 v79, v32 offset:2816
    ds_read2st64_b32 v[36:37], v32 offset0:12 offset1:13
    ds_read_b32 v39, v32 offset:3584
    ds_read2st64_b32 v[24:25], v32 offset0:15 offset1:16
    ds_read_b32 v27, v32 offset:4352
    s_movk_i32 s59, 45
    s_waitcnt lgkmcnt(0)
    s_call_b64 s[66:67], L_vo
    s_waitcnt vmcnt(6)
    buffer_load_dwordx4 a[192:195], v1, s[4:7], s50 offen offset:0 nt
    buffer_load_dwordx4 a[196:199], v1, s[4:7], s50 offen offset:128 nt
    buffer_load_dwordx4 a[200:203], v1, s[4:7], s50 offen offset:256 nt
    s_bitcmp1_b32 s51, 21
    s_cselect_b32 s50, s63, s1
    s_add_u32 s50, s50, s51
    s_add_u32 s51, s51, 49152
    v_mfma_f32_16x16x32_bf16 v[20:23], a[216:219], a[0:3], 0
    v_mfma_f32_16x16x32_bf16 v[20:23], a[220:223], a[4:7], v[20:23]
    v_mfma_f32_16x16x32_bf16 v[20:23], a[224:227], a[8:11], v[20:23]
    s_call_b64 s[66:67], L_kat
    s_waitcnt vmcnt(6)
    buffer_load_dwordx4 a[216:219], v1, s[4:7], s50 offen offset:0 nt
    buffer_load_dwordx4 a[220:223], v1, s[4:7], s50 offen offset:128 nt
    buffer_load_dwordx4 a[224:227], v1, s[4:7], s50 offen offset:256 nt
    s_bitcmp1_b32 s51, 21
    s_cselect_b32 s50, s63, s1
    s_add_u32 s50, s50, s51
    s_add_u32 s51, s51, 49152
    v_mfma_f32_16x16x32_bf16 v[20:23], a[204:207], a[0:3], 0
    v_mfma_f32_16x16x32_bf16 v[20:23], a[208:211], a[4:7], v[20:23]
    v_mfma_f32_16x16x32_bf16 v[20:23], a[212:215], a[8:11], v[20:23]
    s_call_b64 s[66:67], L_kat
    ds_read2st64_b32 v[76:77], v32 offset0:18 offset1:19
    ds_read_b32 v79, v32 offset:5120
    ds_read2st64_b32 v[36:37], v32 offset0:21 offset1:22
    ds_read_b32 v39, v32 offset:5888
    ds_read2st64_b32 v[24:25], v32 offset0:24 offset1:25
    ds_read_b32 v27, v32 offset:6656
    s_movk_i32 s59, 19
    s_waitcnt lgkmcnt(0)
    s_call_b64 s[66:67], L_ko
    s_waitcnt vmcnt(6)
    buffer_load_dwordx4 a[204:207], v1, s[4:7], s50 offen offset:0 nt
    buffer_load_dwordx4 a[208:211], v1, s[4:7], s50 offen offset:128 nt
    buffer_load_dwordx4 a[212:215], v1, s[4:7], s50 offen offset:256 nt
    s_bfe_u32 s60, s98, 0x1000f
    s_xor_b32 s60, s60, s46
    s_and_b32 s60, s60, 1
    s_lshl_b32 s60, s60, 21
    s_add_u32 s60, s60, 24576
    s_add_u32 s61, s46, 3
    s_and_b32 s61, s61, 3
    s_and_b32 s62, s2, 8
    s_lshl1_add_u32 s61, s61, s62
    s_lshl_b32 s61, s61, 1
    s_lshr_b32 s61, 0xc571b260, s61
    s_lshr_b32 s62, s2, 2
    s_xor_b32 s62, s62, s46
    s_lshl_b32 s62, s62, 3
    s_xor_b32 s61, s61, s62
    s_and_b32 s61, s61, 15
    s_xor_b32 s62, s61, 8
    s_mul_i32 s61, s61, 3072
    s_mul_i32 s62, s62, 3072
    s_sub_u32 s1, s61, s60
    s_sub_u32 s63, s62, s60
    s_bitcmp1_b32 s51, 21
    s_cselect_b32 s50, s63, s1
    s_add_u32 s50, s50, s51
    s_add_u32 s51, s51, 49152
    v_mfma_f32_16x16x32_bf16 v[20:23], a[228:231], a[0:3], 0
    v_mfma_f32_16x16x32_bf16 v[20:23], a[232:235], a[4:7], v[20:23]
    v_mfma_f32_16x16x32_bf16 v[20:23], a[236:239], a[8:11], v[20:23]
    s_call_b64 s[66:67], L_kat
    s_waitcnt vmcnt(6)
    buffer_load_dwordx4 a[228:231], v1, s[4:7], s50 offen offset:0 nt
    buffer_load_dwordx4 a[232:235], v1, s[4:7], s50 offen offset:128 nt
    buffer_load_dwordx4 a[236:239], v1, s[4:7], s50 offen offset:256 nt
    s_bitcmp1_b32 s51, 21
    s_cselect_b32 s50, s63, s1
    s_add_u32 s50, s50, s51
    s_add_u32 s51, s51, 49152
    v_mfma_f32_16x16x32_bf16 v[20:23], a[192:195], a[0:3], 0
    v_mfma_f32_16x16x32_bf16 v[20:23], a[196:199], a[4:7], v[20:23]
    v_mfma_f32_16x16x32_bf16 v[20:23], a[200:203], a[8:11], v[20:23]
    s_call_b64 s[66:67], L_kat
    ds_read2st64_b32 v[76:77], v32 offset0:27 offset1:28
    ds_read_b32 v79, v32 offset:7424
    ds_read2st64_b32 v[36:37], v32 offset0:30 offset1:31
    ds_read_b32 v39, v32 offset:8192
    ds_read2st64_b32 v[24:25], v32 offset0:33 offset1:34
    ds_read_b32 v27, v32 offset:8960
    s_movk_i32 s59, 46
    s_waitcnt lgkmcnt(0)
    s_call_b64 s[66:67], L_vo
    s_waitcnt vmcnt(6)
    buffer_load_dwordx4 a[192:195], v1, s[4:7], s50 offen offset:0 nt
    buffer_load_dwordx4 a[196:199], v1, s[4:7], s50 offen offset:128 nt
    buffer_load_dwordx4 a[200:203], v1, s[4:7], s50 offen offset:256 nt
    s_add_u32 s50, s48, 1867776
    s_cmp_ge_u32 s50, s53
    s_cselect_b32 s62, 2064384, 0
    s_sub_u32 s50, s50, s62
    v_mfma_f32_16x16x32_bf16 v[20:23], a[216:219], a[0:3], 0
    v_mfma_f32_16x16x32_bf16 v[20:23], a[220:223], a[4:7], v[20:23]
    v_mfma_f32_16x16x32_bf16 v[20:23], a[224:227], a[8:11], v[20:23]
    s_call_b64 s[66:67], L_kat
    ds_read2st64_b32 v[76:77], v32 offset0:36 offset1:37
    ds_read_b32 v79, v32 offset:9728
    ds_read2st64_b32 v[36:37], v32 offset0:39 offset1:40
    ds_read_b32 v39, v32 offset:10496
    ds_read2st64_b32 v[24:25], v32 offset0:42 offset1:43
    ds_read_b32 v27, v32 offset:11264
    s_movk_i32 s59, 20
    s_waitcnt lgkmcnt(0)
    s_call_b64 s[66:67], L_ko
    s_waitcnt vmcnt(6)
    buffer_load_dwordx4 a[216:219], v1, s[4:7], s50 offen offset:0 nt
    buffer_load_dwordx4 a[220:223], v1, s[4:7], s50 offen offset:128 nt
    buffer_load_dwordx4 a[224:227], v1, s[4:7], s50 offen offset:256 nt
    s_add_u32 s50, s48, 1867776
    s_cmp_ge_u32 s50, s53
    s_cselect_b32 s62, 2064384, 0
    s_sub_u32 s50, s50, s62
    v_mfma_f32_16x16x32_bf16 v[20:23], a[204:207], a[0:3], 0
    v_mfma_f32_16x16x32_bf16 v[20:23], a[208:211], a[4:7], v[20:23]
    v_mfma_f32_16x16x32_bf16 v[20:23], a[212:215], a[8:11], v[20:23]
    s_call_b64 s[66:67], L_kat
    s_waitcnt vmcnt(6)
    buffer_load_dwordx4 a[204:207], v2, s[8:11], s50 offen offset:0 nt
    buffer_load_dwordx4 a[208:211], v2, s[8:11], s50 offen offset:128 nt
    buffer_load_dwordx4 a[212:215], v2, s[8:11], s50 offen offset:256 nt
    s_bitcmp1_b32 s51, 21
    s_cselect_b32 s50, s63, s1
    s_add_u32 s50, s50, s51
    s_add_u32 s51, s51, 49152
    v_mfma_f32_16x16x32_bf16 v[20:23], a[228:231], a[0:3], 0
    v_mfma_f32_16x16x32_bf16 v[20:23], a[232:235], a[4:7], v[20:23]
    v_mfma_f32_16x16x32_bf16 v[20:23], a[236:239], a[8:11], v[20:23]
    s_call_b64 s[66:67], L_kat
    ds_read2st64_b32 v[76:77], v32 offset0:45 offset1:46
    ds_read_b32 v79, v32 offset:12032
    ds_read2st64_b32 v[36:37], v32 offset0:48 offset1:49
    ds_read_b32 v39, v32 offset:12800
    ds_read2st64_b32 v[24:25], v32 offset0:51 offset1:52
    ds_read_b32 v27, v32 offset:13568
    s_movk_i32 s59, 47
    s_waitcnt lgkmcnt(0)
    s_call_b64 s[66:67], L_vo
    s_waitcnt vmcnt(6)
    buffer_load_dwordx4 a[228:231], v1, s[4:7], s50 offen offset:0 nt
    buffer_load_dwordx4 a[232:235], v1, s[4:7], s50 offen offset:128 nt
    buffer_load_dwordx4 a[236:239], v1, s[4:7], s50 offen offset:256 nt
    s_bitcmp1_b32 s51, 21
    s_cselect_b32 s50, s63, s1
    s_add_u32 s50, s50, s51
    s_add_u32 s51, s51, 49152
    v_mfma_f32_16x16x32_bf16 v[20:23], a[192:195], a[0:3], 0
    v_mfma_f32_16x16x32_bf16 v[20:23], a[196:199], a[4:7], v[20:23]
    v_mfma_f32_16x16x32_bf16 v[20:23], a[200:203], a[8:11], v[20:23]
    s_call_b64 s[66:67], L_kat
    s_waitcnt vmcnt(6)
    buffer_load_dwordx4 a[192:195], v1, s[4:7], s50 offen offset:0 nt
    buffer_load_dwordx4 a[196:199], v1, s[4:7], s50 offen offset:128 nt
    buffer_load_dwordx4 a[200:203], v1, s[4:7], s50 offen offset:256 nt
    s_bitcmp1_b32 s51, 21
    s_cselect_b32 s50, s63, s1
    s_add_u32 s50, s50, s51
    s_add_u32 s51, s51, 49152
    v_mfma_f32_16x16x32_bf16 v[20:23], a[216:219], a[240:243], 0
    v_mfma_f32_16x16x32_bf16 v[20:23], a[220:223], a[244:247], v[20:23]
    v_mfma_f32_16x16x32_bf16 v[20:23], a[224:227], a[248:251], v[20:23]
    s_call_b64 s[66:67], L_kot
    v_and_b32 v24, v4, v34
    v_and_b32 v25, v5, v34
    v_and_b32 v26, v6, v34
    v_and_b32 v27, v7, v34
    s_waitcnt vmcnt(6)
    buffer_load_dwordx4 a[216:219], v1, s[4:7], s50 offen offset:0 nt
    buffer_load_dwordx4 a[220:223], v1, s[4:7], s50 offen offset:128 nt
    buffer_load_dwordx4 a[224:227], v1, s[4:7], s50 offen offset:256 nt
    s_bitcmp1_b32 s51, 21
    s_cselect_b32 s50, s63, s1
    s_add_u32 s50, s50, s51
    s_add_u32 s51, s51, 49152
    s_nop 1
    v_mfma_f32_16x16x32_bf16 v[8:11], v[24:27], a[204:207], v[8:11]
    v_mfma_f32_16x16x32_bf16 v[12:15], v[24:27], a[208:211], v[12:15]
    v_mfma_f32_16x16x32_bf16 v[16:19], v[24:27], a[212:215], v[16:19]
    s_waitcnt vmcnt(6)
    buffer_load_dwordx4 a[204:207], v1, s[4:7], s50 offen offset:0 nt
    buffer_load_dwordx4 a[208:211], v1, s[4:7], s50 offen offset:128 nt
    buffer_load_dwordx4 a[212:215], v1, s[4:7], s50 offen offset:256 nt
    s_bitcmp1_b32 s51, 21
    s_cselect_b32 s50, s63, s1
    s_add_u32 s50, s50, s51
    s_add_u32 s51, s51, 49152
    v_mfma_f32_16x16x32_bf16 v[20:23], a[228:231], a[0:3], 0
    v_mfma_f32_16x16x32_bf16 v[20:23], a[232:235], a[4:7], v[20:23]
    v_mfma_f32_16x16x32_bf16 v[20:23], a[236:239], a[8:11], v[20:23]
    s_call_b64 s[66:67], L_kat
    ds_read2st64_b32 v[76:77], v32 offset0:54 offset1:55
    ds_read_b32 v79, v32 offset:14336
    ds_read2st64_b32 v[36:37], v32 offset0:57 offset1:58
    ds_read_b32 v39, v32 offset:15104
    ds_read2st64_b32 v[24:25], v32 offset0:60 offset1:61
    ds_read_b32 v27, v32 offset:15872
    s_movk_i32 s59, 21
    s_waitcnt lgkmcnt(0)
    s_call_b64 s[66:67], L_ko
    s_waitcnt vmcnt(6)
    buffer_load_dwordx4 a[228:231], v1, s[4:7], s50 offen offset:0 nt
    buffer_load_dwordx4 a[232:235], v1, s[4:7], s50 offen offset:128 nt
    buffer_load_dwordx4 a[236:239], v1, s[4:7], s50 offen offset:256 nt
    s_bitcmp1_b32 s51, 21
    s_cselect_b32 s50, s63, s1
    s_add_u32 s50, s50, s51
    s_add_u32 s51, s51, 49152
    v_mfma_f32_16x16x32_bf16 v[20:23], a[192:195], a[0:3], 0
    v_mfma_f32_16x16x32_bf16 v[20:23], a[196:199], a[4:7], v[20:23]
    v_mfma_f32_16x16x32_bf16 v[20:23], a[200:203], a[8:11], v[20:23]
    s_call_b64 s[66:67], L_kat
    ds_read2st64_b32 v[76:77], v32 offset0:63 offset1:64
    ds_read_b32 v79, v32 offset:16640
    ds_read2st64_b32 v[36:37], v32 offset0:66 offset1:67
    ds_read_b32 v39, v32 offset:17408
    ds_read2st64_b32 v[24:25], v32 offset0:69 offset1:70
    ds_read_b32 v27, v32 offset:18176
    s_movk_i32 s59, 48
    s_waitcnt lgkmcnt(0)
    s_call_b64 s[66:67], L_vo
    s_waitcnt vmcnt(6)
    buffer_load_dwordx4 a[192:195], v1, s[4:7], s50 offen offset:0 nt
    buffer_load_dwordx4 a[196:199], v1, s[4:7], s50 offen offset:128 nt
    buffer_load_dwordx4 a[200:203], v1, s[4:7], s50 offen offset:256 nt
    s_bitcmp1_b32 s51, 21
    s_cselect_b32 s50, s63, s1
    s_add_u32 s50, s50, s51
    s_add_u32 s51, s51, 49152
    v_mfma_f32_16x16x32_bf16 v[20:23], a[216:219], a[0:3], 0
    v_mfma_f32_16x16x32_bf16 v[20:23], a[220:223], a[4:7], v[20:23]
    v_mfma_f32_16x16x32_bf16 v[20:23], a[224:227], a[8:11], v[20:23]
    s_call_b64 s[66:67], L_kat
    s_waitcnt vmcnt(6)
    buffer_load_dwordx4 a[216:219], v1, s[4:7], s50 offen offset:0 nt
    buffer_load_dwordx4 a[220:223], v1, s[4:7], s50 offen offset:128 nt
    buffer_load_dwordx4 a[224:227], v1, s[4:7], s50 offen offset:256 nt
    s_bitcmp1_b32 s51, 21
    s_cselect_b32 s50, s63, s1
    s_add_u32 s50, s50, s51
    s_add_u32 s51, s51, 49152
    v_mfma_f32_16x16x32_bf16 v[20:23], a[204:207], a[0:3], 0
    v_mfma_f32_16x16x32_bf16 v[20:23], a[208:211], a[4:7], v[20:23]
    v_mfma_f32_16x16x32_bf16 v[20:23], a[212:215], a[8:11], v[20:23]
    s_call_b64 s[66:67], L_kat
    ds_read2st64_b32 v[76:77], v32 offset0:72 offset1:73
    ds_read_b32 v79, v32 offset:18944
    ds_read2st64_b32 v[36:37], v32 offset0:75 offset1:76
    ds_read_b32 v39, v32 offset:19712
    ds_read2st64_b32 v[24:25], v32 offset0:78 offset1:79
    ds_read_b32 v27, v32 offset:20480
    s_movk_i32 s59, 22
    s_waitcnt lgkmcnt(0)
    s_call_b64 s[66:67], L_ko
    s_waitcnt vmcnt(6)
    buffer_load_dwordx4 a[204:207], v1, s[4:7], s50 offen offset:0 nt
    buffer_load_dwordx4 a[208:211], v1, s[4:7], s50 offen offset:128 nt
    buffer_load_dwordx4 a[212:215], v1, s[4:7], s50 offen offset:256 nt
    s_bitcmp1_b32 s51, 21
    s_cselect_b32 s50, s63, s1
    s_add_u32 s50, s50, s51
    s_add_u32 s51, s51, 49152
    v_mfma_f32_16x16x32_bf16 v[20:23], a[228:231], a[0:3], 0
    v_mfma_f32_16x16x32_bf16 v[20:23], a[232:235], a[4:7], v[20:23]
    v_mfma_f32_16x16x32_bf16 v[20:23], a[236:239], a[8:11], v[20:23]
    s_call_b64 s[66:67], L_kat
    s_waitcnt vmcnt(6)
    buffer_load_dwordx4 a[228:231], v1, s[4:7], s50 offen offset:0 nt
    buffer_load_dwordx4 a[232:235], v1, s[4:7], s50 offen offset:128 nt
    buffer_load_dwordx4 a[236:239], v1, s[4:7], s50 offen offset:256 nt
    s_bitcmp1_b32 s51, 21
    s_cselect_b32 s50, s63, s1
    s_add_u32 s50, s50, s51
    s_add_u32 s51, s51, 49152
    v_mfma_f32_16x16x32_bf16 v[20:23], a[192:195], a[0:3], 0
    v_mfma_f32_16x16x32_bf16 v[20:23], a[196:199], a[4:7], v[20:23]
    v_mfma_f32_16x16x32_bf16 v[20:23], a[200:203], a[8:11], v[20:23]
    s_call_b64 s[66:67], L_kat
    s_mov_b32 s60, 2080768
    buffer_load_dword v40, off, s[12:15], s60 sc1
    ds_read2st64_b32 v[76:77], v32 offset0:81 offset1:82
    ds_read_b32 v79, v32 offset:21248
    ds_read2st64_b32 v[36:37], v32 offset0:84 offset1:85
    ds_read_b32 v39, v32 offset:22016
    ds_read2st64_b32 v[24:25], v32 offset0:87 offset1:88
    ds_read_b32 v27, v32 offset:22784
    s_movk_i32 s59, 49
    s_waitcnt lgkmcnt(0)
    s_call_b64 s[66:67], L_vo
    s_waitcnt vmcnt(7)
    buffer_load_dwordx4 a[192:195], v1, s[4:7], s50 offen offset:0 nt
    buffer_load_dwordx4 a[196:199], v1, s[4:7], s50 offen offset:128 nt
    buffer_load_dwordx4 a[200:203], v1, s[4:7], s50 offen offset:256 nt
    s_add_u32 s50, s58, 1916928
    s_cmp_ge_u32 s50, s53
    s_cselect_b32 s62, 2064384, 0
    s_sub_u32 s50, s50, s62
    v_mfma_f32_16x16x32_bf16 v[20:23], a[216:219], a[0:3], 0
    v_mfma_f32_16x16x32_bf16 v[20:23], a[220:223], a[4:7], v[20:23]
    v_mfma_f32_16x16x32_bf16 v[20:23], a[224:227], a[8:11], v[20:23]
    s_call_b64 s[66:67], L_kat
    s_waitcnt vmcnt(7)
    buffer_load_dwordx4 a[216:219], v1, s[4:7], s50 offen offset:0 nt
    buffer_load_dwordx4 a[220:223], v1, s[4:7], s50 offen offset:128 nt
    buffer_load_dwordx4 a[224:227], v1, s[4:7], s50 offen offset:256 nt
    s_add_u32 s50, s58, 1916928
    s_cmp_ge_u32 s50, s53
    s_cselect_b32 s62, 2064384, 0
    s_sub_u32 s50, s50, s62
    v_mfma_f32_16x16x32_bf16 v[20:23], a[204:207], a[0:3], 0
    v_mfma_f32_16x16x32_bf16 v[20:23], a[208:211], a[4:7], v[20:23]
    v_mfma_f32_16x16x32_bf16 v[20:23], a[212:215], a[8:11], v[20:23]
    s_call_b64 s[66:67], L_kat
    ds_read2st64_b32 v[76:77], v32 offset0:90 offset1:91
    ds_read_b32 v79, v32 offset:23552
    ds_read2st64_b32 v[36:37], v32 offset0:93 offset1:94
    ds_read_b32 v39, v32 offset:24320
    ds_read2st64_b32 v[24:25], v32 offset0:96 offset1:97
    ds_read_b32 v27, v32 offset:25088
    s_movk_i32 s59, 23
    s_waitcnt lgkmcnt(0)
    s_call_b64 s[66:67], L_ko
    s_waitcnt vmcnt(7)
    buffer_load_dwordx4 a[204:207], v2, s[8:11], s50 offen offset:0 nt
    buffer_load_dwordx4 a[208:211], v2, s[8:11], s50 offen offset:128 nt
    buffer_load_dwordx4 a[212:215], v2, s[8:11], s50 offen offset:256 nt
    s_bitcmp1_b32 s51, 21
    s_cselect_b32 s50, s63, s1
    s_add_u32 s50, s50, s51
    s_add_u32 s51, s51, 49152
    v_mfma_f32_16x16x32_bf16 v[20:23], a[228:231], a[0:3], 0
    v_mfma_f32_16x16x32_bf16 v[20:23], a[232:235], a[4:7], v[20:23]
    v_mfma_f32_16x16x32_bf16 v[20:23], a[236:239], a[8:11], v[20:23]
    s_call_b64 s[66:67], L_kat
    ds_read2st64_b32 v[76:77], v32 offset0:99 offset1:100
    ds_read_b32 v79, v32 offset:25856
    ds_read2st64_b32 v[36:37], v32 offset0:102 offset1:103
    ds_read_b32 v39, v32 offset:26624
    ds_read2st64_b32 v[24:25], v32 offset0:105 offset1:106
    ds_read_b32 v27, v32 offset:27392
    s_movk_i32 s59, 50
    s_waitcnt lgkmcnt(0)
    s_call_b64 s[66:67], L_vo
    s_waitcnt vmcnt(6)
    buffer_load_dwordx4 a[228:231], v1, s[4:7], s50 offen offset:0 nt
    buffer_load_dwordx4 a[232:235], v1, s[4:7], s50 offen offset:128 nt
    buffer_load_dwordx4 a[236:239], v1, s[4:7], s50 offen offset:256 nt
    s_bitcmp1_b32 s51, 21
    s_cselect_b32 s50, s63, s1
    s_add_u32 s50, s50, s51
    s_add_u32 s51, s51, 49152
    v_mfma_f32_16x16x32_bf16 v[20:23], a[192:195], a[0:3], 0
    v_mfma_f32_16x16x32_bf16 v[20:23], a[196:199], a[4:7], v[20:23]
    v_mfma_f32_16x16x32_bf16 v[20:23], a[200:203], a[8:11], v[20:23]
    s_call_b64 s[66:67], L_kat
    s_waitcnt vmcnt(6)
    buffer_load_dwordx4 a[192:195], v1, s[4:7], s50 offen offset:0 nt
    buffer_load_dwordx4 a[196:199], v1, s[4:7], s50 offen offset:128 nt
    buffer_load_dwordx4 a[200:203], v1, s[4:7], s50 offen offset:256 nt
    s_bitcmp1_b32 s51, 21
    s_cselect_b32 s50, s63, s1
    s_add_u32 s50, s50, s51
    s_add_u32 s51, s51, 49152
    v_mfma_f32_16x16x32_bf16 v[20:23], a[216:219], a[240:243], 0
    v_mfma_f32_16x16x32_bf16 v[20:23], a[220:223], a[244:247], v[20:23]
    v_mfma_f32_16x16x32_bf16 v[20:23], a[224:227], a[248:251], v[20:23]
    s_call_b64 s[66:67], L_kot
    v_and_b32 v24, v4, v34
    v_and_b32 v25, v5, v34
    v_and_b32 v26, v6, v34
    v_and_b32 v27, v7, v34
    s_waitcnt vmcnt(6)
    buffer_load_dwordx4 a[216:219], v1, s[4:7], s50 offen offset:0 nt
    buffer_load_dwordx4 a[220:223], v1, s[4:7], s50 offen offset:128 nt
    buffer_load_dwordx4 a[224:227], v1, s[4:7], s50 offen offset:256 nt
    s_bitcmp1_b32 s51, 21
    s_cselect_b32 s50, s63, s1
    s_add_u32 s50, s50, s51
    s_add_u32 s51, s51, 49152
    s_nop 1
    v_mfma_f32_16x16x32_bf16 v[8:11], v[24:27], a[204:207], v[8:11]
    v_mfma_f32_16x16x32_bf16 v[12:15], v[24:27], a[208:211], v[12:15]
    v_mfma_f32_16x16x32_bf16 v[16:19], v[24:27], a[212:215], v[16:19]
    s_waitcnt vmcnt(6)
    buffer_load_dwordx4 a[204:207], v1, s[4:7], s50 offen offset:0 nt
    buffer_load_dwordx4 a[208:211], v1, s[4:7], s50 offen offset:128 nt
    buffer_load_dwordx4 a[212:215], v1, s[4:7], s50 offen offset:256 nt
    s_bitcmp1_b32 s51, 21
    s_cselect_b32 s50, s63, s1
    s_add_u32 s50, s50, s51
    s_add_u32 s51, s51, 49152
    v_mfma_f32_16x16x32_bf16 v[20:23], a[228:231], a[0:3], 0
    v_mfma_f32_16x16x32_bf16 v[20:23], a[232:235], a[4:7], v[20:23]
    v_mfma_f32_16x16x32_bf16 v[20:23], a[236:239], a[8:11], v[20:23]
    s_call_b64 s[66:67], L_kat
    ds_read2st64_b32 v[76:77], v32 offset0:108 offset1:109
    ds_read_b32 v79, v32 offset:28160
    ds_read2st64_b32 v[36:37], v32 offset0:111 offset1:112
    ds_read_b32 v39, v32 offset:28928
    ds_read2st64_b32 v[24:25], v32 offset0:114 offset1:115
    ds_read_b32 v27, v32 offset:29696
    s_movk_i32 s59, 24
    s_waitcnt lgkmcnt(0)
    s_call_b64 s[66:67], L_ko
    s_waitcnt vmcnt(6)
    buffer_load_dwordx4 a[228:231], v1, s[4:7], s50 offen offset:0 nt
    buffer_load_dwordx4 a[232:235], v1, s[4:7], s50 offen offset:128 nt
    buffer_load_dwordx4 a[236:239], v1, s[4:7], s50 offen offset:256 nt
    s_bitcmp1_b32 s51, 21
    s_cselect_b32 s50, s63, s1
    s_add_u32 s50, s50, s51
    s_add_u32 s51, s51, 49152
    v_mfma_f32_16x16x32_bf16 v[20:23], a[192:195], a[0:3], 0
    v_mfma_f32_16x16x32_bf16 v[20:23], a[196:199], a[4:7], v[20:23]
    v_mfma_f32_16x16x32_bf16 v[20:23], a[200:203], a[8:11], v[20:23]
    s_call_b64 s[66:67], L_kat
    s_mov_b32 s59, 400000
    s_mov_b32 s60, 2080768
    s_branch L_ctc
L_ct:
    buffer_load_dword v40, off, s[12:15], s60 sc1
    s_waitcnt vmcnt(0)
L_ctc:
    v_cmp_ne_u32 vcc, 43, v40
    s_cbranch_vccz L_ctd
    s_sub_u32 s59, s59, 1
    s_cbranch_scc0 L_ct
L_ctd:
    s_waitcnt vmcnt(6)
    buffer_load_dwordx4 a[192:195], v1, s[4:7], s50 offen offset:0 nt
    buffer_load_dwordx4 a[196:199], v1, s[4:7], s50 offen offset:128 nt
    buffer_load_dwordx4 a[200:203], v1, s[4:7], s50 offen offset:256 nt
    s_bitcmp1_b32 s51, 21
    s_cselect_b32 s50, s63, s1
    s_add_u32 s50, s50, s51
    s_add_u32 s51, s51, 49152
    v_mfma_f32_16x16x32_bf16 v[20:23], a[216:219], a[0:3], 0
    v_mfma_f32_16x16x32_bf16 v[20:23], a[220:223], a[4:7], v[20:23]
    v_mfma_f32_16x16x32_bf16 v[20:23], a[224:227], a[8:11], v[20:23]
    s_call_b64 s[66:67], L_kat
    ds_read2st64_b32 v[76:77], v32 offset0:117 offset1:118
    ds_read_b32 v79, v32 offset:30464
    ds_read2st64_b32 v[36:37], v32 offset0:120 offset1:121
    ds_read_b32 v39, v32 offset:31232
    ds_read2st64_b32 v[24:25], v32 offset0:123 offset1:124
    ds_read_b32 v27, v32 offset:32000
    s_movk_i32 s59, 51
    s_waitcnt lgkmcnt(0)
    s_call_b64 s[66:67], L_vo
    s_waitcnt vmcnt(6)
    buffer_load_dwordx4 a[216:219], v1, s[4:7], s50 offen offset:0 nt
    buffer_load_dwordx4 a[220:223], v1, s[4:7], s50 offen offset:128 nt
    buffer_load_dwordx4 a[224:227], v1, s[4:7], s50 offen offset:256 nt
    s_bitcmp1_b32 s51, 21
    s_cselect_b32 s50, s63, s1
    s_add_u32 s50, s50, s51
    s_add_u32 s51, s51, 49152
    v_mfma_f32_16x16x32_bf16 v[20:23], a[204:207], a[0:3], 0
    v_mfma_f32_16x16x32_bf16 v[20:23], a[208:211], a[4:7], v[20:23]
    v_mfma_f32_16x16x32_bf16 v[20:23], a[212:215], a[8:11], v[20:23]
    s_call_b64 s[66:67], L_kat
    ds_read2st64_b32 v[76:77], v32 offset0:126 offset1:127
    ds_read_b32 v79, v32 offset:32768
    ds_read2st64_b32 v[36:37], v32 offset0:129 offset1:130
    ds_read_b32 v39, v32 offset:33536
    ds_read2st64_b32 v[24:25], v32 offset0:132 offset1:133
    ds_read_b32 v27, v32 offset:34304
    s_movk_i32 s59, 25
    s_waitcnt lgkmcnt(0)
    s_call_b64 s[66:67], L_ko
    s_waitcnt vmcnt(6)
    buffer_load_dwordx4 a[204:207], v1, s[4:7], s50 offen offset:0 nt
    buffer_load_dwordx4 a[208:211], v1, s[4:7], s50 offen offset:128 nt
    buffer_load_dwordx4 a[212:215], v1, s[4:7], s50 offen offset:256 nt
    s_bitcmp1_b32 s51, 21
    s_cselect_b32 s50, s63, s1
    s_add_u32 s50, s50, s51
    s_add_u32 s51, s51, 49152
    v_mfma_f32_16x16x32_bf16 v[20:23], a[228:231], a[0:3], 0
    v_mfma_f32_16x16x32_bf16 v[20:23], a[232:235], a[4:7], v[20:23]
    v_mfma_f32_16x16x32_bf16 v[20:23], a[236:239], a[8:11], v[20:23]
    s_call_b64 s[66:67], L_kat
    s_waitcnt vmcnt(6)
    buffer_load_dwordx4 a[228:231], v1, s[4:7], s50 offen offset:0 nt
    buffer_load_dwordx4 a[232:235], v1, s[4:7], s50 offen offset:128 nt
    buffer_load_dwordx4 a[236:239], v1, s[4:7], s50 offen offset:256 nt
    s_bfe_u32 s60, s98, 0x1000f
    s_xor_b32 s60, s60, s46
    s_and_b32 s60, s60, 1
    s_lshl_b32 s60, s60, 21
    s_add_u32 s60, s60, 24576
    s_add_u32 s61, s46, 0
    s_and_b32 s61, s61, 3
    s_and_b32 s62, s2, 8
    s_lshl1_add_u32 s61, s61, s62
    s_lshl_b32 s61, s61, 1
    s_lshr_b32 s61, 0xc571b260, s61
    s_lshr_b32 s62, s2, 2
    s_xor_b32 s62, s62, s46
    s_lshl_b32 s62, s62, 3
    s_xor_b32 s61, s61, s62
    s_and_b32 s61, s61, 15
    s_xor_b32 s62, s61, 8
    s_mul_i32 s61, s61, 3072
    s_mul_i32 s62, s62, 3072
    s_sub_u32 s1, s61, s60
    s_sub_u32 s63, s62, s60
    s_bitcmp1_b32 s51, 21
    s_cselect_b32 s50, s63, s1
    s_add_u32 s50, s50, s51
    s_add_u32 s51, s51, 49152
    v_mfma_f32_16x16x32_bf16 v[20:23], a[192:195], a[0:3], 0
    v_mfma_f32_16x16x32_bf16 v[20:23], a[196:199], a[4:7], v[20:23]
    v_mfma_f32_16x16x32_bf16 v[20:23], a[200:203], a[8:11], v[20:23]
    s_call_b64 s[66:67], L_kat
    ds_read2st64_b32 v[76:77], v32 offset0:135 offset1:136
    ds_read_b32 v79, v32 offset:35072
    ds_read2st64_b32 v[36:37], v32 offset0:138 offset1:139
    ds_read_b32 v39, v32 offset:35840
    ds_read2st64_b32 v[24:25], v32 offset0:141 offset1:142
    ds_read_b32 v27, v32 offset:36608
    s_movk_i32 s59, 52
    s_waitcnt lgkmcnt(0)
    s_call_b64 s[66:67], L_vo
    s_waitcnt vmcnt(6)
    buffer_load_dwordx4 a[192:195], v1, s[4:7], s50 offen offset:0 nt
    buffer_load_dwordx4 a[196:199], v1, s[4:7], s50 offen offset:128 nt
    buffer_load_dwordx4 a[200:203], v1, s[4:7], s50 offen offset:256 nt
    s_add_u32 s50, s48, 1966080
    s_cmp_ge_u32 s50, s53
    s_cselect_b32 s62, 2064384, 0
    s_sub_u32 s50, s50, s62
    v_mfma_f32_16x16x32_bf16 v[20:23], a[216:219], a[0:3], 0
    v_mfma_f32_16x16x32_bf16 v[20:23], a[220:223], a[4:7], v[20:23]
    v_mfma_f32_16x16x32_bf16 v[20:23], a[224:227], a[8:11], v[20:23]
    s_call_b64 s[66:67], L_kat
    s_waitcnt vmcnt(6)
    buffer_load_dwordx4 a[216:219], v1, s[4:7], s50 offen offset:0 nt
    buffer_load_dwordx4 a[220:223], v1, s[4:7], s50 offen offset:128 nt
    buffer_load_dwordx4 a[224:227], v1, s[4:7], s50 offen offset:256 nt
    s_add_u32 s50, s48, 1966080
    s_cmp_ge_u32 s50, s53
    s_cselect_b32 s62, 2064384, 0
    s_sub_u32 s50, s50, s62
    v_mfma_f32_16x16x32_bf16 v[20:23], a[204:207], a[0:3], 0
    v_mfma_f32_16x16x32_bf16 v[20:23], a[208:211], a[4:7], v[20:23]
    v_mfma_f32_16x16x32_bf16 v[20:23], a[212:215], a[8:11], v[20:23]
    s_call_b64 s[66:67], L_kat
    ds_read2st64_b32 v[76:77], v32 offset0:144 offset1:145
    ds_read_b32 v79, v32 offset:37376
    ds_read2st64_b32 v[36:37], v32 offset0:147 offset1:148
    ds_read_b32 v39, v32 offset:38144
    v_mov_b32 v24, v82
    v_mov_b32 v25, v83
    v_mov_b32 v27, v84
    s_movk_i32 s59, 26
    s_waitcnt lgkmcnt(0)
    s_call_b64 s[66:67], L_ko
    s_waitcnt vmcnt(6)
    buffer_load_dwordx4 a[204:207], v2, s[8:11], s50 offen offset:0 nt
    buffer_load_dwordx4 a[208:211], v2, s[8:11], s50 offen offset:128 nt
    buffer_load_dwordx4 a[212:215], v2, s[8:11], s50 offen offset:256 nt
    s_bitcmp1_b32 s51, 21
    s_cselect_b32 s50, s63, s1
    s_add_u32 s50, s50, s51
    s_add_u32 s51, s51, 49152
    v_mfma_f32_16x16x32_bf16 v[20:23], a[228:231], a[0:3], 0
    v_mfma_f32_16x16x32_bf16 v[20:23], a[232:235], a[4:7], v[20:23]
    v_mfma_f32_16x16x32_bf16 v[20:23], a[236:239], a[8:11], v[20:23]
    s_call_b64 s[66:67], L_kat
    v_mov_b32 v76, v85
    v_mov_b32 v77, v86
    v_mov_b32 v79, v87
    v_mov_b32 v36, v88
    v_mov_b32 v37, v89
    v_mov_b32 v39, v90
    v_mov_b32 v24, v91
    v_mov_b32 v25, v92
    v_mov_b32 v27, v93
    s_movk_i32 s59, 53
    s_call_b64 s[66:67], L_vo
    s_waitcnt vmcnt(6)
    buffer_load_dwordx4 a[228:231], v1, s[4:7], s50 offen offset:0 nt
    buffer_load_dwordx4 a[232:235], v1, s[4:7], s50 offen offset:128 nt
    buffer_load_dwordx4 a[236:239], v1, s[4:7], s50 offen offset:256 nt
    s_bitcmp1_b32 s51, 21
    s_cselect_b32 s50, s63, s1
    s_add_u32 s50, s50, s51
    s_add_u32 s51, s51, 49152
    v_mfma_f32_16x16x32_bf16 v[20:23], a[192:195], a[0:3], 0
    v_mfma_f32_16x16x32_bf16 v[20:23], a[196:199], a[4:7], v[20:23]
    v_mfma_f32_16x16x32_bf16 v[20:23], a[200:203], a[8:11], v[20:23]
    s_call_b64 s[66:67], L_kat
    s_waitcnt vmcnt(6)
    buffer_load_dwordx4 a[192:195], v1, s[4:7], s50 offen offset:0 nt
    buffer_load_dwordx4 a[196:199], v1, s[4:7], s50 offen offset:128 nt
    buffer_load_dwordx4 a[200:203], v1, s[4:7], s50 offen offset:256 nt
    s_bitcmp1_b32 s51, 21
    s_cselect_b32 s50, s63, s1
    s_add_u32 s50, s50, s51
    s_add_u32 s51, s51, 49152
    v_mfma_f32_16x16x32_bf16 v[20:23], a[216:219], a[240:243], 0
    v_mfma_f32_16x16x32_bf16 v[20:23], a[220:223], a[244:247], v[20:23]
    v_mfma_f32_16x16x32_bf16 v[20:23], a[224:227], a[248:251], v[20:23]
    s_call_b64 s[66:67], L_kot
    v_and_b32 v24, v4, v34
    v_and_b32 v25, v5, v34
    v_and_b32 v26, v6, v34
    v_and_b32 v27, v7, v34
    s_waitcnt vmcnt(6)
    buffer_load_dwordx4 a[216:219], v1, s[4:7], s50 offen offset:0 nt
    buffer_load_dwordx4 a[220:223], v1, s[4:7], s50 offen offset:128 nt
    buffer_load_dwordx4 a[224:227], v1, s[4:7], s50 offen offset:256 nt
    s_bitcmp1_b32 s51, 21
    s_cselect_b32 s50, s63, s1
    s_add_u32 s50, s50, s51
    s_add_u32 s51, s51, 49152
    s_nop 1
    v_mfma_f32_16x16x32_bf16 v[8:11], v[24:27], a[204:207], v[8:11]
    v_mfma_f32_16x16x32_bf16 v[12:15], v[24:27], a[208:211], v[12:15]
    v_mfma_f32_16x16x32_bf16 v[16:19], v[24:27], a[212:215], v[16:19]
    s_waitcnt vmcnt(6)
    buffer_load_dwordx4 a[204:207], v1, s[4:7], s50 offen offset:0 nt
    buffer_load_dwordx4 a[208:211], v1, s[4:7], s50 offen offset:128 nt
    buffer_load_dwordx4 a[212:215], v1, s[4:7], s50 offen offset:256 nt
    s_bitcmp1_b32 s51, 21
    s_cselect_b32 s50, s63, s1
    s_add_u32 s50, s50, s51
    s_add_u32 s51, s51, 49152
    v_mfma_f32_16x16x32_bf16 v[20:23], a[228:231], a[0:3], 0
    v_mfma_f32_16x16x32_bf16 v[20:23], a[232:235], a[4:7], v[20:23]
    v_mfma_f32_16x16x32_bf16 v[20:23], a[236:239], a[8:11], v[20:23]
    s_call_b64 s[66:67], L_kat
    v_mov_b32 v76, v94
    v_mov_b32 v77, v95
    v_mov_b32 v79, v96
    v_mov_b32 v36, v97
    v_mov_b32 v37, v98
    v_mov_b32 v39, v99
    v_mov_b32 v24, v100
    v_mov_b32 v25, v101
    v_mov_b32 v27, v102
    s_movk_i32 s59, 27
    s_call_b64 s[66:67], L_ko
    s_waitcnt vmcnt(6)
    buffer_load_dwordx4 a[228:231], v1, s[4:7], s50 offen offset:0 nt
    buffer_load_dwordx4 a[232:235], v1, s[4:7], s50 offen offset:128 nt
    buffer_load_dwordx4 a[236:239], v1, s[4:7], s50 offen offset:256 nt
    s_bitcmp1_b32 s51, 21
    s_cselect_b32 s50, s63, s1
    s_add_u32 s50, s50, s51
    s_add_u32 s51, s51, 49152
    v_mfma_f32_16x16x32_bf16 v[20:23], a[192:195], a[0:3], 0
    v_mfma_f32_16x16x32_bf16 v[20:23], a[196:199], a[4:7], v[20:23]
    v_mfma_f32_16x16x32_bf16 v[20:23], a[200:203], a[8:11], v[20:23]
    s_call_b64 s[66:67], L_kat
    s_waitcnt vmcnt(6)
    buffer_load_dwordx4 a[192:195], v1, s[4:7], s50 offen offset:0 nt
    buffer_load_dwordx4 a[196:199], v1, s[4:7], s50 offen offset:128 nt
    buffer_load_dwordx4 a[200:203], v1, s[4:7], s50 offen offset:256 nt
    s_bitcmp1_b32 s51, 21
    s_cselect_b32 s50, s63, s1
    s_add_u32 s50, s50, s51
    s_add_u32 s51, s51, 49152
    v_mfma_f32_16x16x32_bf16 v[20:23], a[216:219], a[0:3], 0
    v_mfma_f32_16x16x32_bf16 v[20:23], a[220:223], a[4:7], v[20:23]
    v_mfma_f32_16x16x32_bf16 v[20:23], a[224:227], a[8:11], v[20:23]
    s_call_b64 s[66:67], L_kat
    v_mov_b32 v76, v103
    v_mov_b32 v77, v104
    v_mov_b32 v79, v105
    v_mov_b32 v36, v106
    v_mov_b32 v37, v107
    v_mov_b32 v39, v108
    v_mov_b32 v24, v109
    v_mov_b32 v25, v110
    v_mov_b32 v27, v111
    s_movk_i32 s59, 54
    s_call_b64 s[66:67], L_vo
    s_waitcnt vmcnt(6)
    buffer_load_dwordx4 a[216:219], v1, s[4:7], s50 offen offset:0 nt
    buffer_load_dwordx4 a[220:223], v1, s[4:7], s50 offen offset:128 nt
    buffer_load_dwordx4 a[224:227], v1, s[4:7], s50 offen offset:256 nt
    s_bitcmp1_b32 s51, 21
    s_cselect_b32 s50, s63, s1
    s_add_u32 s50, s50, s51
    s_add_u32 s51, s51, 49152
    v_mfma_f32_16x16x32_bf16 v[20:23], a[204:207], a[0:3], 0
    v_mfma_f32_16x16x32_bf16 v[20:23], a[208:211], a[4:7], v[20:23]
    v_mfma_f32_16x16x32_bf16 v[20:23], a[212:215], a[8:11], v[20:23]
    s_call_b64 s[66:67], L_kat
    s_waitcnt vmcnt(6)
    buffer_load_dwordx4 a[204:207], v1, s[4:7], s50 offen offset:0 nt
    buffer_load_dwordx4 a[208:211], v1, s[4:7], s50 offen offset:128 nt
    buffer_load_dwordx4 a[212:215], v1, s[4:7], s50 offen offset:256 nt
    s_bitcmp1_b32 s51, 21
    s_cselect_b32 s50, s63, s1
    s_add_u32 s50, s50, s51
    s_add_u32 s51, s51, 49152
    v_mfma_f32_16x16x32_bf16 v[20:23], a[228:231], a[0:3], 0
    v_mfma_f32_16x16x32_bf16 v[20:23], a[232:235], a[4:7], v[20:23]
    v_mfma_f32_16x16x32_bf16 v[20:23], a[236:239], a[8:11], v[20:23]
    s_call_b64 s[66:67], L_kat
    v_mov_b32 v76, v112
    v_mov_b32 v77, v113
    v_mov_b32 v79, v114
    v_mov_b32 v36, v115
    v_mov_b32 v37, v116
    v_mov_b32 v39, v117
    v_mov_b32 v24, v118
    v_mov_b32 v25, v119
    v_mov_b32 v27, v120
    s_movk_i32 s59, 28
    s_call_b64 s[66:67], L_ko
    s_waitcnt vmcnt(6)
    buffer_load_dwordx4 a[228:231], v1, s[4:7], s50 offen offset:0 nt
    buffer_load_dwordx4 a[232:235], v1, s[4:7], s50 offen offset:128 nt
    buffer_load_dwordx4 a[236:239], v1, s[4:7], s50 offen offset:256 nt
    s_bitcmp1_b32 s51, 21
    s_cselect_b32 s50, s63, s1
    s_add_u32 s50, s50, s51
    s_add_u32 s51, s51, 49152
    v_mfma_f32_16x16x32_bf16 v[20:23], a[192:195], a[0:3], 0
    v_mfma_f32_16x16x32_bf16 v[20:23], a[196:199], a[4:7], v[20:23]
    v_mfma_f32_16x16x32_bf16 v[20:23], a[200:203], a[8:11], v[20:23]
    s_call_b64 s[66:67], L_kat
    v_mov_b32 v76, v121
    v_mov_b32 v77, v122
    v_mov_b32 v79, v123
    v_mov_b32 v36, v124
    v_mov_b32 v37, v125
    v_mov_b32 v39, v126
    v_mov_b32 v24, v127
    v_mov_b32 v25, v128
    v_mov_b32 v27, v129
    s_movk_i32 s59, 55
    s_call_b64 s[66:67], L_vo
    s_waitcnt vmcnt(6)
    buffer_load_dwordx4 a[192:195], v1, s[4:7], s50 offen offset:0 nt
    buffer_load_dwordx4 a[196:199], v1, s[4:7], s50 offen offset:128 nt
    buffer_load_dwordx4 a[200:203], v1, s[4:7], s50 offen offset:256 nt
    s_add_u32 s50, s58, 2015232
    s_cmp_ge_u32 s50, s53
    s_cselect_b32 s62, 2064384, 0
    s_sub_u32 s50, s50, s62
    v_mfma_f32_16x16x32_bf16 v[20:23], a[216:219], a[0:3], 0
    v_mfma_f32_16x16x32_bf16 v[20:23], a[220:223], a[4:7], v[20:23]
    v_mfma_f32_16x16x32_bf16 v[20:23], a[224:227], a[8:11], v[20:23]
    s_call_b64 s[66:67], L_kat
    s_waitcnt vmcnt(6)
    buffer_load_dwordx4 a[216:219], v1, s[4:7], s50 offen offset:0 nt
    buffer_load_dwordx4 a[220:223], v1, s[4:7], s50 offen offset:128 nt
    buffer_load_dwordx4 a[224:227], v1, s[4:7], s50 offen offset:256 nt
    s_add_u32 s50, s58, 2015232
    s_cmp_ge_u32 s50, s53
    s_cselect_b32 s62, 2064384, 0
    s_sub_u32 s50, s50, s62
    v_mfma_f32_16x16x32_bf16 v[20:23], a[204:207], a[0:3], 0
    v_mfma_f32_16x16x32_bf16 v[20:23], a[208:211], a[4:7], v[20:23]
    v_mfma_f32_16x16x32_bf16 v[20:23], a[212:215], a[8:11], v[20:23]
    s_call_b64 s[66:67], L_kat
    v_mov_b32 v76, v130
    v_mov_b32 v77, v131
    v_mov_b32 v79, v132
    v_mov_b32 v36, v133
    v_mov_b32 v37, v134
    v_mov_b32 v39, v135
    v_mov_b32 v24, v136
    v_mov_b32 v25, v137
    v_mov_b32 v27, v138
    s_movk_i32 s59, 29
    s_call_b64 s[66:67], L_ko
    s_waitcnt vmcnt(6)
    buffer_load_dwordx4 a[204:207], v2, s[8:11], s50 offen offset:0 nt
    buffer_load_dwordx4 a[208:211], v2, s[8:11], s50 offen offset:128 nt
    buffer_load_dwordx4 a[212:215], v2, s[8:11], s50 offen offset:256 nt
    s_bitcmp1_b32 s51, 21
    s_cselect_b32 s50, s63, s1
    s_add_u32 s50, s50, s51
    s_add_u32 s60, s53, s0
    s_cmp_eq_u32 s49, 43
    s_cselect_b32 s50, s60, s50
    v_mfma_f32_16x16x32_bf16 v[20:23], a[228:231], a[0:3], 0
    v_mfma_f32_16x16x32_bf16 v[20:23], a[232:235], a[4:7], v[20:23]
    v_mfma_f32_16x16x32_bf16 v[20:23], a[236:239], a[8:11], v[20:23]
    s_call_b64 s[66:67], L_kat
    s_waitcnt vmcnt(6)
    buffer_load_dwordx4 a[228:231], v1, s[4:7], s50 offen offset:0 nt
    buffer_load_dwordx4 a[232:235], v1, s[4:7], s50 offen offset:128 nt
    buffer_load_dwordx4 a[236:239], v1, s[4:7], s50 offen offset:256 nt
    s_bfe_u32 s60, s98, 0x10017
    s_xor_b32 s60, s60, s46
    s_and_b32 s60, s60, 1
    s_lshl_b32 s60, s60, 21
    s_add_u32 s60, s60, 24576
    s_add_u32 s51, s47, s60
    s_sub_u32 s1, s0, s60
    s_sub_u32 s63, s58, s48
    s_add_u32 s63, s63, s1
    s_add_u32 s61, s51, 4177920
    s_bitcmp1_b32 s61, 21
    s_cselect_b32 s50, s63, s1
    s_add_u32 s50, s50, s61
    s_add_u32 s60, s53, s0
    s_cmp_eq_u32 s49, 43
    s_cselect_b32 s50, s60, s50
    v_mfma_f32_16x16x32_bf16 v[20:23], a[192:195], a[0:3], 0
    v_mfma_f32_16x16x32_bf16 v[20:23], a[196:199], a[4:7], v[20:23]
    v_mfma_f32_16x16x32_bf16 v[20:23], a[200:203], a[8:11], v[20:23]
    s_call_b64 s[66:67], L_kat
    v_mov_b32 v76, v139
    v_mov_b32 v77, v140
    v_mov_b32 v79, v141
    v_mov_b32 v36, v142
    v_mov_b32 v37, v143
    v_mov_b32 v39, v144
    v_mov_b32 v24, v145
    v_mov_b32 v25, v146
    v_mov_b32 v27, v147
    s_movk_i32 s59, 56
    s_call_b64 s[66:67], L_vo
    s_waitcnt vmcnt(6)
    buffer_load_dwordx4 a[192:195], v2, s[8:11], s50 offen offset:0 nt
    buffer_load_dwordx4 a[196:199], v2, s[8:11], s50 offen offset:128 nt
    buffer_load_dwordx4 a[200:203], v2, s[8:11], s50 offen offset:256 nt
    s_bitcmp1_b32 s51, 21
    s_cselect_b32 s50, s63, s1
    s_add_u32 s50, s50, s51
    s_add_u32 s51, s51, 49152
    v_mfma_f32_16x16x32_bf16 v[20:23], a[216:219], a[240:243], 0
    v_mfma_f32_16x16x32_bf16 v[20:23], a[220:223], a[244:247], v[20:23]
    v_mfma_f32_16x16x32_bf16 v[20:23], a[224:227], a[248:251], v[20:23]
    s_call_b64 s[66:67], L_kot
    v_and_b32 v24, v4, v34
    v_and_b32 v25, v5, v34
    v_and_b32 v26, v6, v34
    v_and_b32 v27, v7, v34
    s_waitcnt vmcnt(6)
    buffer_load_dwordx4 a[216:219], v2, s[8:11], s50 offen offset:0 nt
    buffer_load_dwordx4 a[220:223], v2, s[8:11], s50 offen offset:128 nt
    buffer_load_dwordx4 a[224:227], v2, s[8:11], s50 offen offset:256 nt
    s_bitcmp1_b32 s51, 21
    s_cselect_b32 s50, s63, s1
    s_add_u32 s50, s50, s51
    s_add_u32 s51, s51, 49152
    s_nop 1
    v_mfma_f32_16x16x32_bf16 v[8:11], v[24:27], a[204:207], v[8:11]
    v_mfma_f32_16x16x32_bf16 v[12:15], v[24:27], a[208:211], v[12:15]
    v_mfma_f32_16x16x32_bf16 v[16:19], v[24:27], a[212:215], v[16:19]
    s_waitcnt vmcnt(6)
    buffer_load_dwordx4 a[204:207], v2, s[8:11], s50 offen offset:0 nt
    buffer_load_dwordx4 a[208:211], v2, s[8:11], s50 offen offset:128 nt
    buffer_load_dwordx4 a[212:215], v2, s[8:11], s50 offen offset:256 nt
    s_bitcmp1_b32 s51, 21
    s_cselect_b32 s50, s63, s1
    s_add_u32 s50, s50, s51
    s_add_u32 s51, s51, 49152
    s_cmp_eq_u32 s49, 42
    s_cbranch_scc1 L_x42a
    v_mfma_f32_16x16x32_bf16 v[20:23], a[228:231], a[240:243], 0
    v_mfma_f32_16x16x32_bf16 v[20:23], a[232:235], a[244:247], v[20:23]
    v_mfma_f32_16x16x32_bf16 v[20:23], a[236:239], a[248:251], v[20:23]
    s_call_b64 s[66:67], L_kot
    ds_write_b16_d16_hi v33, v35
    v_add_u32 v33, 16, v33
    s_branch L_x42e
L_x42a:
    v_mfma_f32_16x16x32_bf16 v[20:23], a[228:231], a[0:3], 0
    v_mfma_f32_16x16x32_bf16 v[20:23], a[232:235], a[4:7], v[20:23]
    v_mfma_f32_16x16x32_bf16 v[20:23], a[236:239], a[8:11], v[20:23]
    s_call_b64 s[66:67], L_kat
L_x42e:
    ds_write_b16_d16_hi v33, v35
    s_mul_i32 s60, s46, 1536
    s_add_u32 s60, s60, 153600
    v_add_u32 v30, s60, v3
    ds_read_b128 v[40:43], v30
    ds_read_b128 v[44:47], v30 offset:1024
    s_lshr_b32 s60, s98, 8
    s_xor_b32 s60, s60, s98
    s_bitcmp1_b32 s60, 15
    s_cbranch_scc0 L_nosend
    s_xor_b32 s60, s2, 0
    s_lshl2_add_u32 s60, s60, s46
    s_mul_i32 s60, s60, 1536
    s_add_u32 s60, s60, 10436608
    s_waitcnt lgkmcnt(0)
    buffer_store_dwordx4 v[40:43], v3, s[12:15], s60 offen sc1
    s_mov_b64 exec, 0xffffff
    buffer_store_dwordx4 v[44:47], v3, s[12:15], s60 offen offset:1024 sc1
    s_mov_b64 exec, -1
L_nosend:
    v_and_b32 v24, v4, v34
    v_and_b32 v25, v5, v34
    v_and_b32 v26, v6, v34
    v_and_b32 v27, v7, v34
    s_waitcnt vmcnt(6)
    buffer_load_dwordx4 a[228:231], v2, s[8:11], s50 offen offset:0 nt
    buffer_load_dwordx4 a[232:235], v2, s[8:11], s50 offen offset:128 nt
    buffer_load_dwordx4 a[236:239], v2, s[8:11], s50 offen offset:256 nt
    s_bitcmp1_b32 s51, 21
    s_cselect_b32 s50, s63, s1
    s_add_u32 s50, s50, s51
    s_add_u32 s51, s51, 49152
    s_cmp_eq_u32 s49, 42
    s_cbranch_scc1 L_y42
    v_mfma_f32_16x16x32_bf16 v[8:11], v[24:27], a[192:195], v[8:11]
    v_mfma_f32_16x16x32_bf16 v[12:15], v[24:27], a[196:199], v[12:15]
    v_mfma_f32_16x16x32_bf16 v[16:19], v[24:27], a[200:203], v[16:19]
L_y42:
    s_waitcnt vmcnt(6)
    buffer_load_dwordx4 a[180:183], v2, s[8:11], s50 offen offset:0 nt
    buffer_load_dwordx4 a[184:187], v2, s[8:11], s50 offen offset:128 nt
    buffer_load_dwordx4 a[188:191], v2, s[8:11], s50 offen offset:256 nt
    s_bitcmp1_b32 s51, 21
    s_cselect_b32 s50, s63, s1
    s_add_u32 s50, s50, s51
    s_add_u32 s51, s51, 49152
    v_mov_b32 v76, v148
    v_mov_b32 v77, v149
    v_mov_b32 v79, v150
    v_mov_b32 v36, v151
    v_mov_b32 v37, v152
    v_mov_b32 v39, v153
    v_mov_b32 v24, v154
    v_mov_b32 v25, v155
    v_mov_b32 v27, v156
    s_movk_i32 s59, 30
    s_call_b64 s[66:67], L_ko
    s_waitcnt vmcnt(6)
    buffer_load_dwordx4 a[168:171], v2, s[8:11], s50 offen offset:0 nt
    buffer_load_dwordx4 a[172:175], v2, s[8:11], s50 offen offset:128 nt
    buffer_load_dwordx4 a[176:179], v2, s[8:11], s50 offen offset:256 nt
    s_bitcmp1_b32 s51, 21
    s_cselect_b32 s50, s63, s1
    s_add_u32 s50, s50, s51
    s_add_u32 s51, s51, 49152
    v_mov_b32 v76, v157
    v_mov_b32 v77, v158
    v_mov_b32 v79, v159
    v_mov_b32 v36, v160
    v_mov_b32 v37, v161
    v_mov_b32 v39, v162
    v_mov_b32 v24, v163
    v_mov_b32 v25, v164
    v_mov_b32 v27, v165
    s_movk_i32 s59, 57
    s_call_b64 s[66:67], L_vo
    s_waitcnt vmcnt(6)
    buffer_load_dwordx4 a[156:159], v2, s[8:11], s50 offen offset:0 nt
    buffer_load_dwordx4 a[160:163], v2, s[8:11], s50 offen offset:128 nt
    buffer_load_dwordx4 a[164:167], v2, s[8:11], s50 offen offset:256 nt
    s_bitcmp1_b32 s51, 21
    s_cselect_b32 s50, s63, s1
    s_add_u32 s50, s50, s51
    s_add_u32 s51, s51, 49152
    v_mov_b32 v76, v166
    v_mov_b32 v77, v167
    v_mov_b32 v79, v168
    v_mov_b32 v36, v169
    v_mov_b32 v37, v170
    v_mov_b32 v39, v171
    v_mov_b32 v24, v172
    v_mov_b32 v25, v173
    v_mov_b32 v27, v174
    s_movk_i32 s59, 31
    s_call_b64 s[66:67], L_ko
    s_waitcnt vmcnt(6)
    buffer_load_dwordx4 a[144:147], v2, s[8:11], s50 offen offset:0 nt
    buffer_load_dwordx4 a[148:151], v2, s[8:11], s50 offen offset:128 nt
    buffer_load_dwordx4 a[152:155], v2, s[8:11], s50 offen offset:256 nt
    s_bitcmp1_b32 s51, 21
    s_cselect_b32 s50, s63, s1
    s_add_u32 s50, s50, s51
    s_add_u32 s51, s51, 49152
    v_mov_b32 v76, v175
    v_mov_b32 v77, v176
    v_mov_b32 v79, v177
    v_mov_b32 v36, v178
    v_mov_b32 v37, v179
    v_mov_b32 v39, v180
    v_mov_b32 v24, v181
    v_mov_b32 v25, v182
    v_mov_b32 v27, v183
    s_movk_i32 s59, 58
    s_call_b64 s[66:67], L_vo
    s_waitcnt vmcnt(6)
    buffer_load_dwordx4 a[132:135], v2, s[8:11], s50 offen offset:0 nt
    buffer_load_dwordx4 a[136:139], v2, s[8:11], s50 offen offset:128 nt
    buffer_load_dwordx4 a[140:143], v2, s[8:11], s50 offen offset:256 nt
    s_bitcmp1_b32 s51, 21
    s_cselect_b32 s50, s63, s1
    s_add_u32 s50, s50, s51
    s_add_u32 s51, s51, 49152
    v_mov_b32 v76, v184
    v_mov_b32 v77, v185
    v_mov_b32 v79, v186
    v_mov_b32 v36, v187
    v_mov_b32 v37, v188
    v_mov_b32 v39, v189
    v_mov_b32 v24, v190
    v_mov_b32 v25, v191
    v_mov_b32 v27, v192
    s_movk_i32 s59, 32
    s_call_b64 s[66:67], L_ko
    s_waitcnt vmcnt(6)
    buffer_load_dwordx4 a[120:123], v2, s[8:11], s50 offen offset:0 nt
    buffer_load_dwordx4 a[124:127], v2, s[8:11], s50 offen offset:128 nt
    buffer_load_dwordx4 a[128:131], v2, s[8:11], s50 offen offset:256 nt
    s_bitcmp1_b32 s51, 21
    s_cselect_b32 s50, s63, s1
    s_add_u32 s50, s50, s51
    s_add_u32 s51, s51, 49152
    v_mov_b32 v76, v193
    v_mov_b32 v77, v194
    v_mov_b32 v79, v195
    v_mov_b32 v36, v196
    v_mov_b32 v37, v197
    v_mov_b32 v39, v198
    v_mov_b32 v24, v199
    v_mov_b32 v25, v200
    v_mov_b32 v27, v201
    s_movk_i32 s59, 59
    s_call_b64 s[66:67], L_vo
    s_waitcnt vmcnt(6)
    buffer_load_dwordx4 a[108:111], v2, s[8:11], s50 offen offset:0 nt
    buffer_load_dwordx4 a[112:115], v2, s[8:11], s50 offen offset:128 nt
    buffer_load_dwordx4 a[116:119], v2, s[8:11], s50 offen offset:256 nt
    s_bitcmp1_b32 s51, 21
    s_cselect_b32 s50, s63, s1
    s_add_u32 s50, s50, s51
    s_add_u32 s51, s51, 49152
    v_mov_b32 v76, v202
    v_mov_b32 v77, v203
    v_mov_b32 v79, v204
    v_mov_b32 v36, v205
    v_mov_b32 v37, v206
    v_mov_b32 v39, v207
    v_mov_b32 v24, v208
    v_mov_b32 v25, v209
    v_mov_b32 v27, v210
    s_movk_i32 s59, 33
    s_call_b64 s[66:67], L_ko
    s_waitcnt vmcnt(6)
    buffer_load_dwordx4 a[96:99], v2, s[8:11], s50 offen offset:0 nt
    buffer_load_dwordx4 a[100:103], v2, s[8:11], s50 offen offset:128 nt
    buffer_load_dwordx4 a[104:107], v2, s[8:11], s50 offen offset:256 nt
    s_bfe_u32 s60, s98, 0x10017
    s_xor_b32 s60, s60, s46
    s_and_b32 s60, s60, 1
    s_lshl_b32 s60, s60, 21
    s_add_u32 s60, s60, 24576
    s_add_u32 s61, s46, 1
    s_and_b32 s61, s61, 3
    s_and_b32 s62, s2, 8
    s_lshl1_add_u32 s61, s61, s62
    s_lshl_b32 s61, s61, 1
    s_lshr_b32 s61, 0xc571b260, s61
    s_lshr_b32 s62, s2, 2
    s_xor_b32 s62, s62, s46
    s_lshl_b32 s62, s62, 3
    s_xor_b32 s61, s61, s62
    s_and_b32 s61, s61, 15
    s_xor_b32 s62, s61, 8
    s_mul_i32 s61, s61, 3072
    s_mul_i32 s62, s62, 3072
    s_sub_u32 s1, s61, s60
    s_sub_u32 s63, s62, s60
    s_bitcmp1_b32 s51, 21
    s_cselect_b32 s50, s63, s1
    s_add_u32 s50, s50, s51
    s_add_u32 s51, s51, 49152
    v_mov_b32 v76, v211
    v_mov_b32 v77, v212
    v_mov_b32 v79, v213
    v_mov_b32 v36, v214
    v_mov_b32 v37, v215
    v_mov_b32 v39, v216
    v_mov_b32 v24, v217
    v_mov_b32 v25, v218
    v_mov_b32 v27, v219
    s_movk_i32 s59, 60
    s_call_b64 s[66:67], L_vo
    s_waitcnt vmcnt(6)
    buffer_load_dwordx4 a[84:87], v2, s[8:11], s50 offen offset:0 nt
    buffer_load_dwordx4 a[88:91], v2, s[8:11], s50 offen offset:128 nt
    buffer_load_dwordx4 a[92:95], v2, s[8:11], s50 offen offset:256 nt
    s_bitcmp1_b32 s51, 21
    s_cselect_b32 s50, s63, s1
    s_add_u32 s50, s50, s51
    s_add_u32 s51, s51, 49152
    v_mov_b32 v76, v220
    v_mov_b32 v77, v221
    v_mov_b32 v79, v222
    v_mov_b32 v36, v223
    v_mov_b32 v37, v224
    v_mov_b32 v39, v225
    v_mov_b32 v24, v226
    v_mov_b32 v25, v227
    v_mov_b32 v27, v228
    s_movk_i32 s59, 34
    s_call_b64 s[66:67], L_ko
    s_lshr_b32 s60, s98, 8
    s_xor_b32 s60, s60, s98
    s_bitcmp1_b32 s60, 15
    s_cbranch_scc0 L_nofetch
    s_xor_b32 s60, s2, 4
    s_lshl2_add_u32 s60, s60, s46
    s_mul_i32 s60, s60, 1536
    s_add_u32 s60, s60, 10436608
    buffer_load_dwordx4 v[40:43], v3, s[12:15], s60 offen sc1
    s_mov_b64 exec, 0x7fffff
    buffer_load_dwordx4 v[44:47], v3, s[12:15], s60 offen offset:1024 sc1
    s_mov_b64 exec, -1
L_nofetch:
    s_waitcnt vmcnt(6)
    buffer_load_dwordx4 a[72:75], v2, s[8:11], s50 offen offset:0 nt
    buffer_load_dwordx4 a[76:79], v2, s[8:11], s50 offen offset:128 nt
    buffer_load_dwordx4 a[80:83], v2, s[8:11], s50 offen offset:256 nt
    s_bitcmp1_b32 s51, 21
    s_cselect_b32 s50, s63, s1
    s_add_u32 s50, s50, s51
    s_add_u32 s51, s51, 49152
    v_mov_b32 v76, v229
    v_mov_b32 v77, v230
    v_mov_b32 v79, v231
    v_mov_b32 v36, v232
    v_mov_b32 v37, v233
    v_mov_b32 v39, v234
    v_mov_b32 v24, v235
    v_mov_b32 v25, v236
    v_mov_b32 v27, v237
    s_movk_i32 s59, 61
    s_call_b64 s[66:67], L_vo
    s_waitcnt vmcnt(6)
    buffer_load_dwordx4 a[60:63], v2, s[8:11], s50 offen offset:0 nt
    buffer_load_dwordx4 a[64:67], v2, s[8:11], s50 offen offset:128 nt
    buffer_load_dwordx4 a[68:71], v2, s[8:11], s50 offen offset:256 nt
    s_bitcmp1_b32 s51, 21
    s_cselect_b32 s50, s63, s1
    s_add_u32 s50, s50, s51
    s_add_u32 s51, s51, 49152
    v_mov_b32 v76, v238
    v_mov_b32 v77, v239
    v_mov_b32 v79, v240
    v_mov_b32 v36, v241
    v_mov_b32 v37, v242
    v_mov_b32 v39, v243
    v_mov_b32 v24, v244
    v_mov_b32 v25, v245
    v_mov_b32 v27, v246
    s_movk_i32 s59, 35
    s_call_b64 s[66:67], L_ko
    s_waitcnt vmcnt(6)
    buffer_load_dwordx4 a[48:51], v2, s[8:11], s50 offen offset:0 nt
    buffer_load_dwordx4 a[52:55], v2, s[8:11], s50 offen offset:128 nt
    buffer_load_dwordx4 a[56:59], v2, s[8:11], s50 offen offset:256 nt
    s_bitcmp1_b32 s51, 21
    s_cselect_b32 s50, s63, s1
    s_add_u32 s50, s50, s51
    s_add_u32 s51, s51, 49152
    v_mov_b32 v76, v247
    v_mov_b32 v77, v248
    v_mov_b32 v79, v249
    v_mov_b32 v36, v250
    v_mov_b32 v37, v251
    v_mov_b32 v39, v252
    v_mov_b32 v24, v253
    v_mov_b32 v25, v254
    v_mov_b32 v27, v255
    s_movk_i32 s59, 62
    s_call_b64 s[66:67], L_vo
    s_waitcnt vmcnt(6)
    buffer_load_dwordx4 a[36:39], v2, s[8:11], s50 offen offset:0 nt
    buffer_load_dwordx4 a[40:43], v2, s[8:11], s50 offen offset:128 nt
    buffer_load_dwordx4 a[44:47], v2, s[8:11], s50 offen offset:256 nt
    s_bitcmp1_b32 s51, 21
    s_cselect_b32 s50, s63, s1
    s_add_u32 s50, s50, s51
    s_add_u32 s51, s51, 49152
    s_lshr_b32 s60, s98, 8
    s_xor_b32 s60, s60, s98
    s_bitcmp1_b32 s60, 15
    s_cbranch_scc0 L_xgot
    s_xor_b32 s60, s2, 4
    s_lshl2_add_u32 s60, s60, s46
    s_mul_i32 s60, s60, 1536
    s_add_u32 s60, s60, 10436608
    s_mov_b32 s59, 400000
    s_branch L_xchk
L_xtop:
    buffer_load_dwordx4 v[40:43], v3, s[12:15], s60 offen sc1
    s_mov_b64 exec, 0x7fffff
    buffer_load_dwordx4 v[44:47], v3, s[12:15], s60 offen offset:1024 sc1
    s_mov_b64 exec, -1
    s_waitcnt vmcnt(0)
L_xchk:
    v_max_u32 v30, v40, v41
    v_max3_u32 v30, v30, v42, v43
    s_mov_b64 exec, 0x7fffff
    v_max3_u32 v30, v30, v44, v45
    v_max3_u32 v30, v30, v46, v47
    s_mov_b64 exec, -1
    v_cmp_eq_u32 vcc, -1, v30
    s_cbranch_vccz L_xgot
    s_sub_u32 s59, s59, 1
    s_cbranch_scc0 L_xtop
L_xgot:
    s_mul_i32 s60, s46, 38400
    v_add_u32 v30, s60, v3
    ds_write_b128 v30, v[40:43]
    ds_write_b128 v30, v[44:47] offset:1024
    s_mov_b32 s64, 1
    v_add_f32_dpp v29, v29, v29 row_ror:8 row_mask:0xf bank_mask:0xf
    v_sub_f32 v28, 0, v28
    s_lshl_b32 s60, s64, 2
    v_add_f32_dpp v29, v29, v29 row_bcast:15 row_mask:0xa bank_mask:0xf
    s_add_u32 s60, s60, s46
    s_lshl_b32 s60, s60, 3
    v_add_f32_dpp v29, v29, v29 row_bcast:31 row_mask:0xc bank_mask:0xf
    s_add_u32 s60, s60, 159744
    v_mov_b32 v30, s60
    s_mov_b32 exec_lo, 0
    s_mov_b32 exec_hi, 0x80000000
    ds_write_b64 v30, v[28:29]
    s_mov_b64 exec, -1
    s_lshl_b32 s60, s46, 1
    s_add_u32 s60, s60, s64
    s_mul_i32 s60, s60, 768
    s_add_u32 s60, s60, 153600
    v_lshrrev_b32 v31, 5, v0
    v_lshl_add_u32 v31, v31, 8, s60
    v_and_b32 v39, 7, v0
    v_lshl_add_u32 v31, v39, 5, v31
    v_and_b32 v39, 16, v0
    v_add_u32 v31, v31, v39
    v_permlane32_swap_b32 v8, v12
    v_permlane32_swap_b32 v9, v13
    v_permlane32_swap_b32 v10, v14
    v_permlane32_swap_b32 v11, v15
    v_permlane32_swap_b32 v16, v20
    v_permlane32_swap_b32 v17, v21
    v_permlane32_swap_b32 v18, v22
    v_permlane32_swap_b32 v19, v23
    v_add_f32_dpp v8, v12, v8 row_ror:8 row_mask:0xf bank_mask:0xf
    v_add_f32_dpp v9, v13, v9 row_ror:8 row_mask:0xf bank_mask:0xf
    v_add_f32_dpp v10, v14, v10 row_ror:8 row_mask:0xf bank_mask:0xf
    v_add_f32_dpp v11, v15, v11 row_ror:8 row_mask:0xf bank_mask:0xf
    v_add_f32_dpp v16, v20, v16 row_ror:8 row_mask:0xf bank_mask:0xf
    v_add_f32_dpp v17, v21, v17 row_ror:8 row_mask:0xf bank_mask:0xf
    v_add_f32_dpp v18, v22, v18 row_ror:8 row_mask:0xf bank_mask:0xf
    v_add_f32_dpp v19, v23, v19 row_ror:8 row_mask:0xf bank_mask:0xf
    s_mov_b32 exec_lo, 0x00ff00ff
    s_mov_b32 exec_hi, 0x00ff00ff
    ds_write_b128 v31, v[8:11]
    s_mov_b32 exec_hi, 0
    ds_write_b128 v31, v[16:19] offset:512
    s_mov_b64 exec, -1
    s_mul_i32 s60, s46, 38400
    s_add_u32 s60, s60, 0
    v_lshrrev_b32 v33, 3, v0
    v_lshl_add_u32 v33, v33, 1, s60
    v_mov_b32 v34, 0
    ds_read_u16_d16_hi v34, v33 offset:1376
    v_mov_b32 v8, 0
    v_mov_b32 v9, 0
    v_mov_b32 v10, 0
    v_mov_b32 v11, 0
    v_mov_b32 v12, 0
    v_mov_b32 v13, 0
    v_mov_b32 v14, 0
    v_mov_b32 v15, 0
    v_mov_b32 v16, 0
    v_mov_b32 v17, 0
    v_mov_b32 v18, 0
    v_mov_b32 v19, 0
    v_mov_b32 v29, 0
    v_mov_b32 v28, 0x7f800000
    s_mov_b32 s52, 0xff800000
    s_waitcnt lgkmcnt(0)
    s_nop 1
    v_max_f32_dpp v28, v34, v34 row_ror:8 row_mask:0xf bank_mask:0xf
    s_nop 1
    v_max_f32_dpp v28, v28, v28 row_bcast:15 row_mask:0xa bank_mask:0xf
    s_nop 1
    v_max_f32_dpp v28, v28, v28 row_bcast:31 row_mask:0xc bank_mask:0xf
    s_nop 1
    v_readlane_b32 s52, v28, 63
    s_nop 1
    v_mov_b32 v28, s52
    v_mul_f32 v28, 0xbfb8aa3b, v28
    s_cmp_eq_u32 s49, 43
    s_cbranch_scc1 L_z43
    ds_read_u16_d16_hi v34, v33 offset:1360
    s_call_b64 s[66:67], L_prob
    s_nop 0
    v_mfma_f32_16x16x32_bf16 v[8:11], v[24:27], a[192:195], v[8:11]
    v_mfma_f32_16x16x32_bf16 v[12:15], v[24:27], a[196:199], v[12:15]
    v_mfma_f32_16x16x32_bf16 v[16:19], v[24:27], a[200:203], v[16:19]
L_z43:
    s_call_b64 s[66:67], L_pst
    s_nop 0
    v_mfma_f32_16x16x32_bf16 v[8:11], v[24:27], a[216:219], v[8:11]
    v_mfma_f32_16x16x32_bf16 v[12:15], v[24:27], a[220:223], v[12:15]
    v_mfma_f32_16x16x32_bf16 v[16:19], v[24:27], a[224:227], v[16:19]
    s_call_b64 s[66:67], L_pst
    s_nop 0
    v_mfma_f32_16x16x32_bf16 v[8:11], v[24:27], a[204:207], v[8:11]
    v_mfma_f32_16x16x32_bf16 v[12:15], v[24:27], a[208:211], v[12:15]
    v_mfma_f32_16x16x32_bf16 v[16:19], v[24:27], a[212:215], v[16:19]
    s_call_b64 s[66:67], L_pst
    s_nop 0
    v_mfma_f32_16x16x32_bf16 v[8:11], v[24:27], a[228:231], v[8:11]
    v_mfma_f32_16x16x32_bf16 v[12:15], v[24:27], a[232:235], v[12:15]
    v_mfma_f32_16x16x32_bf16 v[16:19], v[24:27], a[236:239], v[16:19]
    s_call_b64 s[66:67], L_pst
    s_nop 0
    v_mfma_f32_16x16x32_bf16 v[8:11], v[24:27], a[180:183], v[8:11]
    v_mfma_f32_16x16x32_bf16 v[12:15], v[24:27], a[184:187], v[12:15]
    v_mfma_f32_16x16x32_bf16 v[16:19], v[24:27], a[188:191], v[16:19]
    s_waitcnt vmcnt(6)
    buffer_load_dwordx4 a[228:231], v2, s[8:11], s50 offen offset:0 nt
    buffer_load_dwordx4 a[232:235], v2, s[8:11], s50 offen offset:128 nt
    buffer_load_dwordx4 a[236:239], v2, s[8:11], s50 offen offset:256 nt
    s_bitcmp1_b32 s51, 21
    s_cselect_b32 s50, s63, s1
    s_add_u32 s50, s50, s51
    s_add_u32 s51, s51, 49152
    s_call_b64 s[66:67], L_pst
    s_nop 0
    v_mfma_f32_16x16x32_bf16 v[8:11], v[24:27], a[168:171], v[8:11]
    v_mfma_f32_16x16x32_bf16 v[12:15], v[24:27], a[172:175], v[12:15]
    v_mfma_f32_16x16x32_bf16 v[16:19], v[24:27], a[176:179], v[16:19]
    s_call_b64 s[66:67], L_pst
    s_nop 0
    v_mfma_f32_16x16x32_bf16 v[8:11], v[24:27], a[156:159], v[8:11]
    v_mfma_f32_16x16x32_bf16 v[12:15], v[24:27], a[160:163], v[12:15]
    v_mfma_f32_16x16x32_bf16 v[16:19], v[24:27], a[164:167], v[16:19]
    s_waitcnt vmcnt(6)
    buffer_load_dwordx4 a[216:219], v2, s[8:11], s50 offen offset:0 nt
    buffer_load_dwordx4 a[220:223], v2, s[8:11], s50 offen offset:128 nt
    buffer_load_dwordx4 a[224:227], v2, s[8:11], s50 offen offset:256 nt
    s_bitcmp1_b32 s51, 21
    s_cselect_b32 s50, s63, s1
    s_add_u32 s50, s50, s51
    s_add_u32 s51, s51, 49152
    s_call_b64 s[66:67], L_pst
    s_nop 0
    v_mfma_f32_16x16x32_bf16 v[8:11], v[24:27], a[144:147], v[8:11]
    v_mfma_f32_16x16x32_bf16 v[12:15], v[24:27], a[148:151], v[12:15]
    v_mfma_f32_16x16x32_bf16 v[16:19], v[24:27], a[152:155], v[16:19]
    s_call_b64 s[66:67], L_pst
    s_nop 0
    v_mfma_f32_16x16x32_bf16 v[8:11], v[24:27], a[132:135], v[8:11]
    v_mfma_f32_16x16x32_bf16 v[12:15], v[24:27], a[136:139], v[12:15]
    v_mfma_f32_16x16x32_bf16 v[16:19], v[24:27], a[140:143], v[16:19]
    s_waitcnt vmcnt(6)
    buffer_load_dwordx4 a[204:207], v2, s[8:11], s50 offen offset:0 nt
    buffer_load_dwordx4 a[208:211], v2, s[8:11], s50 offen offset:128 nt
    buffer_load_dwordx4 a[212:215], v2, s[8:11], s50 offen offset:256 nt
    s_bitcmp1_b32 s51, 21
    s_cselect_b32 s50, s63, s1
    s_add_u32 s50, s50, s51
    s_add_u32 s51, s51, 49152
    s_call_b64 s[66:67], L_pst
    s_nop 0
    v_mfma_f32_16x16x32_bf16 v[8:11], v[24:27], a[120:123], v[8:11]
    v_mfma_f32_16x16x32_bf16 v[12:15], v[24:27], a[124:127], v[12:15]
    v_mfma_f32_16x16x32_bf16 v[16:19], v[24:27], a[128:131], v[16:19]
    s_call_b64 s[66:67], L_pst
    s_nop 0
    v_mfma_f32_16x16x32_bf16 v[8:11], v[24:27], a[108:111], v[8:11]
    v_mfma_f32_16x16x32_bf16 v[12:15], v[24:27], a[112:115], v[12:15]
    v_mfma_f32_16x16x32_bf16 v[16:19], v[24:27], a[116:119], v[16:19]
    s_waitcnt vmcnt(6)
    buffer_load_dwordx4 a[192:195], v2, s[8:11], s50 offen offset:0 nt
    buffer_load_dwordx4 a[196:199], v2, s[8:11], s50 offen offset:128 nt
    buffer_load_dwordx4 a[200:203], v2, s[8:11], s50 offen offset:256 nt
    s_bitcmp1_b32 s51, 21
    s_cselect_b32 s50, s63, s1
    s_add_u32 s50, s50, s51
    s_add_u32 s51, s51, 49152
    s_call_b64 s[66:67], L_pst
    s_nop 0
    v_mfma_f32_16x16x32_bf16 v[8:11], v[24:27], a[96:99], v[8:11]
    v_mfma_f32_16x16x32_bf16 v[12:15], v[24:27], a[100:103], v[12:15]
    v_mfma_f32_16x16x32_bf16 v[16:19], v[24:27], a[104:107], v[16:19]
    s_call_b64 s[66:67], L_pst
    s_nop 0
    v_mfma_f32_16x16x32_bf16 v[8:11], v[24:27], a[84:87], v[8:11]
    v_mfma_f32_16x16x32_bf16 v[12:15], v[24:27], a[88:91], v[12:15]
    v_mfma_f32_16x16x32_bf16 v[16:19], v[24:27], a[92:95], v[16:19]
    s_waitcnt vmcnt(6)
    buffer_load_dwordx4 a[180:183], v2, s[8:11], s50 offen offset:0 nt
    buffer_load_dwordx4 a[184:187], v2, s[8:11], s50 offen offset:128 nt
    buffer_load_dwordx4 a[188:191], v2, s[8:11], s50 offen offset:256 nt
    s_bitcmp1_b32 s51, 21
    s_cselect_b32 s50, s63, s1
    s_add_u32 s50, s50, s51
    s_add_u32 s51, s51, 49152
    s_call_b64 s[66:67], L_pst
    s_nop 0
    v_mfma_f32_16x16x32_bf16 v[8:11], v[24:27], a[72:75], v[8:11]
    v_mfma_f32_16x16x32_bf16 v[12:15], v[24:27], a[76:79], v[12:15]
    v_mfma_f32_16x16x32_bf16 v[16:19], v[24:27], a[80:83], v[16:19]
    s_call_b64 s[66:67], L_pst
    s_nop 0
    v_mfma_f32_16x16x32_bf16 v[8:11], v[24:27], a[60:63], v[8:11]
    v_mfma_f32_16x16x32_bf16 v[12:15], v[24:27], a[64:67], v[12:15]
    v_mfma_f32_16x16x32_bf16 v[16:19], v[24:27], a[68:71], v[16:19]
    s_waitcnt vmcnt(6)
    buffer_load_dwordx4 a[168:171], v2, s[8:11], s50 offen offset:0 nt
    buffer_load_dwordx4 a[172:175], v2, s[8:11], s50 offen offset:128 nt
    buffer_load_dwordx4 a[176:179], v2, s[8:11], s50 offen offset:256 nt
    s_bitcmp1_b32 s51, 21
    s_cselect_b32 s50, s63, s1
    s_add_u32 s50, s50, s51
    s_add_u32 s51, s51, 49152
    s_call_b64 s[66:67], L_pst
    s_nop 0
    v_mfma_f32_16x16x32_bf16 v[8:11], v[24:27], a[48:51], v[8:11]
    v_mfma_f32_16x16x32_bf16 v[12:15], v[24:27], a[52:55], v[12:15]
    v_mfma_f32_16x16x32_bf16 v[16:19], v[24:27], a[56:59], v[16:19]
    s_call_b64 s[66:67], L_pst
    s_nop 0
    v_mfma_f32_16x16x32_bf16 v[8:11], v[24:27], a[36:39], v[8:11]
    v_mfma_f32_16x16x32_bf16 v[12:15], v[24:27], a[40:43], v[12:15]
    v_mfma_f32_16x16x32_bf16 v[16:19], v[24:27], a[44:47], v[16:19]
    s_waitcnt vmcnt(6)
    buffer_load_dwordx4 a[156:159], v2, s[8:11], s50 offen offset:0 nt
    buffer_load_dwordx4 a[160:163], v2, s[8:11], s50 offen offset:128 nt
    buffer_load_dwordx4 a[164:167], v2, s[8:11], s50 offen offset:256 nt
    s_bitcmp1_b32 s51, 21
    s_cselect_b32 s50, s63, s1
    s_add_u32 s50, s50, s51
    s_add_u32 s51, s51, 49152
    s_call_b64 s[66:67], L_pst
    s_nop 0
    v_mfma_f32_16x16x32_bf16 v[8:11], v[24:27], a[228:231], v[8:11]
    v_mfma_f32_16x16x32_bf16 v[12:15], v[24:27], a[232:235], v[12:15]
    v_mfma_f32_16x16x32_bf16 v[16:19], v[24:27], a[236:239], v[16:19]
    s_call_b64 s[66:67], L_pst
    s_nop 0
    v_mfma_f32_16x16x32_bf16 v[8:11], v[24:27], a[216:219], v[8:11]
    v_mfma_f32_16x16x32_bf16 v[12:15], v[24:27], a[220:223], v[12:15]
    v_mfma_f32_16x16x32_bf16 v[16:19], v[24:27], a[224:227], v[16:19]
    s_waitcnt vmcnt(6)
    buffer_load_dwordx4 a[228:231], v2, s[8:11], s50 offen offset:0 nt
    buffer_load_dwordx4 a[232:235], v2, s[8:11], s50 offen offset:128 nt
    buffer_load_dwordx4 a[236:239], v2, s[8:11], s50 offen offset:256 nt
    s_bitcmp1_b32 s51, 21
    s_cselect_b32 s50, s63, s1
    s_add_u32 s50, s50, s51
    s_add_u32 s51, s51, 49152
    s_call_b64 s[66:67], L_pst
    s_nop 0
    v_mfma_f32_16x16x32_bf16 v[8:11], v[24:27], a[204:207], v[8:11]
    v_mfma_f32_16x16x32_bf16 v[12:15], v[24:27], a[208:211], v[12:15]
    v_mfma_f32_16x16x32_bf16 v[16:19], v[24:27], a[212:215], v[16:19]
    s_call_b64 s[66:67], L_pst
    s_nop 0
    v_mfma_f32_16x16x32_bf16 v[8:11], v[24:27], a[192:195], v[8:11]
    v_mfma_f32_16x16x32_bf16 v[12:15], v[24:27], a[196:199], v[12:15]
    v_mfma_f32_16x16x32_bf16 v[16:19], v[24:27], a[200:203], v[16:19]
    s_waitcnt vmcnt(6)
    buffer_load_dwordx4 a[216:219], v2, s[8:11], s50 offen offset:0 nt
    buffer_load_dwordx4 a[220:223], v2, s[8:11], s50 offen offset:128 nt
    buffer_load_dwordx4 a[224:227], v2, s[8:11], s50 offen offset:256 nt
    s_bitcmp1_b32 s51, 21
    s_cselect_b32 s50, s63, s1
    s_add_u32 s50, s50, s51
    s_add_u32 s51, s51, 49152
    s_call_b64 s[66:67], L_pst
    s_nop 0
    v_mfma_f32_16x16x32_bf16 v[8:11], v[24:27], a[180:183], v[8:11]
    v_mfma_f32_16x16x32_bf16 v[12:15], v[24:27], a[184:187], v[12:15]
    v_mfma_f32_16x16x32_bf16 v[16:19], v[24:27], a[188:191], v[16:19]
    s_call_b64 s[66:67], L_pst
    s_nop 0
    v_mfma_f32_16x16x32_bf16 v[8:11], v[24:27], a[168:171], v[8:11]
    v_mfma_f32_16x16x32_bf16 v[12:15], v[24:27], a[172:175], v[12:15]
    v_mfma_f32_16x16x32_bf16 v[16:19], v[24:27], a[176:179], v[16:19]
    s_call_b64 s[66:67], L_pst
    s_waitcnt vmcnt(6)
    buffer_load_dwordx4 a[204:207], v2, s[8:11], s50 offen offset:0 nt
    buffer_load_dwordx4 a[208:211], v2, s[8:11], s50 offen offset:128 nt
    buffer_load_dwordx4 a[212:215], v2, s[8:11], s50 offen offset:256 nt
    s_bitcmp1_b32 s51, 21
    s_cselect_b32 s50, s63, s1
    s_add_u32 s50, s50, s51
    s_add_u32 s51, s51, 49152
    s_nop 0
    v_mfma_f32_16x16x32_bf16 v[8:11], v[24:27], a[156:159], v[8:11]
    v_mfma_f32_16x16x32_bf16 v[12:15], v[24:27], a[160:163], v[12:15]
    v_mfma_f32_16x16x32_bf16 v[16:19], v[24:27], a[164:167], v[16:19]
    s_call_b64 s[66:67], L_pst
    s_waitcnt vmcnt(6)
    buffer_load_dwordx4 a[192:195], v2, s[8:11], s50 offen offset:0 nt
    buffer_load_dwordx4 a[196:199], v2, s[8:11], s50 offen offset:128 nt
    buffer_load_dwordx4 a[200:203], v2, s[8:11], s50 offen offset:256 nt
    s_bitcmp1_b32 s51, 21
    s_cselect_b32 s50, s63, s1
    s_add_u32 s50, s50, s51
    s_add_u32 s51, s51, 49152
    s_nop 0
    v_mfma_f32_16x16x32_bf16 v[8:11], v[24:27], a[228:231], v[8:11]
    v_mfma_f32_16x16x32_bf16 v[12:15], v[24:27], a[232:235], v[12:15]
    v_mfma_f32_16x16x32_bf16 v[16:19], v[24:27], a[236:239], v[16:19]
    s_call_b64 s[66:67], L_pst
    s_waitcnt vmcnt(6)
    buffer_load_dwordx4 a[228:231], v2, s[8:11], s50 offen offset:0 nt
    buffer_load_dwordx4 a[232:235], v2, s[8:11], s50 offen offset:128 nt
    buffer_load_dwordx4 a[236:239], v2, s[8:11], s50 offen offset:256 nt
    s_bitcmp1_b32 s51, 21
    s_cselect_b32 s50, s63, s1
    s_add_u32 s50, s50, s51
    s_add_u32 s51, s51, 49152
    s_nop 0
    v_mfma_f32_16x16x32_bf16 v[8:11], v[24:27], a[216:219], v[8:11]
    v_mfma_f32_16x16x32_bf16 v[12:15], v[24:27], a[220:223], v[12:15]
    v_mfma_f32_16x16x32_bf16 v[16:19], v[24:27], a[224:227], v[16:19]
    s_call_b64 s[66:67], L_pst
    s_waitcnt vmcnt(6)
    buffer_load_dwordx4 a[216:219], v2, s[8:11], s50 offen offset:0 nt
    buffer_load_dwordx4 a[220:223], v2, s[8:11], s50 offen offset:128 nt
    buffer_load_dwordx4 a[224:227], v2, s[8:11], s50 offen offset:256 nt
    s_bitcmp1_b32 s51, 21
    s_cselect_b32 s50, s63, s1
    s_add_u32 s50, s50, s51
    s_add_u32 s51, s51, 49152
    s_nop 0
    v_mfma_f32_16x16x32_bf16 v[8:11], v[24:27], a[204:207], v[8:11]
    v_mfma_f32_16x16x32_bf16 v[12:15], v[24:27], a[208:211], v[12:15]
    v_mfma_f32_16x16x32_bf16 v[16:19], v[24:27], a[212:215], v[16:19]
    s_call_b64 s[66:67], L_pst
    s_waitcnt vmcnt(6)
    buffer_load_dwordx4 a[204:207], v2, s[8:11], s50 offen offset:0 nt
    buffer_load_dwordx4 a[208:211], v2, s[8:11], s50 offen offset:128 nt
    buffer_load_dwordx4 a[212:215], v2, s[8:11], s50 offen offset:256 nt
    s_bitcmp1_b32 s51, 21
    s_cselect_b32 s50, s63, s1
    s_add_u32 s50, s50, s51
    s_add_u32 s51, s51, 49152
    s_nop 0
    v_mfma_f32_16x16x32_bf16 v[8:11], v[24:27], a[192:195], v[8:11]
    v_mfma_f32_16x16x32_bf16 v[12:15], v[24:27], a[196:199], v[12:15]
    v_mfma_f32_16x16x32_bf16 v[16:19], v[24:27], a[200:203], v[16:19]
    s_call_b64 s[66:67], L_pst
    s_waitcnt vmcnt(6)
    buffer_load_dwordx4 a[192:195], v2, s[8:11], s50 offen offset:0 nt
    buffer_load_dwordx4 a[196:199], v2, s[8:11], s50 offen offset:128 nt
    buffer_load_dwordx4 a[200:203], v2, s[8:11], s50 offen offset:256 nt
    s_bitcmp1_b32 s51, 21
    s_cselect_b32 s50, s63, s1
    s_add_u32 s50, s50, s51
    s_add_u32 s51, s51, 49152
    s_nop 0
    v_mfma_f32_16x16x32_bf16 v[8:11], v[24:27], a[228:231], v[8:11]
    v_mfma_f32_16x16x32_bf16 v[12:15], v[24:27], a[232:235], v[12:15]
    v_mfma_f32_16x16x32_bf16 v[16:19], v[24:27], a[236:239], v[16:19]
    s_call_b64 s[66:67], L_pst
    s_waitcnt vmcnt(6)
    buffer_load_dwordx4 a[228:231], v2, s[8:11], s50 offen offset:0 nt
    buffer_load_dwordx4 a[232:235], v2, s[8:11], s50 offen offset:128 nt
    buffer_load_dwordx4 a[236:239], v2, s[8:11], s50 offen offset:256 nt
    s_bfe_u32 s60, s98, 0x10017
    s_xor_b32 s60, s60, s46
    s_and_b32 s60, s60, 1
    s_lshl_b32 s60, s60, 21
    s_add_u32 s60, s60, 24576
    s_add_u32 s61, s46, 2
    s_and_b32 s61, s61, 3
    s_and_b32 s62, s2, 8
    s_lshl1_add_u32 s61, s61, s62
    s_lshl_b32 s61, s61, 1
    s_lshr_b32 s61, 0xc571b260, s61
    s_lshr_b32 s62, s2, 2
    s_xor_b32 s62, s62, s46
    s_lshl_b32 s62, s62, 3
    s_xor_b32 s61, s61, s62
    s_and_b32 s61, s61, 15
    s_xor_b32 s62, s61, 8
    s_mul_i32 s61, s61, 3072
    s_mul_i32 s62, s62, 3072
    s_sub_u32 s1, s61, s60
    s_sub_u32 s63, s62, s60
    s_bitcmp1_b32 s51, 21
    s_cselect_b32 s50, s63, s1
    s_add_u32 s50, s50, s51
    s_add_u32 s51, s51, 49152
    s_nop 0
    v_mfma_f32_16x16x32_bf16 v[8:11], v[24:27], a[216:219], v[8:11]
    v_mfma_f32_16x16x32_bf16 v[12:15], v[24:27], a[220:223], v[12:15]
    v_mfma_f32_16x16x32_bf16 v[16:19], v[24:27], a[224:227], v[16:19]
    s_call_b64 s[66:67], L_pst
    s_waitcnt vmcnt(6)
    buffer_load_dwordx4 a[216:219], v2, s[8:11], s50 offen offset:0 nt
    buffer_load_dwordx4 a[220:223], v2, s[8:11], s50 offen offset:128 nt
    buffer_load_dwordx4 a[224:227], v2, s[8:11], s50 offen offset:256 nt
    s_bitcmp1_b32 s51, 21
    s_cselect_b32 s50, s63, s1
    s_add_u32 s50, s50, s51
    s_add_u32 s51, s51, 49152
    s_nop 0
    v_mfma_f32_16x16x32_bf16 v[8:11], v[24:27], a[204:207], v[8:11]
    v_mfma_f32_16x16x32_bf16 v[12:15], v[24:27], a[208:211], v[12:15]
    v_mfma_f32_16x16x32_bf16 v[16:19], v[24:27], a[212:215], v[16:19]
    s_call_b64 s[66:67], L_pst
    s_waitcnt vmcnt(6)
    buffer_load_dwordx4 a[204:207], v2, s[8:11], s50 offen offset:0 nt
    buffer_load_dwordx4 a[208:211], v2, s[8:11], s50 offen offset:128 nt
    buffer_load_dwordx4 a[212:215], v2, s[8:11], s50 offen offset:256 nt
    s_bitcmp1_b32 s51, 21
    s_cselect_b32 s50, s63, s1
    s_add_u32 s50, s50, s51
    s_add_u32 s51, s51, 49152
    s_nop 0
    v_mfma_f32_16x16x32_bf16 v[8:11], v[24:27], a[192:195], v[8:11]
    v_mfma_f32_16x16x32_bf16 v[12:15], v[24:27], a[196:199], v[12:15]
    v_mfma_f32_16x16x32_bf16 v[16:19], v[24:27], a[200:203], v[16:19]
    s_call_b64 s[66:67], L_pst
    s_waitcnt vmcnt(6)
    buffer_load_dwordx4 a[192:195], v2, s[8:11], s50 offen offset:0 nt
    buffer_load_dwordx4 a[196:199], v2, s[8:11], s50 offen offset:128 nt
    buffer_load_dwordx4 a[200:203], v2, s[8:11], s50 offen offset:256 nt
    s_bitcmp1_b32 s51, 21
    s_cselect_b32 s50, s63, s1
    s_add_u32 s50, s50, s51
    s_add_u32 s51, s51, 49152
    s_nop 0
    v_mfma_f32_16x16x32_bf16 v[8:11], v[24:27], a[228:231], v[8:11]
    v_mfma_f32_16x16x32_bf16 v[12:15], v[24:27], a[232:235], v[12:15]
    v_mfma_f32_16x16x32_bf16 v[16:19], v[24:27], a[236:239], v[16:19]
    s_call_b64 s[66:67], L_pst
    s_waitcnt vmcnt(6)
    buffer_load_dwordx4 a[228:231], v2, s[8:11], s50 offen offset:0 nt
    buffer_load_dwordx4 a[232:235], v2, s[8:11], s50 offen offset:128 nt
    buffer_load_dwordx4 a[236:239], v2, s[8:11], s50 offen offset:256 nt
    s_bitcmp1_b32 s51, 21
    s_cselect_b32 s50, s63, s1
    s_add_u32 s50, s50, s51
    s_add_u32 s51, s51, 49152
    s_nop 0
    v_mfma_f32_16x16x32_bf16 v[8:11], v[24:27], a[216:219], v[8:11]
    v_mfma_f32_16x16x32_bf16 v[12:15], v[24:27], a[220:223], v[12:15]
    v_mfma_f32_16x16x32_bf16 v[16:19], v[24:27], a[224:227], v[16:19]
    s_call_b64 s[66:67], L_pst
    s_waitcnt vmcnt(6)
    buffer_load_dwordx4 a[216:219], v2, s[8:11], s50 offen offset:0 nt
    buffer_load_dwordx4 a[220:223], v2, s[8:11], s50 offen offset:128 nt
    buffer_load_dwordx4 a[224:227], v2, s[8:11], s50 offen offset:256 nt
    s_bitcmp1_b32 s51, 21
    s_cselect_b32 s50, s63, s1
    s_add_u32 s50, s50, s51
    s_add_u32 s51, s51, 49152
    s_nop 0
    v_mfma_f32_16x16x32_bf16 v[8:11], v[24:27], a[204:207], v[8:11]
    v_mfma_f32_16x16x32_bf16 v[12:15], v[24:27], a[208:211], v[12:15]
    v_mfma_f32_16x16x32_bf16 v[16:19], v[24:27], a[212:215], v[16:19]
    s_call_b64 s[66:67], L_pst
    s_waitcnt vmcnt(6)
    buffer_load_dwordx4 a[204:207], v2, s[8:11], s50 offen offset:0 nt
    buffer_load_dwordx4 a[208:211], v2, s[8:11], s50 offen offset:128 nt
    buffer_load_dwordx4 a[212:215], v2, s[8:11], s50 offen offset:256 nt
    s_bitcmp1_b32 s51, 21
    s_cselect_b32 s50, s63, s1
    s_add_u32 s50, s50, s51
    s_add_u32 s51, s51, 49152
    s_nop 0
    v_mfma_f32_16x16x32_bf16 v[8:11], v[24:27], a[192:195], v[8:11]
    v_mfma_f32_16x16x32_bf16 v[12:15], v[24:27], a[196:199], v[12:15]
    v_mfma_f32_16x16x32_bf16 v[16:19], v[24:27], a[200:203], v[16:19]
    s_call_b64 s[66:67], L_pst
    s_waitcnt vmcnt(6)
    buffer_load_dwordx4 a[192:195], v2, s[8:11], s50 offen offset:0 nt
    buffer_load_dwordx4 a[196:199], v2, s[8:11], s50 offen offset:128 nt
    buffer_load_dwordx4 a[200:203], v2, s[8:11], s50 offen offset:256 nt
    s_bitcmp1_b32 s51, 21
    s_cselect_b32 s50, s63, s1
    s_add_u32 s50, s50, s51
    s_add_u32 s51, s51, 49152
    s_nop 0
    v_mfma_f32_16x16x32_bf16 v[8:11], v[24:27], a[228:231], v[8:11]
    v_mfma_f32_16x16x32_bf16 v[12:15], v[24:27], a[232:235], v[12:15]
    v_mfma_f32_16x16x32_bf16 v[16:19], v[24:27], a[236:239], v[16:19]
    s_call_b64 s[66:67], L_pst
    s_waitcnt vmcnt(6)
    buffer_load_dwordx4 a[228:231], v2, s[8:11], s50 offen offset:0 nt
    buffer_load_dwordx4 a[232:235], v2, s[8:11], s50 offen offset:128 nt
    buffer_load_dwordx4 a[236:239], v2, s[8:11], s50 offen offset:256 nt
    s_bitcmp1_b32 s51, 21
    s_cselect_b32 s50, s63, s1
    s_add_u32 s50, s50, s51
    s_add_u32 s51, s51, 49152
    s_nop 0
    v_mfma_f32_16x16x32_bf16 v[8:11], v[24:27], a[216:219], v[8:11]
    v_mfma_f32_16x16x32_bf16 v[12:15], v[24:27], a[220:223], v[12:15]
    v_mfma_f32_16x16x32_bf16 v[16:19], v[24:27], a[224:227], v[16:19]
    s_call_b64 s[66:67], L_pst
    s_waitcnt vmcnt(6)
    buffer_load_dwordx4 a[216:219], v2, s[8:11], s50 offen offset:0 nt
    buffer_load_dwordx4 a[220:223], v2, s[8:11], s50 offen offset:128 nt
    buffer_load_dwordx4 a[224:227], v2, s[8:11], s50 offen offset:256 nt
    s_bitcmp1_b32 s51, 21
    s_cselect_b32 s50, s63, s1
    s_add_u32 s50, s50, s51
    s_add_u32 s51, s51, 49152
    s_nop 0
    v_mfma_f32_16x16x32_bf16 v[8:11], v[24:27], a[204:207], v[8:11]
    v_mfma_f32_16x16x32_bf16 v[12:15], v[24:27], a[208:211], v[12:15]
    v_mfma_f32_16x16x32_bf16 v[16:19], v[24:27], a[212:215], v[16:19]
    s_call_b64 s[66:67], L_pst
    s_waitcnt vmcnt(6)
    buffer_load_dwordx4 a[204:207], v2, s[8:11], s50 offen offset:0 nt
    buffer_load_dwordx4 a[208:211], v2, s[8:11], s50 offen offset:128 nt
    buffer_load_dwordx4 a[212:215], v2, s[8:11], s50 offen offset:256 nt
    s_bitcmp1_b32 s51, 21
    s_cselect_b32 s50, s63, s1
    s_add_u32 s50, s50, s51
    s_add_u32 s51, s51, 49152
    s_nop 0
    v_mfma_f32_16x16x32_bf16 v[8:11], v[24:27], a[192:195], v[8:11]
    v_mfma_f32_16x16x32_bf16 v[12:15], v[24:27], a[196:199], v[12:15]
    v_mfma_f32_16x16x32_bf16 v[16:19], v[24:27], a[200:203], v[16:19]
    s_call_b64 s[66:67], L_pst
    s_waitcnt vmcnt(6)
    buffer_load_dwordx4 a[192:195], v2, s[8:11], s50 offen offset:0 nt
    buffer_load_dwordx4 a[196:199], v2, s[8:11], s50 offen offset:128 nt
    buffer_load_dwordx4 a[200:203], v2, s[8:11], s50 offen offset:256 nt
    s_bitcmp1_b32 s51, 21
    s_cselect_b32 s50, s63, s1
    s_add_u32 s50, s50, s51
    s_add_u32 s51, s51, 49152
    s_nop 0
    v_mfma_f32_16x16x32_bf16 v[8:11], v[24:27], a[228:231], v[8:11]
    v_mfma_f32_16x16x32_bf16 v[12:15], v[24:27], a[232:235], v[12:15]
    v_mfma_f32_16x16x32_bf16 v[16:19], v[24:27], a[236:239], v[16:19]
    s_call_b64 s[66:67], L_pst
    s_waitcnt vmcnt(6)
    buffer_load_dwordx4 a[228:231], v2, s[8:11], s50 offen offset:0 nt
    buffer_load_dwordx4 a[232:235], v2, s[8:11], s50 offen offset:128 nt
    buffer_load_dwordx4 a[236:239], v2, s[8:11], s50 offen offset:256 nt
    s_bitcmp1_b32 s51, 21
    s_cselect_b32 s50, s63, s1
    s_add_u32 s50, s50, s51
    s_add_u32 s51, s51, 49152
    s_nop 0
    v_mfma_f32_16x16x32_bf16 v[8:11], v[24:27], a[216:219], v[8:11]
    v_mfma_f32_16x16x32_bf16 v[12:15], v[24:27], a[220:223], v[12:15]
    v_mfma_f32_16x16x32_bf16 v[16:19], v[24:27], a[224:227], v[16:19]
    s_call_b64 s[66:67], L_pst
    s_waitcnt vmcnt(6)
    buffer_load_dwordx4 a[216:219], v2, s[8:11], s50 offen offset:0 nt
    buffer_load_dwordx4 a[220:223], v2, s[8:11], s50 offen offset:128 nt
    buffer_load_dwordx4 a[224:227], v2, s[8:11], s50 offen offset:256 nt
    s_bitcmp1_b32 s51, 21
    s_cselect_b32 s50, s63, s1
    s_add_u32 s50, s50, s51
    s_add_u32 s51, s51, 49152
    s_nop 0
    v_mfma_f32_16x16x32_bf16 v[8:11], v[24:27], a[204:207], v[8:11]
    v_mfma_f32_16x16x32_bf16 v[12:15], v[24:27], a[208:211], v[12:15]
    v_mfma_f32_16x16x32_bf16 v[16:19], v[24:27], a[212:215], v[16:19]
    s_call_b64 s[66:67], L_pst
    s_waitcnt vmcnt(6)
    buffer_load_dwordx4 a[204:207], v2, s[8:11], s50 offen offset:0 nt
    buffer_load_dwordx4 a[208:211], v2, s[8:11], s50 offen offset:128 nt
    buffer_load_dwordx4 a[212:215], v2, s[8:11], s50 offen offset:256 nt
    s_bitcmp1_b32 s51, 21
    s_cselect_b32 s50, s63, s1
    s_add_u32 s50, s50, s51
    s_add_u32 s51, s51, 49152
    s_nop 0
    v_mfma_f32_16x16x32_bf16 v[8:11], v[24:27], a[192:195], v[8:11]
    v_mfma_f32_16x16x32_bf16 v[12:15], v[24:27], a[196:199], v[12:15]
    v_mfma_f32_16x16x32_bf16 v[16:19], v[24:27], a[200:203], v[16:19]
    s_call_b64 s[66:67], L_pst
    s_waitcnt vmcnt(6)
    buffer_load_dwordx4 a[192:195], v2, s[8:11], s50 offen offset:0 nt
    buffer_load_dwordx4 a[196:199], v2, s[8:11], s50 offen offset:128 nt
    buffer_load_dwordx4 a[200:203], v2, s[8:11], s50 offen offset:256 nt
    s_bitcmp1_b32 s51, 21
    s_cselect_b32 s50, s63, s1
    s_add_u32 s50, s50, s51
    s_add_u32 s51, s51, 49152
    s_nop 0
    v_mfma_f32_16x16x32_bf16 v[8:11], v[24:27], a[228:231], v[8:11]
    v_mfma_f32_16x16x32_bf16 v[12:15], v[24:27], a[232:235], v[12:15]
    v_mfma_f32_16x16x32_bf16 v[16:19], v[24:27], a[236:239], v[16:19]
    s_call_b64 s[66:67], L_pst
    s_waitcnt vmcnt(6)
    buffer_load_dwordx4 a[228:231], v2, s[8:11], s50 offen offset:0 nt
    buffer_load_dwordx4 a[232:235], v2, s[8:11], s50 offen offset:128 nt
    buffer_load_dwordx4 a[236:239], v2, s[8:11], s50 offen offset:256 nt
    s_bitcmp1_b32 s51, 21
    s_cselect_b32 s50, s63, s1
    s_add_u32 s50, s50, s51
    s_add_u32 s51, s51, 49152
    s_nop 0
    v_mfma_f32_16x16x32_bf16 v[8:11], v[24:27], a[216:219], v[8:11]
    v_mfma_f32_16x16x32_bf16 v[12:15], v[24:27], a[220:223], v[12:15]
    v_mfma_f32_16x16x32_bf16 v[16:19], v[24:27], a[224:227], v[16:19]
    s_call_b64 s[66:67], L_pst
    s_waitcnt vmcnt(6)
    buffer_load_dwordx4 a[216:219], v2, s[8:11], s50 offen offset:0 nt
    buffer_load_dwordx4 a[220:223], v2, s[8:11], s50 offen offset:128 nt
    buffer_load_dwordx4 a[224:227], v2, s[8:11], s50 offen offset:256 nt
    s_bitcmp1_b32 s51, 21
    s_cselect_b32 s50, s63, s1
    s_add_u32 s50, s50, s51
    s_add_u32 s51, s51, 49152
    s_nop 0
    v_mfma_f32_16x16x32_bf16 v[8:11], v[24:27], a[204:207], v[8:11]
    v_mfma_f32_16x16x32_bf16 v[12:15], v[24:27], a[208:211], v[12:15]
    v_mfma_f32_16x16x32_bf16 v[16:19], v[24:27], a[212:215], v[16:19]
    s_call_b64 s[66:67], L_pst
    s_waitcnt vmcnt(6)
    buffer_load_dwordx4 a[204:207], v2, s[8:11], s50 offen offset:0 nt
    buffer_load_dwordx4 a[208:211], v2, s[8:11], s50 offen offset:128 nt
    buffer_load_dwordx4 a[212:215], v2, s[8:11], s50 offen offset:256 nt
    s_bitcmp1_b32 s51, 21
    s_cselect_b32 s50, s63, s1
    s_add_u32 s50, s50, s51
    s_add_u32 s51, s51, 49152
    s_nop 0
    v_mfma_f32_16x16x32_bf16 v[8:11], v[24:27], a[192:195], v[8:11]
    v_mfma_f32_16x16x32_bf16 v[12:15], v[24:27], a[196:199], v[12:15]
    v_mfma_f32_16x16x32_bf16 v[16:19], v[24:27], a[200:203], v[16:19]
    s_call_b64 s[66:67], L_pst
    s_waitcnt vmcnt(6)
    buffer_load_dwordx4 a[192:195], v2, s[8:11], s50 offen offset:0 nt
    buffer_load_dwordx4 a[196:199], v2, s[8:11], s50 offen offset:128 nt
    buffer_load_dwordx4 a[200:203], v2, s[8:11], s50 offen offset:256 nt
    s_bitcmp1_b32 s51, 21
    s_cselect_b32 s50, s63, s1
    s_add_u32 s50, s50, s51
    s_add_u32 s51, s51, 49152
    s_nop 0
    v_mfma_f32_16x16x32_bf16 v[8:11], v[24:27], a[228:231], v[8:11]
    v_mfma_f32_16x16x32_bf16 v[12:15], v[24:27], a[232:235], v[12:15]
    v_mfma_f32_16x16x32_bf16 v[16:19], v[24:27], a[236:239], v[16:19]
    s_call_b64 s[66:67], L_pst
    s_waitcnt vmcnt(6)
    buffer_load_dwordx4 a[228:231], v2, s[8:11], s50 offen offset:0 nt
    buffer_load_dwordx4 a[232:235], v2, s[8:11], s50 offen offset:128 nt
    buffer_load_dwordx4 a[236:239], v2, s[8:11], s50 offen offset:256 nt
    s_bitcmp1_b32 s51, 21
    s_cselect_b32 s50, s63, s1
    s_add_u32 s50, s50, s51
    s_add_u32 s51, s51, 49152
    s_nop 0
    v_mfma_f32_16x16x32_bf16 v[8:11], v[24:27], a[216:219], v[8:11]
    v_mfma_f32_16x16x32_bf16 v[12:15], v[24:27], a[220:223], v[12:15]
    v_mfma_f32_16x16x32_bf16 v[16:19], v[24:27], a[224:227], v[16:19]
    s_call_b64 s[66:67], L_pst
    s_waitcnt vmcnt(6)
    buffer_load_dwordx4 a[216:219], v2, s[8:11], s50 offen offset:0 nt
    buffer_load_dwordx4 a[220:223], v2, s[8:11], s50 offen offset:128 nt
    buffer_load_dwordx4 a[224:227], v2, s[8:11], s50 offen offset:256 nt
    s_bfe_u32 s60, s98, 0x10017
    s_xor_b32 s60, s60, s46
    s_and_b32 s60, s60, 1
    s_lshl_b32 s60, s60, 21
    s_add_u32 s60, s60, 24576
    s_add_u32 s61, s46, 3
    s_and_b32 s61, s61, 3
    s_and_b32 s62, s2, 8
    s_lshl1_add_u32 s61, s61, s62
    s_lshl_b32 s61, s61, 1
    s_lshr_b32 s61, 0xc571b260, s61
    s_lshr_b32 s62, s2, 2
    s_xor_b32 s62, s62, s46
    s_lshl_b32 s62, s62, 3
    s_xor_b32 s61, s61, s62
    s_and_b32 s61, s61, 15
    s_xor_b32 s62, s61, 8
    s_mul_i32 s61, s61, 3072
    s_mul_i32 s62, s62, 3072
    s_sub_u32 s1, s61, s60
    s_sub_u32 s63, s62, s60
    s_bitcmp1_b32 s51, 21
    s_cselect_b32 s50, s63, s1
    s_add_u32 s50, s50, s51
    s_add_u32 s51, s51, 49152
    s_nop 0
    v_mfma_f32_16x16x32_bf16 v[8:11], v[24:27], a[204:207], v[8:11]
    v_mfma_f32_16x16x32_bf16 v[12:15], v[24:27], a[208:211], v[12:15]
    v_mfma_f32_16x16x32_bf16 v[16:19], v[24:27], a[212:215], v[16:19]
    s_call_b64 s[66:67], L_pst
    s_waitcnt vmcnt(6)
    buffer_load_dwordx4 a[204:207], v2, s[8:11], s50 offen offset:0 nt
    buffer_load_dwordx4 a[208:211], v2, s[8:11], s50 offen offset:128 nt
    buffer_load_dwordx4 a[212:215], v2, s[8:11], s50 offen offset:256 nt
    s_bitcmp1_b32 s51, 21
    s_cselect_b32 s50, s63, s1
    s_add_u32 s50, s50, s51
    s_add_u32 s51, s51, 49152
    s_nop 0
    v_mfma_f32_16x16x32_bf16 v[8:11], v[24:27], a[192:195], v[8:11]
    v_mfma_f32_16x16x32_bf16 v[12:15], v[24:27], a[196:199], v[12:15]
    v_mfma_f32_16x16x32_bf16 v[16:19], v[24:27], a[200:203], v[16:19]
    s_call_b64 s[66:67], L_pst
    s_waitcnt vmcnt(6)
    buffer_load_dwordx4 a[192:195], v2, s[8:11], s50 offen offset:0 nt
    buffer_load_dwordx4 a[196:199], v2, s[8:11], s50 offen offset:128 nt
    buffer_load_dwordx4 a[200:203], v2, s[8:11], s50 offen offset:256 nt
    s_bitcmp1_b32 s51, 21
    s_cselect_b32 s50, s63, s1
    s_add_u32 s50, s50, s51
    s_add_u32 s51, s51, 49152
    s_nop 0
    v_mfma_f32_16x16x32_bf16 v[8:11], v[24:27], a[228:231], v[8:11]
    v_mfma_f32_16x16x32_bf16 v[12:15], v[24:27], a[232:235], v[12:15]
    v_mfma_f32_16x16x32_bf16 v[16:19], v[24:27], a[236:239], v[16:19]
    s_call_b64 s[66:67], L_pst
    s_waitcnt vmcnt(6)
    buffer_load_dwordx4 a[228:231], v2, s[8:11], s50 offen offset:0 nt
    buffer_load_dwordx4 a[232:235], v2, s[8:11], s50 offen offset:128 nt
    buffer_load_dwordx4 a[236:239], v2, s[8:11], s50 offen offset:256 nt
    s_bitcmp1_b32 s51, 21
    s_cselect_b32 s50, s63, s1
    s_add_u32 s50, s50, s51
    s_add_u32 s51, s51, 49152
    s_nop 0
    v_mfma_f32_16x16x32_bf16 v[8:11], v[24:27], a[216:219], v[8:11]
    v_mfma_f32_16x16x32_bf16 v[12:15], v[24:27], a[220:223], v[12:15]
    v_mfma_f32_16x16x32_bf16 v[16:19], v[24:27], a[224:227], v[16:19]
    s_call_b64 s[66:67], L_pst
    s_waitcnt vmcnt(6)
    buffer_load_dwordx4 a[216:219], v2, s[8:11], s50 offen offset:0 nt
    buffer_load_dwordx4 a[220:223], v2, s[8:11], s50 offen offset:128 nt
    buffer_load_dwordx4 a[224:227], v2, s[8:11], s50 offen offset:256 nt
    s_bitcmp1_b32 s51, 21
    s_cselect_b32 s50, s63, s1
    s_add_u32 s50, s50, s51
    s_add_u32 s51, s51, 49152
    s_nop 0
    v_mfma_f32_16x16x32_bf16 v[8:11], v[24:27], a[204:207], v[8:11]
    v_mfma_f32_16x16x32_bf16 v[12:15], v[24:27], a[208:211], v[12:15]
    v_mfma_f32_16x16x32_bf16 v[16:19], v[24:27], a[212:215], v[16:19]
    s_call_b64 s[66:67], L_pst
    s_waitcnt vmcnt(6)
    buffer_load_dwordx4 a[204:207], v2, s[8:11], s50 offen offset:0 nt
    buffer_load_dwordx4 a[208:211], v2, s[8:11], s50 offen offset:128 nt
    buffer_load_dwordx4 a[212:215], v2, s[8:11], s50 offen offset:256 nt
    s_bitcmp1_b32 s51, 21
    s_cselect_b32 s50, s63, s1
    s_add_u32 s50, s50, s51
    s_add_u32 s51, s51, 49152
    s_nop 0
    v_mfma_f32_16x16x32_bf16 v[8:11], v[24:27], a[192:195], v[8:11]
    v_mfma_f32_16x16x32_bf16 v[12:15], v[24:27], a[196:199], v[12:15]
    v_mfma_f32_16x16x32_bf16 v[16:19], v[24:27], a[200:203], v[16:19]
    s_call_b64 s[66:67], L_pst
    s_waitcnt vmcnt(6)
    buffer_load_dwordx4 a[192:195], v2, s[8:11], s50 offen offset:0 nt
    buffer_load_dwordx4 a[196:199], v2, s[8:11], s50 offen offset:128 nt
    buffer_load_dwordx4 a[200:203], v2, s[8:11], s50 offen offset:256 nt
    s_bitcmp1_b32 s51, 21
    s_cselect_b32 s50, s63, s1
    s_add_u32 s50, s50, s51
    s_add_u32 s51, s51, 49152
    s_nop 0
    v_mfma_f32_16x16x32_bf16 v[8:11], v[24:27], a[228:231], v[8:11]
    v_mfma_f32_16x16x32_bf16 v[12:15], v[24:27], a[232:235], v[12:15]
    v_mfma_f32_16x16x32_bf16 v[16:19], v[24:27], a[236:239], v[16:19]
    s_call_b64 s[66:67], L_pst
    s_waitcnt vmcnt(6)
    buffer_load_dwordx4 a[228:231], v2, s[8:11], s50 offen offset:0 nt
    buffer_load_dwordx4 a[232:235], v2, s[8:11], s50 offen offset:128 nt
    buffer_load_dwordx4 a[236:239], v2, s[8:11], s50 offen offset:256 nt
    s_bitcmp1_b32 s51, 21
    s_cselect_b32 s50, s63, s1
    s_add_u32 s50, s50, s51
    s_add_u32 s51, s51, 49152
    s_nop 0
    v_mfma_f32_16x16x32_bf16 v[8:11], v[24:27], a[216:219], v[8:11]
    v_mfma_f32_16x16x32_bf16 v[12:15], v[24:27], a[220:223], v[12:15]
    v_mfma_f32_16x16x32_bf16 v[16:19], v[24:27], a[224:227], v[16:19]
    s_call_b64 s[66:67], L_pst
    s_waitcnt vmcnt(6)
    buffer_load_dwordx4 a[216:219], v2, s[8:11], s50 offen offset:0 nt
    buffer_load_dwordx4 a[220:223], v2, s[8:11], s50 offen offset:128 nt
    buffer_load_dwordx4 a[224:227], v2, s[8:11], s50 offen offset:256 nt
    s_bitcmp1_b32 s51, 21
    s_cselect_b32 s50, s63, s1
    s_add_u32 s50, s50, s51
    s_add_u32 s51, s51, 49152
    s_nop 0
    v_mfma_f32_16x16x32_bf16 v[8:11], v[24:27], a[204:207], v[8:11]
    v_mfma_f32_16x16x32_bf16 v[12:15], v[24:27], a[208:211], v[12:15]
    v_mfma_f32_16x16x32_bf16 v[16:19], v[24:27], a[212:215], v[16:19]
    s_call_b64 s[66:67], L_pst
    s_waitcnt vmcnt(6)
    buffer_load_dwordx4 a[204:207], v2, s[8:11], s50 offen offset:0 nt
    buffer_load_dwordx4 a[208:211], v2, s[8:11], s50 offen offset:128 nt
    buffer_load_dwordx4 a[212:215], v2, s[8:11], s50 offen offset:256 nt
    s_bitcmp1_b32 s51, 21
    s_cselect_b32 s50, s63, s1
    s_add_u32 s50, s50, s51
    s_add_u32 s51, s51, 49152
    s_nop 0
    v_mfma_f32_16x16x32_bf16 v[8:11], v[24:27], a[192:195], v[8:11]
    v_mfma_f32_16x16x32_bf16 v[12:15], v[24:27], a[196:199], v[12:15]
    v_mfma_f32_16x16x32_bf16 v[16:19], v[24:27], a[200:203], v[16:19]
    s_call_b64 s[66:67], L_pst
    s_waitcnt vmcnt(6)
    buffer_load_dwordx4 a[192:195], v2, s[8:11], s50 offen offset:0 nt
    buffer_load_dwordx4 a[196:199], v2, s[8:11], s50 offen offset:128 nt
    buffer_load_dwordx4 a[200:203], v2, s[8:11], s50 offen offset:256 nt
    s_bitcmp1_b32 s51, 21
    s_cselect_b32 s50, s63, s1
    s_add_u32 s50, s50, s51
    s_add_u32 s51, s51, 49152
    s_nop 0
    v_mfma_f32_16x16x32_bf16 v[8:11], v[24:27], a[228:231], v[8:11]
    v_mfma_f32_16x16x32_bf16 v[12:15], v[24:27], a[232:235], v[12:15]
    v_mfma_f32_16x16x32_bf16 v[16:19], v[24:27], a[236:239], v[16:19]
    s_call_b64 s[66:67], L_pst
    s_waitcnt vmcnt(6)
    buffer_load_dwordx4 a[228:231], v2, s[8:11], s50 offen offset:0 nt
    buffer_load_dwordx4 a[232:235], v2, s[8:11], s50 offen offset:128 nt
    buffer_load_dwordx4 a[236:239], v2, s[8:11], s50 offen offset:256 nt
    s_bitcmp1_b32 s51, 21
    s_cselect_b32 s50, s63, s1
    s_add_u32 s50, s50, s51
    s_add_u32 s51, s51, 49152
    s_nop 0
    v_mfma_f32_16x16x32_bf16 v[8:11], v[24:27], a[216:219], v[8:11]
    v_mfma_f32_16x16x32_bf16 v[12:15], v[24:27], a[220:223], v[12:15]
    v_mfma_f32_16x16x32_bf16 v[16:19], v[24:27], a[224:227], v[16:19]
    s_call_b64 s[66:67], L_pst
    s_waitcnt vmcnt(6)
    buffer_load_dwordx4 a[216:219], v2, s[8:11], s50 offen offset:0 nt
    buffer_load_dwordx4 a[220:223], v2, s[8:11], s50 offen offset:128 nt
    buffer_load_dwordx4 a[224:227], v2, s[8:11], s50 offen offset:256 nt
    s_bitcmp1_b32 s51, 21
    s_cselect_b32 s50, s63, s1
    s_add_u32 s50, s50, s51
    s_add_u32 s51, s51, 49152
    s_nop 0
    v_mfma_f32_16x16x32_bf16 v[8:11], v[24:27], a[204:207], v[8:11]
    v_mfma_f32_16x16x32_bf16 v[12:15], v[24:27], a[208:211], v[12:15]
    v_mfma_f32_16x16x32_bf16 v[16:19], v[24:27], a[212:215], v[16:19]
    s_call_b64 s[66:67], L_pst
    s_waitcnt vmcnt(6)
    buffer_load_dwordx4 a[204:207], v2, s[8:11], s50 offen offset:0 nt
    buffer_load_dwordx4 a[208:211], v2, s[8:11], s50 offen offset:128 nt
    buffer_load_dwordx4 a[212:215], v2, s[8:11], s50 offen offset:256 nt
    s_bitcmp1_b32 s51, 21
    s_cselect_b32 s50, s63, s1
    s_add_u32 s50, s50, s51
    s_add_u32 s51, s51, 49152
    s_nop 0
    v_mfma_f32_16x16x32_bf16 v[8:11], v[24:27], a[192:195], v[8:11]
    v_mfma_f32_16x16x32_bf16 v[12:15], v[24:27], a[196:199], v[12:15]
    v_mfma_f32_16x16x32_bf16 v[16:19], v[24:27], a[200:203], v[16:19]
    s_call_b64 s[66:67], L_pst
    s_waitcnt vmcnt(6)
    buffer_load_dwordx4 a[192:195], v2, s[8:11], s50 offen offset:0 nt
    buffer_load_dwordx4 a[196:199], v2, s[8:11], s50 offen offset:128 nt
    buffer_load_dwordx4 a[200:203], v2, s[8:11], s50 offen offset:256 nt
    s_bitcmp1_b32 s51, 21
    s_cselect_b32 s50, s63, s1
    s_add_u32 s50, s50, s51
    s_add_u32 s51, s51, 49152
    s_nop 0
    v_mfma_f32_16x16x32_bf16 v[8:11], v[24:27], a[228:231], v[8:11]
    v_mfma_f32_16x16x32_bf16 v[12:15], v[24:27], a[232:235], v[12:15]
    v_mfma_f32_16x16x32_bf16 v[16:19], v[24:27], a[236:239], v[16:19]
    s_call_b64 s[66:67], L_pst
    s_waitcnt vmcnt(6)
    buffer_load_dwordx4 a[228:231], v2, s[8:11], s50 offen offset:0 nt
    buffer_load_dwordx4 a[232:235], v2, s[8:11], s50 offen offset:128 nt
    buffer_load_dwordx4 a[236:239], v2, s[8:11], s50 offen offset:256 nt
    s_bitcmp1_b32 s51, 21
    s_cselect_b32 s50, s63, s1
    s_add_u32 s50, s50, s51
    s_add_u32 s51, s51, 49152
    s_nop 0
    v_mfma_f32_16x16x32_bf16 v[8:11], v[24:27], a[216:219], v[8:11]
    v_mfma_f32_16x16x32_bf16 v[12:15], v[24:27], a[220:223], v[12:15]
    v_mfma_f32_16x16x32_bf16 v[16:19], v[24:27], a[224:227], v[16:19]
    s_call_b64 s[66:67], L_pst
    s_waitcnt vmcnt(6)
    buffer_load_dwordx4 a[216:219], v2, s[8:11], s50 offen offset:0 nt
    buffer_load_dwordx4 a[220:223], v2, s[8:11], s50 offen offset:128 nt
    buffer_load_dwordx4 a[224:227], v2, s[8:11], s50 offen offset:256 nt
    s_bitcmp1_b32 s51, 21
    s_cselect_b32 s50, s63, s1
    s_add_u32 s50, s50, s51
    s_add_u32 s51, s51, 49152
    s_nop 0
    v_mfma_f32_16x16x32_bf16 v[8:11], v[24:27], a[204:207], v[8:11]
    v_mfma_f32_16x16x32_bf16 v[12:15], v[24:27], a[208:211], v[12:15]
    v_mfma_f32_16x16x32_bf16 v[16:19], v[24:27], a[212:215], v[16:19]
    s_call_b64 s[66:67], L_pst
    s_waitcnt vmcnt(6)
    buffer_load_dwordx4 a[204:207], v2, s[8:11], s50 offen offset:0 nt
    buffer_load_dwordx4 a[208:211], v2, s[8:11], s50 offen offset:128 nt
    buffer_load_dwordx4 a[212:215], v2, s[8:11], s50 offen offset:256 nt
    s_bitcmp1_b32 s51, 21
    s_cselect_b32 s50, s63, s1
    s_add_u32 s50, s50, s51
    s_add_u32 s51, s51, 49152
    s_nop 0
    v_mfma_f32_16x16x32_bf16 v[8:11], v[24:27], a[192:195], v[8:11]
    v_mfma_f32_16x16x32_bf16 v[12:15], v[24:27], a[196:199], v[12:15]
    v_mfma_f32_16x16x32_bf16 v[16:19], v[24:27], a[200:203], v[16:19]
    s_call_b64 s[66:67], L_pst
    s_waitcnt vmcnt(6)
    buffer_load_dwordx4 a[192:195], v2, s[8:11], s50 offen offset:0 nt
    buffer_load_dwordx4 a[196:199], v2, s[8:11], s50 offen offset:128 nt
    buffer_load_dwordx4 a[200:203], v2, s[8:11], s50 offen offset:256 nt
    s_bitcmp1_b32 s51, 21
    s_cselect_b32 s50, s63, s1
    s_add_u32 s50, s50, s51
    s_add_u32 s51, s51, 49152
    s_nop 0
    v_mfma_f32_16x16x32_bf16 v[8:11], v[24:27], a[228:231], v[8:11]
    v_mfma_f32_16x16x32_bf16 v[12:15], v[24:27], a[232:235], v[12:15]
    v_mfma_f32_16x16x32_bf16 v[16:19], v[24:27], a[236:239], v[16:19]
    s_call_b64 s[66:67], L_pst
    s_waitcnt vmcnt(6)
    buffer_load_dwordx4 a[228:231], v2, s[8:11], s50 offen offset:0 nt
    buffer_load_dwordx4 a[232:235], v2, s[8:11], s50 offen offset:128 nt
    buffer_load_dwordx4 a[236:239], v2, s[8:11], s50 offen offset:256 nt
    s_bitcmp1_b32 s51, 21
    s_cselect_b32 s50, s63, s1
    s_add_u32 s50, s50, s51
    s_add_u32 s51, s51, 49152
    s_nop 0
    v_mfma_f32_16x16x32_bf16 v[8:11], v[24:27], a[216:219], v[8:11]
    v_mfma_f32_16x16x32_bf16 v[12:15], v[24:27], a[220:223], v[12:15]
    v_mfma_f32_16x16x32_bf16 v[16:19], v[24:27], a[224:227], v[16:19]
    s_call_b64 s[66:67], L_pst
    s_waitcnt vmcnt(6)
    buffer_load_dwordx4 a[216:219], v2, s[8:11], s50 offen offset:0 nt
    buffer_load_dwordx4 a[220:223], v2, s[8:11], s50 offen offset:128 nt
    buffer_load_dwordx4 a[224:227], v2, s[8:11], s50 offen offset:256 nt
    s_bitcmp1_b32 s51, 21
    s_cselect_b32 s50, s63, s1
    s_add_u32 s50, s50, s51
    s_add_u32 s51, s51, 49152
    s_nop 0
    v_mfma_f32_16x16x32_bf16 v[8:11], v[24:27], a[204:207], v[8:11]
    v_mfma_f32_16x16x32_bf16 v[12:15], v[24:27], a[208:211], v[12:15]
    v_mfma_f32_16x16x32_bf16 v[16:19], v[24:27], a[212:215], v[16:19]
    s_call_b64 s[66:67], L_pst
    s_waitcnt vmcnt(6)
    buffer_load_dwordx4 a[204:207], v2, s[8:11], s50 offen offset:0 nt
    buffer_load_dwordx4 a[208:211], v2, s[8:11], s50 offen offset:128 nt
    buffer_load_dwordx4 a[212:215], v2, s[8:11], s50 offen offset:256 nt
    s_bfe_u32 s60, s98, 0x10017
    s_xor_b32 s60, s60, s46
    s_and_b32 s60, s60, 1
    s_lshl_b32 s60, s60, 21
    s_add_u32 s60, s60, 24576
    s_add_u32 s61, s46, 0
    s_and_b32 s61, s61, 3
    s_and_b32 s62, s2, 8
    s_lshl1_add_u32 s61, s61, s62
    s_lshl_b32 s61, s61, 1
    s_lshr_b32 s61, 0xc571b260, s61
    s_lshr_b32 s62, s2, 2
    s_xor_b32 s62, s62, s46
    s_lshl_b32 s62, s62, 3
    s_xor_b32 s61, s61, s62
    s_and_b32 s61, s61, 15
    s_xor_b32 s62, s61, 8
    s_mul_i32 s61, s61, 3072
    s_mul_i32 s62, s62, 3072
    s_sub_u32 s1, s61, s60
    s_sub_u32 s63, s62, s60
    s_bitcmp1_b32 s51, 21
    s_cselect_b32 s50, s63, s1
    s_add_u32 s50, s50, s51
    s_add_u32 s51, s51, 49152
    s_nop 0
    v_mfma_f32_16x16x32_bf16 v[8:11], v[24:27], a[192:195], v[8:11]
    v_mfma_f32_16x16x32_bf16 v[12:15], v[24:27], a[196:199], v[12:15]
    v_mfma_f32_16x16x32_bf16 v[16:19], v[24:27], a[200:203], v[16:19]
    s_call_b64 s[66:67], L_pst
    s_waitcnt vmcnt(6)
    buffer_load_dwordx4 a[192:195], v2, s[8:11], s50 offen offset:0 nt
    buffer_load_dwordx4 a[196:199], v2, s[8:11], s50 offen offset:128 nt
    buffer_load_dwordx4 a[200:203], v2, s[8:11], s50 offen offset:256 nt
    s_bitcmp1_b32 s51, 21
    s_cselect_b32 s50, s63, s1
    s_add_u32 s50, s50, s51
    s_add_u32 s51, s51, 49152
    s_nop 0
    v_mfma_f32_16x16x32_bf16 v[8:11], v[24:27], a[228:231], v[8:11]
    v_mfma_f32_16x16x32_bf16 v[12:15], v[24:27], a[232:235], v[12:15]
    v_mfma_f32_16x16x32_bf16 v[16:19], v[24:27], a[236:239], v[16:19]
    s_call_b64 s[66:67], L_pst
    s_waitcnt vmcnt(6)
    buffer_load_dwordx4 a[228:231], v2, s[8:11], s50 offen offset:0 nt
    buffer_load_dwordx4 a[232:235], v2, s[8:11], s50 offen offset:128 nt
    buffer_load_dwordx4 a[236:239], v2, s[8:11], s50 offen offset:256 nt
    s_bitcmp1_b32 s51, 21
    s_cselect_b32 s50, s63, s1
    s_add_u32 s50, s50, s51
    s_add_u32 s51, s51, 49152
    s_nop 0
    v_mfma_f32_16x16x32_bf16 v[8:11], v[24:27], a[216:219], v[8:11]
    v_mfma_f32_16x16x32_bf16 v[12:15], v[24:27], a[220:223], v[12:15]
    v_mfma_f32_16x16x32_bf16 v[16:19], v[24:27], a[224:227], v[16:19]
    s_call_b64 s[66:67], L_pst
    s_waitcnt vmcnt(6)
    buffer_load_dwordx4 a[216:219], v2, s[8:11], s50 offen offset:0 nt
    buffer_load_dwordx4 a[220:223], v2, s[8:11], s50 offen offset:128 nt
    buffer_load_dwordx4 a[224:227], v2, s[8:11], s50 offen offset:256 nt
    s_bitcmp1_b32 s51, 21
    s_cselect_b32 s50, s63, s1
    s_add_u32 s50, s50, s51
    s_add_u32 s51, s51, 49152
    s_nop 0
    v_mfma_f32_16x16x32_bf16 v[8:11], v[24:27], a[204:207], v[8:11]
    v_mfma_f32_16x16x32_bf16 v[12:15], v[24:27], a[208:211], v[12:15]
    v_mfma_f32_16x16x32_bf16 v[16:19], v[24:27], a[212:215], v[16:19]
    s_call_b64 s[66:67], L_pst
    s_waitcnt vmcnt(6)
    buffer_load_dwordx4 a[204:207], v2, s[8:11], s50 offen offset:0 nt
    buffer_load_dwordx4 a[208:211], v2, s[8:11], s50 offen offset:128 nt
    buffer_load_dwordx4 a[212:215], v2, s[8:11], s50 offen offset:256 nt
    s_bitcmp1_b32 s51, 21
    s_cselect_b32 s50, s63, s1
    s_add_u32 s50, s50, s51
    s_add_u32 s51, s51, 49152
    s_nop 0
    v_mfma_f32_16x16x32_bf16 v[8:11], v[24:27], a[192:195], v[8:11]
    v_mfma_f32_16x16x32_bf16 v[12:15], v[24:27], a[196:199], v[12:15]
    v_mfma_f32_16x16x32_bf16 v[16:19], v[24:27], a[200:203], v[16:19]
    s_call_b64 s[66:67], L_pst
    s_waitcnt vmcnt(6)
    buffer_load_dwordx4 a[192:195], v2, s[8:11], s50 offen offset:0 nt
    buffer_load_dwordx4 a[196:199], v2, s[8:11], s50 offen offset:128 nt
    buffer_load_dwordx4 a[200:203], v2, s[8:11], s50 offen offset:256 nt
    s_bitcmp1_b32 s51, 21
    s_cselect_b32 s50, s63, s1
    s_add_u32 s50, s50, s51
    s_add_u32 s51, s51, 49152
    s_nop 0
    v_mfma_f32_16x16x32_bf16 v[8:11], v[24:27], a[228:231], v[8:11]
    v_mfma_f32_16x16x32_bf16 v[12:15], v[24:27], a[232:235], v[12:15]
    v_mfma_f32_16x16x32_bf16 v[16:19], v[24:27], a[236:239], v[16:19]
    s_call_b64 s[66:67], L_pst
    s_waitcnt vmcnt(6)
    buffer_load_dwordx4 a[228:231], v2, s[8:11], s50 offen offset:0 nt
    buffer_load_dwordx4 a[232:235], v2, s[8:11], s50 offen offset:128 nt
    buffer_load_dwordx4 a[236:239], v2, s[8:11], s50 offen offset:256 nt
    s_bitcmp1_b32 s51, 21
    s_cselect_b32 s50, s63, s1
    s_add_u32 s50, s50, s51
    s_add_u32 s51, s51, 49152
    s_nop 0
    v_mfma_f32_16x16x32_bf16 v[8:11], v[24:27], a[216:219], v[8:11]
    v_mfma_f32_16x16x32_bf16 v[12:15], v[24:27], a[220:223], v[12:15]
    v_mfma_f32_16x16x32_bf16 v[16:19], v[24:27], a[224:227], v[16:19]
    s_call_b64 s[66:67], L_pst
    s_waitcnt vmcnt(6)
    buffer_load_dwordx4 a[216:219], v2, s[8:11], s50 offen offset:0 nt
    buffer_load_dwordx4 a[220:223], v2, s[8:11], s50 offen offset:128 nt
    buffer_load_dwordx4 a[224:227], v2, s[8:11], s50 offen offset:256 nt
    s_bitcmp1_b32 s51, 21
    s_cselect_b32 s50, s63, s1
    s_add_u32 s50, s50, s51
    s_add_u32 s51, s51, 49152
    s_nop 0
    v_mfma_f32_16x16x32_bf16 v[8:11], v[24:27], a[204:207], v[8:11]
    v_mfma_f32_16x16x32_bf16 v[12:15], v[24:27], a[208:211], v[12:15]
    v_mfma_f32_16x16x32_bf16 v[16:19], v[24:27], a[212:215], v[16:19]
    s_call_b64 s[66:67], L_pst
    s_waitcnt vmcnt(6)
    buffer_load_dwordx4 a[204:207], v2, s[8:11], s50 offen offset:0 nt
    buffer_load_dwordx4 a[208:211], v2, s[8:11], s50 offen offset:128 nt
    buffer_load_dwordx4 a[212:215], v2, s[8:11], s50 offen offset:256 nt
    s_bitcmp1_b32 s51, 21
    s_cselect_b32 s50, s63, s1
    s_add_u32 s50, s50, s51
    s_add_u32 s51, s51, 49152
    s_nop 0
    v_mfma_f32_16x16x32_bf16 v[8:11], v[24:27], a[192:195], v[8:11]
    v_mfma_f32_16x16x32_bf16 v[12:15], v[24:27], a[196:199], v[12:15]
    v_mfma_f32_16x16x32_bf16 v[16:19], v[24:27], a[200:203], v[16:19]
    s_call_b64 s[66:67], L_pst
    s_waitcnt vmcnt(6)
    buffer_load_dwordx4 a[192:195], v2, s[8:11], s50 offen offset:0 nt
    buffer_load_dwordx4 a[196:199], v2, s[8:11], s50 offen offset:128 nt
    buffer_load_dwordx4 a[200:203], v2, s[8:11], s50 offen offset:256 nt
    s_bitcmp1_b32 s51, 21
    s_cselect_b32 s50, s63, s1
    s_add_u32 s50, s50, s51
    s_add_u32 s51, s51, 49152
    s_nop 0
    v_mfma_f32_16x16x32_bf16 v[8:11], v[24:27], a[228:231], v[8:11]
    v_mfma_f32_16x16x32_bf16 v[12:15], v[24:27], a[232:235], v[12:15]
    v_mfma_f32_16x16x32_bf16 v[16:19], v[24:27], a[236:239], v[16:19]
    s_call_b64 s[66:67], L_pst
    s_waitcnt vmcnt(6)
    buffer_load_dwordx4 a[228:231], v2, s[8:11], s50 offen offset:0 nt
    buffer_load_dwordx4 a[232:235], v2, s[8:11], s50 offen offset:128 nt
    buffer_load_dwordx4 a[236:239], v2, s[8:11], s50 offen offset:256 nt
    s_bitcmp1_b32 s51, 21
    s_cselect_b32 s50, s63, s1
    s_add_u32 s50, s50, s51
    s_add_u32 s51, s51, 49152
    s_nop 0
    v_mfma_f32_16x16x32_bf16 v[8:11], v[24:27], a[216:219], v[8:11]
    v_mfma_f32_16x16x32_bf16 v[12:15], v[24:27], a[220:223], v[12:15]
    v_mfma_f32_16x16x32_bf16 v[16:19], v[24:27], a[224:227], v[16:19]
    s_call_b64 s[66:67], L_pst
    s_waitcnt vmcnt(6)
    buffer_load_dwordx4 a[216:219], v2, s[8:11], s50 offen offset:0 nt
    buffer_load_dwordx4 a[220:223], v2, s[8:11], s50 offen offset:128 nt
    buffer_load_dwordx4 a[224:227], v2, s[8:11], s50 offen offset:256 nt
    s_nop 0
    v_mfma_f32_16x16x32_bf16 v[8:11], v[24:27], a[204:207], v[8:11]
    v_mfma_f32_16x16x32_bf16 v[12:15], v[24:27], a[208:211], v[12:15]
    v_mfma_f32_16x16x32_bf16 v[16:19], v[24:27], a[212:215], v[16:19]
    s_call_b64 s[66:67], L_pst
    v_lshrrev_b32 v38, 3, v0
    v_mul_u32_u24 v38, 1280, v38
    v_and_b32 v39, 7, v0
    v_lshl_add_u32 v38, v39, 4, v38
    s_mul_i32 s61, s44, 24
    s_add_u32 s61, s61, s45
    s_mul_i32 s61, s61, 10240
    s_lshl_b32 s62, s46, 7
    s_add_u32 s61, s61, s62
    s_add_u32 s61, s61, 0
    buffer_load_dwordx4 v[52:55], v38, s[20:23], s61 offen offset:0 nt
    buffer_load_dwordx4 v[56:59], v38, s[20:23], s61 offen offset:512 nt
    s_cmp_lt_u32 s46, 2
    s_cselect_b64 exec, -1, 1
    buffer_load_dwordx4 v[60:63], v38, s[20:23], s61 offen offset:1024 nt
    s_mov_b64 exec, -1
    s_waitcnt vmcnt(9)
    s_nop 0
    v_mfma_f32_16x16x32_bf16 v[8:11], v[24:27], a[192:195], v[8:11]
    v_mfma_f32_16x16x32_bf16 v[12:15], v[24:27], a[196:199], v[12:15]
    v_mfma_f32_16x16x32_bf16 v[16:19], v[24:27], a[200:203], v[16:19]
    s_call_b64 s[66:67], L_pst
    v_lshrrev_b32 v38, 3, v0
    v_mul_u32_u24 v38, 1280, v38
    v_and_b32 v39, 7, v0
    v_lshl_add_u32 v38, v39, 4, v38
    s_mul_i32 s61, s44, 24
    s_add_u32 s61, s61, s45
    s_mul_i32 s61, s61, 10240
    s_lshl_b32 s62, s46, 7
    s_add_u32 s61, s61, s62
    s_add_u32 s61, s61, 81920
    buffer_load_dwordx4 v[64:67], v38, s[20:23], s61 offen offset:0 nt
    buffer_load_dwordx4 v[68:71], v38, s[20:23], s61 offen offset:512 nt
    s_cmp_lt_u32 s46, 2
    s_cselect_b64 exec, -1, 1
    buffer_load_dwordx4 v[72:75], v38, s[20:23], s61 offen offset:1024 nt
    s_mov_b64 exec, -1
    s_waitcnt vmcnt(9)
    s_nop 0
    v_mfma_f32_16x16x32_bf16 v[8:11], v[24:27], a[228:231], v[8:11]
    v_mfma_f32_16x16x32_bf16 v[12:15], v[24:27], a[232:235], v[12:15]
    v_mfma_f32_16x16x32_bf16 v[16:19], v[24:27], a[236:239], v[16:19]
    s_call_b64 s[66:67], L_pst
    v_lshrrev_b32 v38, 3, v0
    v_mul_u32_u24 v38, 1280, v38
    v_and_b32 v39, 7, v0
    v_lshl_add_u32 v38, v39, 4, v38
    s_mul_i32 s61, s44, 24
    s_add_u32 s61, s61, s45
    s_mul_i32 s61, s61, 10240
    s_lshl_b32 s62, s46, 7
    s_add_u32 s61, s61, s62
    s_add_u32 s61, s61, 163840
    buffer_load_dwordx4 a[240:243], v38, s[20:23], s61 offen offset:0 nt
    buffer_load_dwordx4 a[244:247], v38, s[20:23], s61 offen offset:512 nt
    s_cmp_lt_u32 s46, 2
    s_cselect_b64 exec, -1, 1
    buffer_load_dwordx4 a[248:251], v38, s[20:23], s61 offen offset:1024 nt
    s_mov_b64 exec, -1
    s_mov_b32 s64, 0
    v_add_f32_dpp v29, v29, v29 row_ror:8 row_mask:0xf bank_mask:0xf
    v_sub_f32 v28, 0, v28
    s_lshl_b32 s60, s64, 2
    v_add_f32_dpp v29, v29, v29 row_bcast:15 row_mask:0xa bank_mask:0xf
    s_add_u32 s60, s60, s46
    s_lshl_b32 s60, s60, 3
    v_add_f32_dpp v29, v29, v29 row_bcast:31 row_mask:0xc bank_mask:0xf
    s_add_u32 s60, s60, 159744
    v_mov_b32 v30, s60
    s_mov_b32 exec_lo, 0
    s_mov_b32 exec_hi, 0x80000000
    ds_write_b64 v30, v[28:29]
    s_mov_b64 exec, -1
    s_lshl_b32 s60, s46, 1
    s_add_u32 s60, s60, s64
    s_mul_i32 s60, s60, 768
    s_add_u32 s60, s60, 153600
    v_lshrrev_b32 v31, 5, v0
    v_lshl_add_u32 v31, v31, 8, s60
    v_and_b32 v39, 7, v0
    v_lshl_add_u32 v31, v39, 5, v31
    v_and_b32 v39, 16, v0
    v_add_u32 v31, v31, v39
    s_waitcnt vmcnt(9)
    s_nop 0
    v_mfma_f32_16x16x32_bf16 v[8:11], v[24:27], a[216:219], v[8:11]
    v_mfma_f32_16x16x32_bf16 v[12:15], v[24:27], a[220:223], v[12:15]
    v_mfma_f32_16x16x32_bf16 v[16:19], v[24:27], a[224:227], v[16:19]
    s_branch L_passend
    .p2align 12
L_passend:
    s_nop 7
    v_permlane32_swap_b32 v8, v12
    v_permlane32_swap_b32 v9, v13
    v_permlane32_swap_b32 v10, v14
    v_permlane32_swap_b32 v11, v15
    v_permlane32_swap_b32 v16, v20
    v_permlane32_swap_b32 v17, v21
    v_permlane32_swap_b32 v18, v22
    v_permlane32_swap_b32 v19, v23
    v_add_f32_dpp v8, v12, v8 row_ror:8 row_mask:0xf bank_mask:0xf
    v_add_f32_dpp v9, v13, v9 row_ror:8 row_mask:0xf bank_mask:0xf
    v_add_f32_dpp v10, v14, v10 row_ror:8 row_mask:0xf bank_mask:0xf
    v_add_f32_dpp v11, v15, v11 row_ror:8 row_mask:0xf bank_mask:0xf
    v_add_f32_dpp v16, v20, v16 row_ror:8 row_mask:0xf bank_mask:0xf
    v_add_f32_dpp v17, v21, v17 row_ror:8 row_mask:0xf bank_mask:0xf
    v_add_f32_dpp v18, v22, v18 row_ror:8 row_mask:0xf bank_mask:0xf
    v_add_f32_dpp v19, v23, v19 row_ror:8 row_mask:0xf bank_mask:0xf
    s_mov_b32 exec_lo, 0x00ff00ff
    s_mov_b32 exec_hi, 0x00ff00ff
    ds_write_b128 v31, v[8:11]
    s_mov_b32 exec_hi, 0
    ds_write_b128 v31, v[16:19] offset:512
    s_mov_b64 exec, -1
    s_lshl_b32 s60, s46, 5
    s_add_u32 s60, s60, 159744
    v_mov_b32 v36, s60
    s_mul_i32 s60, s46, 768
    s_add_u32 s60, s60, 153600
    v_lshl_add_u32 v30, v0, 2, s60
    s_cmp_gt_u32 s46, 1
    s_waitcnt lgkmcnt(0)
    s_barrier
    s_cbranch_scc1 L_ajoin_92
    ds_read_b128 v[32:35], v36
    ds_read_b128 v[36:39], v36 offset:16
    ds_read2st64_b32 v[8:9], v30 offset0:0 offset1:1
    ds_read2st64_b32 v[10:11], v30 offset0:2 offset1:6
    ds_read2st64_b32 v[12:13], v30 offset0:7 offset1:8
    ds_read2st64_b32 v[14:15], v30 offset0:12 offset1:13
    ds_read2st64_b32 v[16:17], v30 offset0:14 offset1:18
    ds_read2st64_b32 v[18:19], v30 offset0:19 offset1:20
    s_sub_u32 s60, s57, 21
    s_cselect_b32 s60, 0, s60
    s_cselect_b32 s61, 12, 24
    s_cselect_b32 s62, 12, 64
    s_add_u32 s60, s60, s57
    s_lshl_b32 s60, s60, 7
    s_add_u32 s60, s60, s65
    s_lshl_b32 s60, s60, 7
    s_add_u32 s60, s60, s56
    v_lshrrev_b32 v20, 3, v0
    v_bfe_u32 v20, s98, v20, 1
    v_lshlrev_b32 v20, 13, v20
    v_and_b32 v21, 128, v3
    v_mad_u32_u24 v20, v21, s61, v20
    v_and_b32 v21, 256, v3
    v_mad_u32_u24 v20, v21, s62, v20
    v_and_b32 v21, 7, v0
    v_lshl_add_u32 v20, v21, 4, v20
    v_and_b32 v21, 1, v0
    v_cmp_eq_u32 vcc, 1, v21
    s_waitcnt lgkmcnt(0)
    v_max3_f32 v21, v32, v34, v36
    v_max_f32 v21, v21, v38
    v_sub_f32 v32, v32, v21
    v_sub_f32 v34, v34, v21
    v_sub_f32 v36, v36, v21
    v_sub_f32 v38, v38, v21
    v_exp_f32 v32, v32
    v_exp_f32 v34, v34
    v_exp_f32 v36, v36
    v_exp_f32 v38, v38
    v_mul_f32 v33, v33, v32
    v_mul_f32 v8, v8, v32
    v_mul_f32 v9, v9, v32
    v_mul_f32 v10, v10, v32
    v_fmac_f32 v33, v35, v34
    v_fmac_f32 v8, v11, v34
    v_fmac_f32 v9, v12, v34
    v_fmac_f32 v10, v13, v34
    v_fmac_f32 v33, v37, v36
    v_fmac_f32 v8, v14, v36
    v_fmac_f32 v9, v15, v36
    v_fmac_f32 v10, v16, v36
    v_fmac_f32 v33, v39, v38
    v_fmac_f32 v8, v17, v38
    v_fmac_f32 v9, v18, v38
    v_fmac_f32 v10, v19, v38
    v_cndmask_b32 v11, v21, v33, vcc
    buffer_store_dwordx4 v[8:11], v20, s[12:15], s60 offen offset:0 sc1
L_ajoin_92:
    s_cmp_ge_u32 s46, 2
    s_cbranch_scc1 L_nl2_93
    s_lshr_b32 s64, s2, 6
    s_and_b32 s1, s2, 63
    v_and_or_b32 v39, v0, 4, s46
    v_bfe_u32 v39, s98, v39, 1
    v_and_or_b32 v39, v0, 32, v39
    v_lshlrev_b32 v39, 13, v39
    v_and_b32 v35, 3, v0
    v_lshl_add_u32 v39, v35, 5, v39
    v_and_or_b32 v39, v0, 16, v39
    s_lshl2_add_u32 s64, s46, s64
    s_lshl_b32 s64, s64, 7
    s_add_u32 s64, s64, s1
    s_lshl_b32 s64, s64, 7
    s_add_u32 s64, s64, s56
    s_add_u32 s64, s64, 704512
    s_add_u32 s1, s64, 524288
    v_and_b32 v36, 7, v0
    v_lshlrev_b32 v36, 7, v36
    v_lshrrev_b32 v37, 3, v0
    v_lshl_add_u32 v36, v37, 4, v36
    s_sub_u32 s60, s44, 21
    s_cselect_b32 s60, 0, s60
    s_cselect_b32 s61, 12, 24
    s_cselect_b32 s62, 12, 64
    s_add_u32 s60, s60, s44
    s_lshl_b32 s60, s60, 7
    s_and_b32 s63, s2, 1
    s_mul_i32 s61, s61, s63
    s_and_b32 s63, s2, 2
    s_mul_i32 s62, s62, s63
    s_add_u32 s60, s60, s61
    s_add_u32 s60, s60, s62
    s_lshl_b32 s60, s60, 7
    s_add_u32 s60, s60, s56
    s_bitcmp1_b32 s98, s45
    s_cselect_b32 s61, 8192, 0
    s_add_u32 s60, s60, s61
    s_mov_b64 s[32:33], -1
    s_cmp_lt_u32 s44, 21
    s_cselect_b32 s34, 0x0f0f0f0f, -1
    s_cselect_b32 s40, 0, -1
    s_cmp_eq_u32 s44, 21
    s_cselect_b32 s40, 0x0f0f0f0f, s40
    s_mov_b32 s35, s34
    s_mov_b32 s41, s40
    v_and_b32 v37, 8, v0
    v_cmp_eq_u32 vcc, 0, v37
    v_mov_b32 v37, 0xff800000
    v_mov_b32 v12, 0
    v_mov_b32 v13, 0
    v_mov_b32 v14, 0
    v_mov_b32 v16, 0
    v_mov_b32 v17, 0
    v_mov_b32 v18, 0
    v_cndmask_b32 v15, 0, v37, vcc
    v_cndmask_b32 v19, 0, v37, vcc
    s_mov_b32 s59, 400000
L_poll_95:
    s_mov_b64 exec, s[32:33]
    buffer_load_dwordx4 v[8:11], v36, s[12:15], s60 offen offset:0 sc1
    s_mov_b64 exec, s[34:35]
    buffer_load_dwordx4 v[12:15], v36, s[12:15], s60 offen offset:1024 sc1
    s_mov_b64 exec, s[40:41]
    buffer_load_dwordx4 v[16:19], v36, s[12:15], s60 offen offset:2048 sc1
    s_mov_b64 exec, -1
    s_waitcnt vmcnt(0)
    v_max_u32 v37, v8, v9
    v_max3_u32 v37, v37, v10, v11
    v_cmp_eq_u32 s[32:33], -1, v37
    v_max_u32 v38, v12, v13
    v_max3_u32 v38, v38, v14, v15
    v_cmp_eq_u32 s[34:35], -1, v38
    v_max_u32 v37, v16, v17
    v_max3_u32 v37, v37, v18, v19
    v_cmp_eq_u32 s[40:41], -1, v37
    s_or_b64 vcc, s[32:33], s[34:35]
    s_or_b64 vcc, vcc, s[40:41]
    s_cbranch_scc0 L_got_96
    s_sub_u32 s59, s59, 1
    s_cbranch_scc0 L_poll_95
L_got_96:
    v_mov_b32 v32, v11
    v_mov_b32 v33, v15
    v_mov_b32 v34, v19
    v_mov_b32_dpp v32, v11 row_ror:8 row_mask:0xf bank_mask:0xc
    v_mov_b32_dpp v33, v15 row_ror:8 row_mask:0xf bank_mask:0xc
    v_mov_b32_dpp v34, v19 row_ror:8 row_mask:0xf bank_mask:0xc
    v_mov_b32_dpp v11, v11 row_ror:8 row_mask:0xf bank_mask:0x3
    v_mov_b32_dpp v15, v15 row_ror:8 row_mask:0xf bank_mask:0x3
    v_mov_b32_dpp v19, v19 row_ror:8 row_mask:0xf bank_mask:0x3
    v_max3_f32 v35, v32, v33, v34
    s_nop 1
    v_max_f32_dpp v35, v35, v35 quad_perm:[1,0,3,2] row_mask:0xf bank_mask:0xf
    s_nop 1
    v_max_f32_dpp v35, v35, v35 quad_perm:[2,3,0,1] row_mask:0xf bank_mask:0xf
    s_nop 1
    v_max_f32_dpp v35, v35, v35 row_half_mirror row_mask:0xf bank_mask:0xf
    v_sub_f32 v32, v32, v35
    v_sub_f32 v33, v33, v35
    v_sub_f32 v34, v34, v35
    v_exp_f32 v32, v32
    v_exp_f32 v33, v33
    v_exp_f32 v34, v34
    v_mul_f32 v8, v8, v32
    v_mul_f32 v9, v9, v32
    v_mul_f32 v10, v10, v32
    v_mul_f32 v11, v11, v32
    v_fmac_f32 v8, v12, v33
    v_fmac_f32 v9, v13, v33
    v_fmac_f32 v10, v14, v33
    v_fmac_f32 v11, v15, v33
    v_fmac_f32 v8, v16, v34
    v_fmac_f32 v9, v17, v34
    v_fmac_f32 v10, v18, v34
    v_fmac_f32 v11, v19, v34
    v_add_f32_dpp v8, v8, v8 quad_perm:[1,0,3,2] row_mask:0xf bank_mask:0xf
    v_add_f32_dpp v9, v9, v9 quad_perm:[1,0,3,2] row_mask:0xf bank_mask:0xf
    v_add_f32_dpp v10, v10, v10 quad_perm:[1,0,3,2] row_mask:0xf bank_mask:0xf
    v_add_f32_dpp v11, v11, v11 quad_perm:[1,0,3,2] row_mask:0xf bank_mask:0xf
    v_add_f32_dpp v8, v8, v8 quad_perm:[2,3,0,1] row_mask:0xf bank_mask:0xf
    v_add_f32_dpp v9, v9, v9 quad_perm:[2,3,0,1] row_mask:0xf bank_mask:0xf
    v_add_f32_dpp v10, v10, v10 quad_perm:[2,3,0,1] row_mask:0xf bank_mask:0xf
    v_add_f32_dpp v11, v11, v11 quad_perm:[2,3,0,1] row_mask:0xf bank_mask:0xf
    v_add_f32_dpp v8, v8, v8 row_half_mirror row_mask:0xf bank_mask:0xf
    v_add_f32_dpp v9, v9, v9 row_half_mirror row_mask:0xf bank_mask:0xf
    v_add_f32_dpp v10, v10, v10 row_half_mirror row_mask:0xf bank_mask:0xf
    v_add_f32_dpp v11, v11, v11 row_half_mirror row_mask:0xf bank_mask:0xf
    v_rcp_f32 v11, v11
    s_nop 0
    v_mul_f32 v8, v8, v11
    v_cvt_pk_bf16_f32 v36, v8, v8
    v_mul_f32 v9, v9, v11
    v_cvt_pk_bf16_f32 v37, v9, v9
    v_mul_f32 v10, v10, v11
    v_cvt_pk_bf16_f32 v38, v10, v10
    v_and_b32 v32, v4, v36
    v_and_b32 v33, v5, v36
    v_and_b32 v34, v6, v36
    v_and_b32 v35, v7, v36
    v_and_b32 v24, v4, v37
    v_and_b32 v25, v5, v37
    v_and_b32 v26, v6, v37
    v_and_b32 v27, v7, v37
    v_mfma_f32_16x16x32_bf16 v[8:11], v[32:35], v[52:55], 0
    v_mfma_f32_16x16x32_bf16 v[12:15], v[32:35], v[56:59], 0
    v_mfma_f32_16x16x32_bf16 v[16:19], v[32:35], v[60:63], 0
    v_and_b32 v28, v4, v38
    v_and_b32 v29, v5, v38
    v_and_b32 v30, v6, v38
    v_and_b32 v31, v7, v38
    v_mfma_f32_16x16x32_bf16 v[8:11], v[24:27], v[64:67], v[8:11]
    v_mfma_f32_16x16x32_bf16 v[12:15], v[24:27], v[68:71], v[12:15]
    v_mfma_f32_16x16x32_bf16 v[16:19], v[24:27], v[72:75], v[16:19]
    v_mfma_f32_16x16x32_bf16 v[8:11], v[28:31], a[240:243], v[8:11]
    v_mfma_f32_16x16x32_bf16 v[12:15], v[28:31], a[244:247], v[12:15]
    v_mfma_f32_16x16x32_bf16 v[16:19], v[28:31], a[248:251], v[16:19]
    s_nop 7
    v_permlane32_swap_b32 v8, v12
    v_permlane32_swap_b32 v9, v13
    v_permlane32_swap_b32 v10, v14
    v_permlane32_swap_b32 v11, v15
    v_permlane32_swap_b32 v16, v20
    v_permlane32_swap_b32 v17, v21
    v_permlane32_swap_b32 v18, v22
    v_permlane32_swap_b32 v19, v23
    v_add_f32_dpp v8, v12, v8 row_ror:8 row_mask:0xf bank_mask:0xf
    v_add_f32_dpp v9, v13, v9 row_ror:8 row_mask:0xf bank_mask:0xf
    v_add_f32_dpp v10, v14, v10 row_ror:8 row_mask:0xf bank_mask:0xf
    v_add_f32_dpp v11, v15, v11 row_ror:8 row_mask:0xf bank_mask:0xf
    v_add_f32_dpp v16, v20, v16 row_ror:8 row_mask:0xf bank_mask:0xf
    v_add_f32_dpp v17, v21, v17 row_ror:8 row_mask:0xf bank_mask:0xf
    v_add_f32_dpp v18, v22, v18 row_ror:8 row_mask:0xf bank_mask:0xf
    v_add_f32_dpp v19, v23, v19 row_ror:8 row_mask:0xf bank_mask:0xf
    s_mov_b32 exec_lo, 0x00ff00ff
    s_mov_b32 exec_hi, 0x00ff00ff
    buffer_store_dwordx4 v[8:11], v39, s[12:15], s64 offen sc1
    s_mov_b32 exec_hi, 0
    buffer_store_dwordx4 v[16:19], v39, s[12:15], s1 offen sc1
    s_mov_b64 exec, -1
    s_branch L_nle_94
L_nl2_93:
    s_lshr_b32 s64, s2, 6
    s_and_b32 s1, s2, 63
    v_and_or_b32 v39, v0, 4, s46
    v_bfe_u32 v39, s98, v39, 1
    v_and_or_b32 v39, v0, 32, v39
    v_lshlrev_b32 v39, 13, v39
    v_and_b32 v35, 3, v0
    v_lshl_add_u32 v39, v35, 5, v39
    v_and_or_b32 v39, v0, 16, v39
    s_lshl2_add_u32 s64, s46, s64
    s_lshl_b32 s64, s64, 7
    s_add_u32 s64, s64, s1
    s_lshl_b32 s64, s64, 7
    s_add_u32 s64, s64, s56
    s_add_u32 s64, s64, 704512
    s_add_u32 s1, s64, 524288
    v_and_b32 v36, 7, v0
    v_lshlrev_b32 v36, 7, v36
    v_lshrrev_b32 v37, 3, v0
    v_lshl_add_u32 v36, v37, 4, v36
    s_sub_u32 s60, s44, 21
    s_cselect_b32 s60, 0, s60
    s_cselect_b32 s61, 12, 24
    s_cselect_b32 s62, 12, 64
    s_add_u32 s60, s60, s44
    s_lshl_b32 s60, s60, 7
    s_and_b32 s63, s2, 1
    s_mul_i32 s61, s61, s63
    s_and_b32 s63, s2, 2
    s_mul_i32 s62, s62, s63
    s_add_u32 s60, s60, s61
    s_add_u32 s60, s60, s62
    s_lshl_b32 s60, s60, 7
    s_add_u32 s60, s60, s56
    s_bitcmp1_b32 s98, s45
    s_cselect_b32 s61, 8192, 0
    s_add_u32 s60, s60, s61
    s_mov_b64 s[32:33], -1
    s_cmp_lt_u32 s44, 21
    s_cselect_b32 s34, 0x0f0f0f0f, -1
    s_cselect_b32 s40, 0, -1
    s_cmp_eq_u32 s44, 21
    s_cselect_b32 s40, 0x0f0f0f0f, s40
    s_mov_b32 s35, s34
    s_mov_b32 s41, s40
    v_and_b32 v37, 8, v0
    v_cmp_eq_u32 vcc, 0, v37
    v_mov_b32 v37, 0xff800000
    v_mov_b32 v12, 0
    v_mov_b32 v13, 0
    v_mov_b32 v14, 0
    v_mov_b32 v16, 0
    v_mov_b32 v17, 0
    v_mov_b32 v18, 0
    v_cndmask_b32 v15, 0, v37, vcc
    v_cndmask_b32 v19, 0, v37, vcc
    s_mov_b32 s59, 400000
L_poll_97:
    s_mov_b64 exec, s[32:33]
    buffer_load_dwordx4 v[8:11], v36, s[12:15], s60 offen offset:0 sc1
    s_mov_b64 exec, s[34:35]
    buffer_load_dwordx4 v[12:15], v36, s[12:15], s60 offen offset:1024 sc1
    s_mov_b64 exec, s[40:41]
    buffer_load_dwordx4 v[16:19], v36, s[12:15], s60 offen offset:2048 sc1
    s_mov_b64 exec, -1
    s_waitcnt vmcnt(0)
    v_max_u32 v37, v8, v9
    v_max3_u32 v37, v37, v10, v11
    v_cmp_eq_u32 s[32:33], -1, v37
    v_max_u32 v38, v12, v13
    v_max3_u32 v38, v38, v14, v15
    v_cmp_eq_u32 s[34:35], -1, v38
    v_max_u32 v37, v16, v17
    v_max3_u32 v37, v37, v18, v19
    v_cmp_eq_u32 s[40:41], -1, v37
    s_or_b64 vcc, s[32:33], s[34:35]
    s_or_b64 vcc, vcc, s[40:41]
    s_cbranch_scc0 L_got_98
    s_sub_u32 s59, s59, 1
    s_cbranch_scc0 L_poll_97
L_got_98:
    v_mov_b32 v32, v11
    v_mov_b32 v33, v15
    v_mov_b32 v34, v19
    v_mov_b32_dpp v32, v11 row_ror:8 row_mask:0xf bank_mask:0xc
    v_mov_b32_dpp v33, v15 row_ror:8 row_mask:0xf bank_mask:0xc
    v_mov_b32_dpp v34, v19 row_ror:8 row_mask:0xf bank_mask:0xc
    v_mov_b32_dpp v11, v11 row_ror:8 row_mask:0xf bank_mask:0x3
    v_mov_b32_dpp v15, v15 row_ror:8 row_mask:0xf bank_mask:0x3
    v_mov_b32_dpp v19, v19 row_ror:8 row_mask:0xf bank_mask:0x3
    v_max3_f32 v35, v32, v33, v34
    s_nop 1
    v_max_f32_dpp v35, v35, v35 quad_perm:[1,0,3,2] row_mask:0xf bank_mask:0xf
    s_nop 1
    v_max_f32_dpp v35, v35, v35 quad_perm:[2,3,0,1] row_mask:0xf bank_mask:0xf
    s_nop 1
    v_max_f32_dpp v35, v35, v35 row_half_mirror row_mask:0xf bank_mask:0xf
    v_sub_f32 v32, v32, v35
    v_sub_f32 v33, v33, v35
    v_sub_f32 v34, v34, v35
    v_exp_f32 v32, v32
    v_exp_f32 v33, v33
    v_exp_f32 v34, v34
    v_mul_f32 v8, v8, v32
    v_mul_f32 v9, v9, v32
    v_mul_f32 v10, v10, v32
    v_mul_f32 v11, v11, v32
    v_fmac_f32 v8, v12, v33
    v_fmac_f32 v9, v13, v33
    v_fmac_f32 v10, v14, v33
    v_fmac_f32 v11, v15, v33
    v_fmac_f32 v8, v16, v34
    v_fmac_f32 v9, v17, v34
    v_fmac_f32 v10, v18, v34
    v_fmac_f32 v11, v19, v34
    v_add_f32_dpp v8, v8, v8 quad_perm:[1,0,3,2] row_mask:0xf bank_mask:0xf
    v_add_f32_dpp v9, v9, v9 quad_perm:[1,0,3,2] row_mask:0xf bank_mask:0xf
    v_add_f32_dpp v10, v10, v10 quad_perm:[1,0,3,2] row_mask:0xf bank_mask:0xf
    v_add_f32_dpp v11, v11, v11 quad_perm:[1,0,3,2] row_mask:0xf bank_mask:0xf
    v_add_f32_dpp v8, v8, v8 quad_perm:[2,3,0,1] row_mask:0xf bank_mask:0xf
    v_add_f32_dpp v9, v9, v9 quad_perm:[2,3,0,1] row_mask:0xf bank_mask:0xf
    v_add_f32_dpp v10, v10, v10 quad_perm:[2,3,0,1] row_mask:0xf bank_mask:0xf
    v_add_f32_dpp v11, v11, v11 quad_perm:[2,3,0,1] row_mask:0xf bank_mask:0xf
    v_add_f32_dpp v8, v8, v8 row_half_mirror row_mask:0xf bank_mask:0xf
    v_add_f32_dpp v9, v9, v9 row_half_mirror row_mask:0xf bank_mask:0xf
    v_add_f32_dpp v10, v10, v10 row_half_mirror row_mask:0xf bank_mask:0xf
    v_add_f32_dpp v11, v11, v11 row_half_mirror row_mask:0xf bank_mask:0xf
    v_rcp_f32 v11, v11
    s_nop 0
    v_mul_f32 v8, v8, v11
    v_cvt_pk_bf16_f32 v36, v8, v8
    v_mul_f32 v9, v9, v11
    v_cvt_pk_bf16_f32 v37, v9, v9
    v_mul_f32 v10, v10, v11
    v_cvt_pk_bf16_f32 v38, v10, v10
    v_and_b32 v32, v4, v36
    v_and_b32 v33, v5, v36
    v_and_b32 v34, v6, v36
    v_and_b32 v35, v7, v36
    v_and_b32 v24, v4, v37
    v_and_b32 v25, v5, v37
    v_and_b32 v26, v6, v37
    v_and_b32 v27, v7, v37
    v_mfma_f32_16x16x32_bf16 v[8:11], v[32:35], v[52:55], 0
    v_mfma_f32_16x16x32_bf16 v[12:15], v[32:35], v[56:59], 0
    v_and_b32 v28, v4, v38
    v_and_b32 v29, v5, v38
    v_and_b32 v30, v6, v38
    v_and_b32 v31, v7, v38
    v_mfma_f32_16x16x32_bf16 v[8:11], v[24:27], v[64:67], v[8:11]
    v_mfma_f32_16x16x32_bf16 v[12:15], v[24:27], v[68:71], v[12:15]
    v_mfma_f32_16x16x32_bf16 v[8:11], v[28:31], a[240:243], v[8:11]
    v_mfma_f32_16x16x32_bf16 v[12:15], v[28:31], a[244:247], v[12:15]
    s_nop 7
    v_permlane32_swap_b32 v8, v12
    v_permlane32_swap_b32 v9, v13
    v_permlane32_swap_b32 v10, v14
    v_permlane32_swap_b32 v11, v15
    s_nop 0
    v_add_f32_dpp v8, v12, v8 row_ror:8 row_mask:0xf bank_mask:0xf
    v_add_f32_dpp v9, v13, v9 row_ror:8 row_mask:0xf bank_mask:0xf
    v_add_f32_dpp v10, v14, v10 row_ror:8 row_mask:0xf bank_mask:0xf
    v_add_f32_dpp v11, v15, v11 row_ror:8 row_mask:0xf bank_mask:0xf
    s_mov_b32 exec_lo, 0x00ff00ff
    s_mov_b32 exec_hi, 0x00ff00ff
    buffer_store_dwordx4 v[8:11], v39, s[12:15], s64 offen sc1
    s_mov_b64 exec, -1
L_nle_94:
    s_sub_u32 s63, s44, 24
    s_and_b32 s60, s2, 3
    s_lshl2_add_u32 s63, s63, s60
    s_lshr_b32 s60, s45, 2
    s_lshl1_add_u32 s63, s63, s60
    s_barrier
    s_cmp_lt_u32 s63, 20
    s_cbranch_scc1 L_red
    s_cmp_lt_u32 s2, 192
    s_cbranch_scc1 L_ffn
    s_cmp_lg_u32 s56, 0
    s_cbranch_scc1 L_fin
    v_lshrrev_b32 v30, 3, v0
    v_mul_u32_u24 v30, 196608, v30
    v_and_b32 v31, 7, v0
    v_lshl_add_u32 v31, v31, 4, v30
    v_add_u32 v30, v30, v31
    s_lshl_b32 s61, s45, 2
    s_add_u32 s61, s61, s46
    s_mul_i32 s61, s61, 12288
    s_mul_i32 s62, s44, 384
    s_add_u32 s61, s61, s62
    s_add_u32 s62, s61, 3145728
    buffer_load_dwordx4 v[52:55], v30, s[16:19], s61 offen offset:0 nt
    buffer_load_dwordx4 v[56:59], v30, s[16:19], s61 offen offset:128 nt
    buffer_load_dwordx4 v[60:63], v30, s[16:19], s61 offen offset:256 nt
    buffer_load_dwordx4 v[64:67], v30, s[16:19], s62 offen offset:0 nt
    buffer_load_dwordx4 v[68:71], v30, s[16:19], s62 offen offset:128 nt
    buffer_load_dwordx4 v[72:75], v30, s[16:19], s62 offen offset:256 nt
    s_cmp_ge_u32 s46, 2
    s_cbranch_scc1 L_wq2_99
    s_mul_i32 s62, s45, 24576
    s_sub_u32 s61, s61, s62
    s_add_u32 s61, s61, 6291456
    buffer_load_dwordx4 a[240:243], v31, s[16:19], s61 offen offset:0 nt
    buffer_load_dwordx4 a[244:247], v31, s[16:19], s61 offen offset:128 nt
    buffer_load_dwordx4 a[248:251], v31, s[16:19], s61 offen offset:256 nt
L_wq2_99:
    s_sub_u32 s60, s63, 20
    s_lshl2_add_u32 s60, s60, s46
    s_mul_i32 s60, s60, 21504
    s_add_u32 s60, s60, 8388608
    v_mov_b32 v76, -1
    v_mov_b32 v77, -1
    v_mov_b32 v78, -1
    v_mov_b32 v79, -1
    buffer_store_dwordx4 v[76:79], v3, s[12:15], s60 offen offset:0 sc1 nt
    buffer_store_dwordx4 v[76:79], v3, s[12:15], s60 offen offset:1024 sc1 nt
    buffer_store_dwordx4 v[76:79], v3, s[12:15], s60 offen offset:2048 sc1 nt
    buffer_store_dwordx4 v[76:79], v3, s[12:15], s60 offen offset:3072 sc1 nt
    s_add_u32 s60, s60, 4096
    buffer_store_dwordx4 v[76:79], v3, s[12:15], s60 offen offset:0 sc1 nt
    buffer_store_dwordx4 v[76:79], v3, s[12:15], s60 offen offset:1024 sc1 nt
    buffer_store_dwordx4 v[76:79], v3, s[12:15], s60 offen offset:2048 sc1 nt
    buffer_store_dwordx4 v[76:79], v3, s[12:15], s60 offen offset:3072 sc1 nt
    s_add_u32 s60, s60, 4096
    buffer_store_dwordx4 v[76:79], v3, s[12:15], s60 offen offset:0 sc1 nt
    buffer_store_dwordx4 v[76:79], v3, s[12:15], s60 offen offset:1024 sc1 nt
    buffer_store_dwordx4 v[76:79], v3, s[12:15], s60 offen offset:2048 sc1 nt
    buffer_store_dwordx4 v[76:79], v3, s[12:15], s60 offen offset:3072 sc1 nt
    s_add_u32 s60, s60, 4096
    buffer_store_dwordx4 v[76:79], v3, s[12:15], s60 offen offset:0 sc1 nt
    buffer_store_dwordx4 v[76:79], v3, s[12:15], s60 offen offset:1024 sc1 nt
    buffer_store_dwordx4 v[76:79], v3, s[12:15], s60 offen offset:2048 sc1 nt
    buffer_store_dwordx4 v[76:79], v3, s[12:15], s60 offen offset:3072 sc1 nt
    s_add_u32 s60, s60, 4096
    buffer_store_dwordx4 v[76:79], v3, s[12:15], s60 offen offset:0 sc1 nt
    buffer_store_dwordx4 v[76:79], v3, s[12:15], s60 offen offset:1024 sc1 nt
    buffer_store_dwordx4 v[76:79], v3, s[12:15], s60 offen offset:2048 sc1 nt
    buffer_store_dwordx4 v[76:79], v3, s[12:15], s60 offen offset:3072 sc1 nt
    s_add_u32 s60, s60, 4096
    buffer_store_dwordx4 v[76:79], v3, s[12:15], s60 offen offset:0 sc1 nt
    s_branch L_getx2
    .p2align 12
L_ffn:
    s_mul_i32 s63, s45, 24
    s_add_u32 s63, s63, s44
    s_cmp_lg_u32 s56, 0
    s_cbranch_scc1 L_nowq
    v_lshrrev_b32 v36, 3, v0
    v_mul_u32_u24 v36, 196608, v36
    v_and_b32 v37, 7, v0
    v_lshl_add_u32 v37, v37, 4, v36
    v_add_u32 v36, v36, v37
    s_lshl_b32 s61, s45, 2
    s_add_u32 s61, s61, s46
    s_mul_i32 s61, s61, 12288
    s_mul_i32 s62, s44, 384
    s_add_u32 s61, s61, s62
    s_add_u32 s62, s61, 3145728
    buffer_load_dwordx4 v[52:55], v36, s[16:19], s61 offen offset:0 nt
    buffer_load_dwordx4 v[56:59], v36, s[16:19], s61 offen offset:128 nt
    buffer_load_dwordx4 v[60:63], v36, s[16:19], s61 offen offset:256 nt
    buffer_load_dwordx4 v[64:67], v36, s[16:19], s62 offen offset:0 nt
    buffer_load_dwordx4 v[68:71], v36, s[16:19], s62 offen offset:128 nt
    buffer_load_dwordx4 v[72:75], v36, s[16:19], s62 offen offset:256 nt
L_nowq:
    v_mul_u32_u24 v32, 12288, v0
    v_mul_u32_u24 v33, 6144, v0
    s_mul_i32 s61, s46, 3072
    s_lshl4_add_u32 s61, s63, s61
    s_add_u32 s62, s61, 786432
    buffer_load_dwordx4 v[20:23], v32, s[24:27], s61 offen
    buffer_load_dwordx4 v[24:27], v32, s[24:27], s62 offen
    s_add_u32 s62, s61, 1572864
    v_lshrrev_b32 v34, 3, v0
    v_mul_u32_u24 v34, 1280, v34
    v_and_b32 v35, 7, v0
    v_lshl_add_u32 v34, v35, 4, v34
    s_mul_i32 s61, s63, 10240
    s_lshl_b32 s60, s46, 7
    s_add_u32 s61, s61, s60
    buffer_load_dwordx4 a[240:243], v34, s[28:31], s61 offen
    buffer_load_dwordx4 a[244:247], v34, s[28:31], s61 offen offset:512
    s_cmp_ge_u32 s46, 2
    s_cbranch_scc1 L_w12
    buffer_load_dwordx4 v[28:31], v33, s[24:27], s62 offen
    buffer_load_dwordx4 a[248:251], v34, s[28:31], s61 offen offset:1024
L_w12:
    s_cmp_ge_u32 s46, 2
    s_cbranch_scc1 L_nl2_100
    s_lshr_b32 s64, s45, 1
    s_mul_i32 s1, s64, 48
    s_sub_u32 s1, s63, s1
    v_and_or_b32 v39, v0, 4, s46
    v_bfe_u32 v39, s98, v39, 1
    v_and_or_b32 v39, v0, 32, v39
    v_lshlrev_b32 v39, 13, v39
    v_and_b32 v35, 3, v0
    v_lshl_add_u32 v39, v35, 5, v39
    v_and_or_b32 v39, v0, 16, v39
    s_lshl2_add_u32 s64, s46, s64
    s_lshl_b32 s64, s64, 7
    s_add_u32 s64, s64, s1
    s_lshl_b32 s64, s64, 7
    s_add_u32 s64, s64, s56
    s_add_u32 s64, s64, 1359872
    s_add_u32 s1, s64, 524288
    v_mov_b32 v32, v3
    v_lshlrev_b32 v33, 3, v0
    s_and_b32 s61, s2, 1
    s_mul_i32 s61, s61, 2560
    s_bfe_u32 s60, s2, 0x10001
    s_lshl_b32 s60, s60, 14
    s_add_u32 s61, s61, s60
    s_add_u32 s61, s61, s56
    s_add_u32 s61, s61, 2015232
    s_bitcmp1_b32 s98, s45
    s_cselect_b32 s59, 8192, 0
    s_add_u32 s61, s61, s59
    s_mov_b64 s[32:33], -1
    s_mov_b64 s[34:35], -1
    s_mov_b64 s[40:41], -1
    s_bitcmp1_b32 s46, 0
    s_cselect_b64 s[42:43], -1, 0
    s_bitcmp1_b32 s46, 1
    s_cselect_b64 s[54:55], -1, 0
    s_mov_b32 s59, 400000
L_poll_104:
    s_mov_b64 exec, s[32:33]
    buffer_load_dwordx4 v[8:11], v32, s[12:15], s61 offen sc1
    s_mov_b64 exec, s[34:35]
    buffer_load_dwordx4 v[12:15], v32, s[12:15], s61 offen offset:1024 sc1
    s_mov_b64 exec, s[40:41]
    buffer_load_dwordx2 v[16:17], v33, s[12:15], s61 offen offset:2048 sc1
    s_mov_b64 exec, -1
    s_waitcnt vmcnt(0)
    v_max_u32 v36, v8, v9
    v_max3_u32 v36, v36, v10, v11
    v_cmp_eq_u32 s[32:33], -1, v36
    v_max_u32 v37, v12, v13
    v_max3_u32 v37, v37, v14, v15
    v_cmp_eq_u32 s[34:35], -1, v37
    v_max_u32 v36, v16, v17
    v_cmp_eq_u32 s[40:41], -1, v36
    s_or_b64 vcc, s[32:33], s[34:35]
    s_or_b64 vcc, vcc, s[40:41]
    s_cbranch_scc0 L_got_105
    s_sub_u32 s59, s59, 1
    s_cbranch_scc0 L_poll_104
L_got_105:
    v_cndmask_b32 v36, v8, v9, s[42:43]
    v_cndmask_b32 v34, v10, v11, s[42:43]
    v_cndmask_b32 v37, v12, v13, s[42:43]
    v_cndmask_b32 v35, v14, v15, s[42:43]
    v_cndmask_b32 v38, v16, v17, s[42:43]
    v_cndmask_b32 v36, v36, v34, s[54:55]
    v_cndmask_b32 v37, v37, v35, s[54:55]
    v_readfirstlane_b32 s60, v8
    s_nop 1
    v_pk_add_f32 v[8:9], v[8:9], s[60:61] op_sel_hi:[1,0] neg_lo:[0,1] neg_hi:[0,1]
    v_pk_add_f32 v[10:11], v[10:11], s[60:61] op_sel_hi:[1,0] neg_lo:[0,1] neg_hi:[0,1]
    v_pk_add_f32 v[12:13], v[12:13], s[60:61] op_sel_hi:[1,0] neg_lo:[0,1] neg_hi:[0,1]
    v_pk_add_f32 v[14:15], v[14:15], s[60:61] op_sel_hi:[1,0] neg_lo:[0,1] neg_hi:[0,1]
    v_pk_add_f32 v[16:17], v[16:17], s[60:61] op_sel_hi:[1,0] neg_lo:[0,1] neg_hi:[0,1]
    v_pk_mul_f32 v[18:19], v[8:9], v[8:9]
    v_pk_fma_f32 v[18:19], v[10:11], v[10:11], v[18:19]
    v_pk_add_f32 v[8:9], v[8:9], v[10:11]
    v_pk_fma_f32 v[18:19], v[12:13], v[12:13], v[18:19]
    v_pk_add_f32 v[8:9], v[8:9], v[12:13]
    v_pk_fma_f32 v[18:19], v[14:15], v[14:15], v[18:19]
    v_pk_add_f32 v[8:9], v[8:9], v[14:15]
    v_pk_fma_f32 v[18:19], v[16:17], v[16:17], v[18:19]
    v_pk_add_f32 v[8:9], v[8:9], v[16:17]
    v_add_f32 v19, v18, v19
    v_add_f32 v18, v8, v9
    s_nop 0
    s_nop 0
    v_add_f32_dpp v18, v18, v18 quad_perm:[1,0,3,2] row_mask:0xf bank_mask:0xf
    v_add_f32_dpp v19, v19, v19 quad_perm:[1,0,3,2] row_mask:0xf bank_mask:0xf
    s_nop 0
    v_add_f32_dpp v18, v18, v18 quad_perm:[2,3,0,1] row_mask:0xf bank_mask:0xf
    v_add_f32_dpp v19, v19, v19 quad_perm:[2,3,0,1] row_mask:0xf bank_mask:0xf
    s_nop 0
    v_add_f32_dpp v18, v18, v18 row_half_mirror row_mask:0xf bank_mask:0xf
    v_add_f32_dpp v19, v19, v19 row_half_mirror row_mask:0xf bank_mask:0xf
    s_nop 0
    v_add_f32_dpp v18, v18, v18 row_mirror row_mask:0xf bank_mask:0xf
    v_add_f32_dpp v19, v19, v19 row_mirror row_mask:0xf bank_mask:0xf
    s_nop 0
    v_add_f32_dpp v18, v18, v18 row_bcast:15 row_mask:0xa bank_mask:0xf
    v_add_f32_dpp v19, v19, v19 row_bcast:15 row_mask:0xa bank_mask:0xf
    s_nop 0
    v_add_f32_dpp v18, v18, v18 row_bcast:31 row_mask:0xc bank_mask:0xf
    v_add_f32_dpp v19, v19, v19 row_bcast:31 row_mask:0xc bank_mask:0xf
    s_nop 0
    v_readlane_b32 s61, v18, 63
    v_readlane_b32 s62, v19, 63
    v_mov_b32 v32, 0x3acccccd
    s_nop 0
    v_mul_f32 v18, s61, v32
    v_mul_f32 v19, s62, v32
    v_fma_f32 v19, -v18, v18, v19
    v_max_f32 v19, 0, v19
    v_add_f32 v18, s60, v18
    v_cvt_pk_bf16_f32 v18, 0, v18
    v_cvt_pk_bf16_f32 v19, 0, v19
    v_add_f32 v19, 0x3727c5ac, v19
    v_cvt_pk_bf16_f32 v19, 0, v19
    v_sqrt_f32 v19, v19
    s_nop 0
    v_cvt_pk_bf16_f32 v19, 0, v19
    v_rcp_f32 v19, v19
    v_sub_f32 v36, v36, v18
    v_cvt_pk_bf16_f32 v36, 0, v36
    v_sub_f32 v37, v37, v18
    v_cvt_pk_bf16_f32 v37, 0, v37
    v_sub_f32 v38, v38, v18
    v_cvt_pk_bf16_f32 v38, 0, v38
    v_mul_f32 v36, v36, v19
    v_cvt_pk_bf16_f32 v36, v36, v36
    v_mul_f32 v37, v37, v19
    v_cvt_pk_bf16_f32 v37, v37, v37
    v_mul_f32 v38, v38, v19
    v_cvt_pk_bf16_f32 v38, v38, v38
    v_and_b32 v32, 0xffff, v36
    v_and_b32 v33, 0xffff0000, v36
    v_dot2_f32_bf16 v8, v20, v32, 0
    v_dot2_f32_bf16 v9, v20, v33, 0
    v_dot2_f32_bf16 v10, v21, v32, 0
    v_dot2_f32_bf16 v11, v21, v33, 0
    v_dot2_f32_bf16 v12, v22, v32, 0
    v_dot2_f32_bf16 v13, v22, v33, 0
    v_dot2_f32_bf16 v14, v23, v32, 0
    v_dot2_f32_bf16 v15, v23, v33, 0
    s_nop 2
    v_and_b32 v32, 0xffff, v37
    v_and_b32 v33, 0xffff0000, v37
    v_dot2_f32_bf16 v8, v24, v32, v8
    v_dot2_f32_bf16 v9, v24, v33, v9
    v_dot2_f32_bf16 v10, v25, v32, v10
    v_dot2_f32_bf16 v11, v25, v33, v11
    v_dot2_f32_bf16 v12, v26, v32, v12
    v_dot2_f32_bf16 v13, v26, v33, v13
    v_dot2_f32_bf16 v14, v27, v32, v14
    v_dot2_f32_bf16 v15, v27, v33, v15
    s_nop 2
    v_and_b32 v32, 0xffff, v38
    v_and_b32 v33, 0xffff0000, v38
    v_dot2_f32_bf16 v8, v28, v32, v8
    v_dot2_f32_bf16 v9, v28, v33, v9
    v_dot2_f32_bf16 v10, v29, v32, v10
    v_dot2_f32_bf16 v11, v29, v33, v11
    v_dot2_f32_bf16 v12, v30, v32, v12
    v_dot2_f32_bf16 v13, v30, v33, v13
    v_dot2_f32_bf16 v14, v31, v32, v14
    v_dot2_f32_bf16 v15, v31, v33, v15
    s_nop 2
    v_permlane32_swap_b32 v8, v12
    v_permlane32_swap_b32 v9, v13
    v_permlane32_swap_b32 v10, v14
    v_permlane32_swap_b32 v11, v15
    v_add_f32 v8, v8, v12
    v_add_f32 v9, v9, v13
    v_add_f32 v10, v10, v14
    v_add_f32 v11, v11, v15
    v_lshrrev_b32 v32, 3, v0
    v_lshlrev_b32 v32, 4, v32
    v_permlane16_swap_b32 v8, v10
    v_permlane16_swap_b32 v9, v11
    v_add_u32 v32, 153600, v32
    v_add_f32 v8, v8, v10
    v_add_f32 v9, v9, v11
    s_lshl_b32 s60, s46, 2
    v_add_u32 v33, s60, v32
    v_add_f32_dpp v10, v8, v8 row_ror:8 row_mask:0xf bank_mask:0x3
    s_nop 1
    v_add_f32_dpp v10, v9, v9 row_ror:8 row_mask:0xf bank_mask:0xc
    s_nop 1
    v_add_f32_dpp v10, v10, v10 quad_perm:[1,0,3,2] row_mask:0xf bank_mask:0xf
    s_nop 1
    v_add_f32_dpp v10, v10, v10 quad_perm:[2,3,0,1] row_mask:0xf bank_mask:0xf
    s_nop 1
    v_add_f32_dpp v10, v10, v10 row_half_mirror row_mask:0xf bank_mask:0xf
    ds_write_b32 v33, v10
    s_waitcnt lgkmcnt(0)
    s_barrier
    ds_read_b128 v[8:11], v32
    s_waitcnt lgkmcnt(0)
    v_add_f32 v8, v8, v9
    v_add_f32 v10, v10, v11
    v_add_f32 v8, v8, v10
    v_cvt_pk_bf16_f32 v8, 0, v8
    v_mul_f32 v9, 0xbfb8aa3b, v8
    v_exp_f32 v9, v9
    s_nop 0
    v_add_f32 v9, 1.0, v9
    v_rcp_f32 v9, v9
    s_nop 0
    v_mul_f32 v8, v8, v9
    v_cvt_pk_bf16_f32 v36, v8, v8
    v_and_b32 v32, v4, v36
    v_and_b32 v33, v5, v36
    v_and_b32 v34, v6, v36
    v_and_b32 v35, v7, v36
    s_nop 1
    v_mfma_f32_16x16x32_bf16 v[8:11], v[32:35], a[240:243], 0
    v_mfma_f32_16x16x32_bf16 v[12:15], v[32:35], a[244:247], 0
    v_mfma_f32_16x16x32_bf16 v[16:19], v[32:35], a[248:251], 0
    s_nop 7
    v_permlane32_swap_b32 v8, v12
    v_permlane32_swap_b32 v9, v13
    v_permlane32_swap_b32 v10, v14
    v_permlane32_swap_b32 v11, v15
    v_permlane32_swap_b32 v16, v20
    v_permlane32_swap_b32 v17, v21
    v_permlane32_swap_b32 v18, v22
    v_permlane32_swap_b32 v19, v23
    v_add_f32_dpp v8, v12, v8 row_ror:8 row_mask:0xf bank_mask:0xf
    v_add_f32_dpp v9, v13, v9 row_ror:8 row_mask:0xf bank_mask:0xf
    v_add_f32_dpp v10, v14, v10 row_ror:8 row_mask:0xf bank_mask:0xf
    v_add_f32_dpp v11, v15, v11 row_ror:8 row_mask:0xf bank_mask:0xf
    v_add_f32_dpp v16, v20, v16 row_ror:8 row_mask:0xf bank_mask:0xf
    v_add_f32_dpp v17, v21, v17 row_ror:8 row_mask:0xf bank_mask:0xf
    v_add_f32_dpp v18, v22, v18 row_ror:8 row_mask:0xf bank_mask:0xf
    v_add_f32_dpp v19, v23, v19 row_ror:8 row_mask:0xf bank_mask:0xf
    s_mov_b32 exec_lo, 0x00ff00ff
    s_mov_b32 exec_hi, 0x00ff00ff
    buffer_store_dwordx4 v[8:11], v39, s[12:15], s64 offen sc1
    s_mov_b32 exec_hi, 0
    buffer_store_dwordx4 v[16:19], v39, s[12:15], s1 offen sc1
    s_mov_b64 exec, -1
    s_branch L_nle_101
L_nl2_100:
    s_lshr_b32 s64, s45, 1
    s_mul_i32 s1, s64, 48
    s_sub_u32 s1, s63, s1
    v_and_or_b32 v39, v0, 4, s46
    v_bfe_u32 v39, s98, v39, 1
    v_and_or_b32 v39, v0, 32, v39
    v_lshlrev_b32 v39, 13, v39
    v_and_b32 v35, 3, v0
    v_lshl_add_u32 v39, v35, 5, v39
    v_and_or_b32 v39, v0, 16, v39
    s_lshl2_add_u32 s64, s46, s64
    s_lshl_b32 s64, s64, 7
    s_add_u32 s64, s64, s1
    s_lshl_b32 s64, s64, 7
    s_add_u32 s64, s64, s56
    s_add_u32 s64, s64, 1359872
    s_add_u32 s1, s64, 524288
    v_mov_b32 v32, v3
    v_lshlrev_b32 v33, 3, v0
    s_and_b32 s61, s2, 1
    s_mul_i32 s61, s61, 2560
    s_bfe_u32 s60, s2, 0x10001
    s_lshl_b32 s60, s60, 14
    s_add_u32 s61, s61, s60
    s_add_u32 s61, s61, s56
    s_add_u32 s61, s61, 2015232
    s_bitcmp1_b32 s98, s45
    s_cselect_b32 s59, 8192, 0
    s_add_u32 s61, s61, s59
    s_mov_b64 s[32:33], -1
    s_mov_b64 s[34:35], -1
    s_mov_b64 s[40:41], -1
    s_bitcmp1_b32 s46, 0
    s_cselect_b64 s[42:43], -1, 0
    s_bitcmp1_b32 s46, 1
    s_cselect_b64 s[54:55], -1, 0
    s_mov_b32 s59, 400000
L_poll_108:
    s_mov_b64 exec, s[32:33]
    buffer_load_dwordx4 v[8:11], v32, s[12:15], s61 offen sc1
    s_mov_b64 exec, s[34:35]
    buffer_load_dwordx4 v[12:15], v32, s[12:15], s61 offen offset:1024 sc1
    s_mov_b64 exec, s[40:41]
    buffer_load_dwordx2 v[16:17], v33, s[12:15], s61 offen offset:2048 sc1
    s_mov_b64 exec, -1
    s_waitcnt vmcnt(0)
    v_max_u32 v36, v8, v9
    v_max3_u32 v36, v36, v10, v11
    v_cmp_eq_u32 s[32:33], -1, v36
    v_max_u32 v37, v12, v13
    v_max3_u32 v37, v37, v14, v15
    v_cmp_eq_u32 s[34:35], -1, v37
    v_max_u32 v36, v16, v17
    v_cmp_eq_u32 s[40:41], -1, v36
    s_or_b64 vcc, s[32:33], s[34:35]
    s_or_b64 vcc, vcc, s[40:41]
    s_cbranch_scc0 L_got_109
    s_sub_u32 s59, s59, 1
    s_cbranch_scc0 L_poll_108
L_got_109:
    v_cndmask_b32 v36, v8, v9, s[42:43]
    v_cndmask_b32 v34, v10, v11, s[42:43]
    v_cndmask_b32 v37, v12, v13, s[42:43]
    v_cndmask_b32 v35, v14, v15, s[42:43]
    v_cndmask_b32 v38, v16, v17, s[42:43]
    v_cndmask_b32 v36, v36, v34, s[54:55]
    v_cndmask_b32 v37, v37, v35, s[54:55]
    v_readfirstlane_b32 s60, v8
    s_nop 1
    v_pk_add_f32 v[8:9], v[8:9], s[60:61] op_sel_hi:[1,0] neg_lo:[0,1] neg_hi:[0,1]
    v_pk_add_f32 v[10:11], v[10:11], s[60:61] op_sel_hi:[1,0] neg_lo:[0,1] neg_hi:[0,1]
    v_pk_add_f32 v[12:13], v[12:13], s[60:61] op_sel_hi:[1,0] neg_lo:[0,1] neg_hi:[0,1]
    v_pk_add_f32 v[14:15], v[14:15], s[60:61] op_sel_hi:[1,0] neg_lo:[0,1] neg_hi:[0,1]
    v_pk_add_f32 v[16:17], v[16:17], s[60:61] op_sel_hi:[1,0] neg_lo:[0,1] neg_hi:[0,1]
    v_pk_mul_f32 v[18:19], v[8:9], v[8:9]
    v_pk_fma_f32 v[18:19], v[10:11], v[10:11], v[18:19]
    v_pk_add_f32 v[8:9], v[8:9], v[10:11]
    v_pk_fma_f32 v[18:19], v[12:13], v[12:13], v[18:19]
    v_pk_add_f32 v[8:9], v[8:9], v[12:13]
    v_pk_fma_f32 v[18:19], v[14:15], v[14:15], v[18:19]
    v_pk_add_f32 v[8:9], v[8:9], v[14:15]
    v_pk_fma_f32 v[18:19], v[16:17], v[16:17], v[18:19]
    v_pk_add_f32 v[8:9], v[8:9], v[16:17]
    v_add_f32 v19, v18, v19
    v_add_f32 v18, v8, v9
    s_nop 0
    s_nop 0
    v_add_f32_dpp v18, v18, v18 quad_perm:[1,0,3,2] row_mask:0xf bank_mask:0xf
    v_add_f32_dpp v19, v19, v19 quad_perm:[1,0,3,2] row_mask:0xf bank_mask:0xf
    s_nop 0
    v_add_f32_dpp v18, v18, v18 quad_perm:[2,3,0,1] row_mask:0xf bank_mask:0xf
    v_add_f32_dpp v19, v19, v19 quad_perm:[2,3,0,1] row_mask:0xf bank_mask:0xf
    s_nop 0
    v_add_f32_dpp v18, v18, v18 row_half_mirror row_mask:0xf bank_mask:0xf
    v_add_f32_dpp v19, v19, v19 row_half_mirror row_mask:0xf bank_mask:0xf
    s_nop 0
    v_add_f32_dpp v18, v18, v18 row_mirror row_mask:0xf bank_mask:0xf
    v_add_f32_dpp v19, v19, v19 row_mirror row_mask:0xf bank_mask:0xf
    s_nop 0
    v_add_f32_dpp v18, v18, v18 row_bcast:15 row_mask:0xa bank_mask:0xf
    v_add_f32_dpp v19, v19, v19 row_bcast:15 row_mask:0xa bank_mask:0xf
    s_nop 0
    v_add_f32_dpp v18, v18, v18 row_bcast:31 row_mask:0xc bank_mask:0xf
    v_add_f32_dpp v19, v19, v19 row_bcast:31 row_mask:0xc bank_mask:0xf
    s_nop 0
    v_readlane_b32 s61, v18, 63
    v_readlane_b32 s62, v19, 63
    v_mov_b32 v32, 0x3acccccd
    s_nop 0
    v_mul_f32 v18, s61, v32
    v_mul_f32 v19, s62, v32
    v_fma_f32 v19, -v18, v18, v19
    v_max_f32 v19, 0, v19
    v_add_f32 v18, s60, v18
    v_cvt_pk_bf16_f32 v18, 0, v18
    v_cvt_pk_bf16_f32 v19, 0, v19
    v_add_f32 v19, 0x3727c5ac, v19
    v_cvt_pk_bf16_f32 v19, 0, v19
    v_sqrt_f32 v19, v19
    s_nop 0
    v_cvt_pk_bf16_f32 v19, 0, v19
    v_rcp_f32 v19, v19
    v_sub_f32 v36, v36, v18
    v_cvt_pk_bf16_f32 v36, 0, v36
    v_sub_f32 v37, v37, v18
    v_cvt_pk_bf16_f32 v37, 0, v37
    v_sub_f32 v38, v38, v18
    v_cvt_pk_bf16_f32 v38, 0, v38
    v_mul_f32 v36, v36, v19
    v_cvt_pk_bf16_f32 v36, v36, v36
    v_mul_f32 v37, v37, v19
    v_cvt_pk_bf16_f32 v37, v37, v37
    v_mul_f32 v38, v38, v19
    v_cvt_pk_bf16_f32 v38, v38, v38
    v_and_b32 v32, 0xffff, v36
    v_and_b32 v33, 0xffff0000, v36
    v_dot2_f32_bf16 v8, v20, v32, 0
    v_dot2_f32_bf16 v9, v20, v33, 0
    v_dot2_f32_bf16 v10, v21, v32, 0
    v_dot2_f32_bf16 v11, v21, v33, 0
    v_dot2_f32_bf16 v12, v22, v32, 0
    v_dot2_f32_bf16 v13, v22, v33, 0
    v_dot2_f32_bf16 v14, v23, v32, 0
    v_dot2_f32_bf16 v15, v23, v33, 0
    s_nop 2
    v_and_b32 v32, 0xffff, v37
    v_and_b32 v33, 0xffff0000, v37
    v_dot2_f32_bf16 v8, v24, v32, v8
    v_dot2_f32_bf16 v9, v24, v33, v9
    v_dot2_f32_bf16 v10, v25, v32, v10
    v_dot2_f32_bf16 v11, v25, v33, v11
    v_dot2_f32_bf16 v12, v26, v32, v12
    v_dot2_f32_bf16 v13, v26, v33, v13
    v_dot2_f32_bf16 v14, v27, v32, v14
    v_dot2_f32_bf16 v15, v27, v33, v15
    s_nop 2
    v_permlane32_swap_b32 v8, v12
    v_permlane32_swap_b32 v9, v13
    v_permlane32_swap_b32 v10, v14
    v_permlane32_swap_b32 v11, v15
    v_add_f32 v8, v8, v12
    v_add_f32 v9, v9, v13
    v_add_f32 v10, v10, v14
    v_add_f32 v11, v11, v15
    v_lshrrev_b32 v32, 3, v0
    v_lshlrev_b32 v32, 4, v32
    v_permlane16_swap_b32 v8, v10
    v_permlane16_swap_b32 v9, v11
    v_add_u32 v32, 153600, v32
    v_add_f32 v8, v8, v10
    v_add_f32 v9, v9, v11
    s_lshl_b32 s60, s46, 2
    v_add_u32 v33, s60, v32
    v_add_f32_dpp v10, v8, v8 row_ror:8 row_mask:0xf bank_mask:0x3
    s_nop 1
    v_add_f32_dpp v10, v9, v9 row_ror:8 row_mask:0xf bank_mask:0xc
    s_nop 1
    v_add_f32_dpp v10, v10, v10 quad_perm:[1,0,3,2] row_mask:0xf bank_mask:0xf
    s_nop 1
    v_add_f32_dpp v10, v10, v10 quad_perm:[2,3,0,1] row_mask:0xf bank_mask:0xf
    s_nop 1
    v_add_f32_dpp v10, v10, v10 row_half_mirror row_mask:0xf bank_mask:0xf
    ds_write_b32 v33, v10
    s_waitcnt lgkmcnt(0)
    s_barrier
    ds_read_b128 v[8:11], v32
    s_waitcnt lgkmcnt(0)
    v_add_f32 v8, v8, v9
    v_add_f32 v10, v10, v11
    v_add_f32 v8, v8, v10
    v_cvt_pk_bf16_f32 v8, 0, v8
    v_mul_f32 v9, 0xbfb8aa3b, v8
    v_exp_f32 v9, v9
    s_nop 0
    v_add_f32 v9, 1.0, v9
    v_rcp_f32 v9, v9
    s_nop 0
    v_mul_f32 v8, v8, v9
    v_cvt_pk_bf16_f32 v36, v8, v8
    v_and_b32 v32, v4, v36
    v_and_b32 v33, v5, v36
    v_and_b32 v34, v6, v36
    v_and_b32 v35, v7, v36
    s_nop 1
    v_mfma_f32_16x16x32_bf16 v[8:11], v[32:35], a[240:243], 0
    v_mfma_f32_16x16x32_bf16 v[12:15], v[32:35], a[244:247], 0
    s_nop 7
    v_permlane32_swap_b32 v8, v12
    v_permlane32_swap_b32 v9, v13
    v_permlane32_swap_b32 v10, v14
    v_permlane32_swap_b32 v11, v15
    s_nop 0
    v_add_f32_dpp v8, v12, v8 row_ror:8 row_mask:0xf bank_mask:0xf
    v_add_f32_dpp v9, v13, v9 row_ror:8 row_mask:0xf bank_mask:0xf
    v_add_f32_dpp v10, v14, v10 row_ror:8 row_mask:0xf bank_mask:0xf
    v_add_f32_dpp v11, v15, v11 row_ror:8 row_mask:0xf bank_mask:0xf
    s_mov_b32 exec_lo, 0x00ff00ff
    s_mov_b32 exec_hi, 0x00ff00ff
    buffer_store_dwordx4 v[8:11], v39, s[12:15], s64 offen sc1
    s_mov_b64 exec, -1
L_nle_101:
    s_cmp_lg_u32 s56, 0
    s_cbranch_scc1 L_fin
    s_barrier
    v_lshrrev_b32 v30, 3, v0
    v_mul_u32_u24 v30, 196608, v30
    v_and_b32 v31, 7, v0
    v_lshl_add_u32 v31, v31, 4, v30
    v_add_u32 v30, v30, v31
    s_lshl_b32 s61, s45, 2
    s_add_u32 s61, s61, s46
    s_mul_i32 s61, s61, 12288
    s_mul_i32 s62, s44, 384
    s_add_u32 s61, s61, s62
    s_add_u32 s62, s61, 3145728
    s_cmp_ge_u32 s46, 2
    s_cbranch_scc1 L_wq2_110
    s_mul_i32 s62, s45, 24576
    s_sub_u32 s61, s61, s62
    s_add_u32 s61, s61, 6291456
    buffer_load_dwordx4 a[240:243], v31, s[16:19], s61 offen offset:0 nt
    buffer_load_dwordx4 a[244:247], v31, s[16:19], s61 offen offset:128 nt
    buffer_load_dwordx4 a[248:251], v31, s[16:19], s61 offen offset:256 nt
L_wq2_110:
    s_branch L_getx2
    .p2align 12
L_red:
    s_lshr_b32 s61, s63, 1
    s_lshl2_add_u32 s61, s61, s46
    s_lshl_b32 s61, s61, 14
    s_add_u32 s61, s61, s56
    s_add_u32 s61, s61, 704512
    s_bitcmp1_b32 s98, s45
    s_cselect_b32 s59, 8192, 0
    s_add_u32 s61, s61, s59
    s_add_u32 s62, s61, 4096
    v_and_b32 v55, 112, v3
    v_lshrrev_b32 v52, 5, v0
    v_lshl_add_u32 v54, v52, 2, v55
    v_and_b32 v52, 16, v0
    v_lshrrev_b32 v52, 1, v52
    s_lshl_b32 s60, s46, 7
    s_add_u32 s60, s60, 153600
    v_add3_u32 v54, v54, v52, s60
    v_bfe_u32 v56, v0, 3, 1
    v_mul_u32_u24 v56, 2560, v56
    v_lshrrev_b32 v52, 4, v0
    v_lshl_add_u32 v56, v52, 13, v56
    v_add_u32 v56, v56, v55
    v_add_u32 v55, 153600, v55
    s_lshl_b32 s60, s63, 7
    s_add_u32 s60, s60, s56
    s_add_u32 s60, s60, 2015232
    s_mov_b64 s[32:33], -1
    s_mov_b64 s[34:35], -1
    s_mov_b64 s[40:41], -1
    s_mov_b64 s[42:43], -1
    s_mov_b64 s[54:55], -1
    s_mov_b64 s[66:67], -1
    s_mov_b64 s[38:39], -1
    s_mov_b64 s[50:51], -1
    s_mov_b32 s59, 400000
L_poll_121:
    s_mov_b64 exec, s[32:33]
    buffer_load_dwordx4 v[8:11], v3, s[12:15], s61 offen offset:0 sc1
    s_mov_b64 exec, s[34:35]
    buffer_load_dwordx4 v[12:15], v3, s[12:15], s61 offen offset:1024 sc1
    s_mov_b64 exec, s[40:41]
    buffer_load_dwordx4 v[16:19], v3, s[12:15], s61 offen offset:2048 sc1
    s_mov_b64 exec, s[42:43]
    buffer_load_dwordx4 v[20:23], v3, s[12:15], s61 offen offset:3072 sc1
    s_mov_b64 exec, s[54:55]
    buffer_load_dwordx4 v[24:27], v3, s[12:15], s62 offen offset:0 sc1
    s_mov_b64 exec, s[66:67]
    buffer_load_dwordx4 v[28:31], v3, s[12:15], s62 offen offset:1024 sc1
    s_mov_b64 exec, s[38:39]
    buffer_load_dwordx4 v[32:35], v3, s[12:15], s62 offen offset:2048 sc1
    s_mov_b64 exec, s[50:51]
    buffer_load_dwordx4 v[36:39], v3, s[12:15], s62 offen offset:3072 sc1
    s_mov_b64 exec, -1
    s_waitcnt vmcnt(5)
    v_max_u32 v52, v8, v9
    v_max3_u32 v52, v52, v10, v11
    v_cmp_eq_u32 s[32:33], -1, v52
    v_max_u32 v53, v12, v13
    v_max3_u32 v53, v53, v14, v15
    v_cmp_eq_u32 s[34:35], -1, v53
    v_max_u32 v52, v16, v17
    v_max3_u32 v52, v52, v18, v19
    v_cmp_eq_u32 s[40:41], -1, v52
    s_or_b64 vcc, s[32:33], s[34:35]
    s_waitcnt vmcnt(0)
    v_max_u32 v53, v20, v21
    v_max3_u32 v53, v53, v22, v23
    v_cmp_eq_u32 s[42:43], -1, v53
    s_or_b64 vcc, vcc, s[40:41]
    v_max_u32 v52, v24, v25
    v_max3_u32 v52, v52, v26, v27
    v_cmp_eq_u32 s[54:55], -1, v52
    s_or_b64 vcc, vcc, s[42:43]
    v_max_u32 v53, v28, v29
    v_max3_u32 v53, v53, v30, v31
    v_cmp_eq_u32 s[66:67], -1, v53
    s_or_b64 vcc, vcc, s[54:55]
    v_max_u32 v52, v32, v33
    v_max3_u32 v52, v52, v34, v35
    v_cmp_eq_u32 s[38:39], -1, v52
    s_or_b64 vcc, vcc, s[66:67]
    v_max_u32 v53, v36, v37
    v_max3_u32 v53, v53, v38, v39
    v_cmp_eq_u32 s[50:51], -1, v53
    s_or_b64 vcc, vcc, s[38:39]
    s_or_b64 vcc, vcc, s[50:51]
    s_cbranch_scc0 L_got_122
    s_sub_u32 s59, s59, 1
    s_cbranch_scc0 L_poll_121
L_got_122:
    v_pk_add_f32 v[8:9], v[8:9], v[24:25]
    v_pk_add_f32 v[10:11], v[10:11], v[26:27]
    v_pk_add_f32 v[12:13], v[12:13], v[28:29]
    v_pk_add_f32 v[14:15], v[14:15], v[30:31]
    v_pk_add_f32 v[16:17], v[16:17], v[32:33]
    v_pk_add_f32 v[18:19], v[18:19], v[34:35]
    v_pk_add_f32 v[20:21], v[20:21], v[36:37]
    v_pk_add_f32 v[22:23], v[22:23], v[38:39]
    v_pk_add_f32 v[8:9], v[8:9], v[16:17]
    v_pk_add_f32 v[10:11], v[10:11], v[18:19]
    v_pk_add_f32 v[12:13], v[12:13], v[20:21]
    v_pk_add_f32 v[14:15], v[14:15], v[22:23]
    v_pk_add_f32 v[8:9], v[8:9], v[12:13]
    v_pk_add_f32 v[10:11], v[10:11], v[14:15]
    s_nop 1
    v_permlane32_swap_b32 v8, v9
    v_permlane32_swap_b32 v10, v11
    s_nop 0
    v_add_f32 v8, v8, v9
    v_add_f32 v10, v10, v11
    s_nop 1
    v_permlane16_swap_b32 v8, v10
    s_nop 1
    v_add_f32 v8, v8, v10
    s_nop 1
    v_add_f32_dpp v8, v8, v8 row_ror:8 row_mask:0xf bank_mask:0xf
    ds_write_b32 v54, v8
    ds_read_b128 v[24:27], v55 offset:7424
    s_waitcnt lgkmcnt(0)
    s_barrier
    s_cmp_lg_u32 s46, 0
    s_cbranch_scc1 L_reddone_123
    ds_read_b128 v[8:11], v55
    ds_read_b128 v[12:15], v55 offset:128
    ds_read_b128 v[16:19], v55 offset:256
    ds_read_b128 v[20:23], v55 offset:384
    s_waitcnt lgkmcnt(0)
    v_pk_add_f32 v[8:9], v[8:9], v[16:17]
    v_pk_add_f32 v[10:11], v[10:11], v[18:19]
    v_pk_add_f32 v[12:13], v[12:13], v[20:21]
    v_pk_add_f32 v[14:15], v[14:15], v[22:23]
    v_pk_add_f32 v[8:9], v[8:9], v[12:13]
    v_pk_add_f32 v[10:11], v[10:11], v[14:15]
    v_cvt_pk_bf16_f32 v8, 0, v8
    v_cvt_pk_bf16_f32 v9, 0, v9
    v_cvt_pk_bf16_f32 v10, 0, v10
    v_cvt_pk_bf16_f32 v11, 0, v11
    v_pk_add_f32 v[8:9], v[8:9], v[24:25]
    v_pk_add_f32 v[10:11], v[10:11], v[26:27]
    v_cvt_pk_bf16_f32 v8, 0, v8
    v_cvt_pk_bf16_f32 v9, 0, v9
    v_cvt_pk_bf16_f32 v10, 0, v10
    v_cvt_pk_bf16_f32 v11, 0, v11
    buffer_store_dwordx4 v[8:11], v56, s[12:15], s60 offen sc1
    ds_write_b128 v55, v[8:11] offset:7424
    s_waitcnt lgkmcnt(0)
L_reddone_123:
    s_barrier
    s_cmp_lg_u32 s56, 0
    s_cbranch_scc1 L_nowq_120
    v_lshrrev_b32 v30, 3, v0
    v_mul_u32_u24 v30, 196608, v30
    v_and_b32 v31, 7, v0
    v_lshl_add_u32 v31, v31, 4, v30
    v_add_u32 v30, v30, v31
    s_lshl_b32 s61, s45, 2
    s_add_u32 s61, s61, s46
    s_mul_i32 s61, s61, 12288
    s_mul_i32 s62, s44, 384
    s_add_u32 s61, s61, s62
    s_add_u32 s62, s61, 3145728
    buffer_load_dwordx4 v[52:55], v30, s[16:19], s61 offen offset:0 nt
    buffer_load_dwordx4 v[56:59], v30, s[16:19], s61 offen offset:128 nt
    buffer_load_dwordx4 v[60:63], v30, s[16:19], s61 offen offset:256 nt
    buffer_load_dwordx4 v[64:67], v30, s[16:19], s62 offen offset:0 nt
    buffer_load_dwordx4 v[68:71], v30, s[16:19], s62 offen offset:128 nt
    buffer_load_dwordx4 v[72:75], v30, s[16:19], s62 offen offset:256 nt
    s_cmp_ge_u32 s46, 2
    s_cbranch_scc1 L_wq2_124
    s_mul_i32 s62, s45, 24576
    s_sub_u32 s61, s61, s62
    s_add_u32 s61, s61, 6291456
    buffer_load_dwordx4 a[240:243], v31, s[16:19], s61 offen offset:0 nt
    buffer_load_dwordx4 a[244:247], v31, s[16:19], s61 offen offset:128 nt
    buffer_load_dwordx4 a[248:251], v31, s[16:19], s61 offen offset:256 nt
L_wq2_124:
L_nowq_120:
    s_lshr_b32 s61, s63, 1
    s_lshl2_add_u32 s61, s61, s46
    s_lshl_b32 s61, s61, 14
    s_add_u32 s61, s61, s56
    s_add_u32 s61, s61, 1359872
    s_bitcmp1_b32 s98, s45
    s_cselect_b32 s59, 8192, 0
    s_add_u32 s61, s61, s59
    s_add_u32 s62, s61, 4096
    v_and_b32 v35, 112, v3
    v_lshrrev_b32 v32, 5, v0
    v_lshl_add_u32 v34, v32, 2, v35
    v_and_b32 v32, 16, v0
    v_lshrrev_b32 v32, 1, v32
    s_lshl_b32 s60, s46, 7
    s_add_u32 s60, s60, 153600
    v_add3_u32 v34, v34, v32, s60
    v_bfe_u32 v36, v0, 3, 1
    v_mul_u32_u24 v36, 2560, v36
    v_lshrrev_b32 v32, 4, v0
    v_lshl_add_u32 v36, v32, 13, v36
    v_add_u32 v36, v36, v35
    v_add_u32 v35, 153600, v35
    s_lshl_b32 s60, s63, 7
    s_add_u32 s60, s60, s56
    s_add_u32 s60, s60, 2048000
    s_mov_b64 s[32:33], -1
    s_mov_b64 s[34:35], -1
    s_mov_b64 s[40:41], -1
    s_mov_b64 s[42:43], -1
    s_mov_b64 s[54:55], -1
    s_mov_b64 s[66:67], -1
    s_mov_b32 s38, 1280
    s_mov_b32 s39, 0x20000
    s_mov_b32 s59, 400000
L_poll_125:
    s_mov_b64 exec, s[32:33]
    buffer_load_dwordx4 v[8:11], v3, s[12:15], s61 offen offset:0 sc1
    s_mov_b64 exec, s[34:35]
    buffer_load_dwordx4 v[12:15], v3, s[12:15], s61 offen offset:1024 sc1
    s_mov_b64 exec, s[40:41]
    buffer_load_dwordx4 v[16:19], v3, s[12:15], s61 offen offset:2048 sc1
    s_mov_b64 exec, s[42:43]
    buffer_load_dwordx4 v[20:23], v3, s[12:15], s61 offen offset:3072 sc1
    s_mov_b64 exec, s[54:55]
    buffer_load_dwordx4 v[24:27], v3, s[12:15], s62 offen offset:0 sc1
    s_mov_b64 exec, s[66:67]
    buffer_load_dwordx4 v[28:31], v3, s[12:15], s62 offen offset:1024 sc1
    s_mov_b64 exec, -1
    s_waitcnt vmcnt(3)
    v_max_u32 v32, v8, v9
    v_max3_u32 v32, v32, v10, v11
    v_cmp_eq_u32 s[32:33], -1, v32
    v_max_u32 v33, v12, v13
    v_max3_u32 v33, v33, v14, v15
    v_cmp_eq_u32 s[34:35], -1, v33
    v_max_u32 v32, v16, v17
    v_max3_u32 v32, v32, v18, v19
    v_cmp_eq_u32 s[40:41], -1, v32
    s_or_b64 vcc, s[32:33], s[34:35]
    s_waitcnt vmcnt(0)
    v_max_u32 v33, v20, v21
    v_max3_u32 v33, v33, v22, v23
    v_cmp_eq_u32 s[42:43], -1, v33
    s_or_b64 vcc, vcc, s[40:41]
    v_max_u32 v32, v24, v25
    v_max3_u32 v32, v32, v26, v27
    v_cmp_eq_u32 s[54:55], -1, v32
    s_or_b64 vcc, vcc, s[42:43]
    v_max_u32 v33, v28, v29
    v_max3_u32 v33, v33, v30, v31
    v_cmp_eq_u32 s[66:67], -1, v33
    s_or_b64 vcc, vcc, s[54:55]
    s_or_b64 vcc, vcc, s[66:67]
    s_cbranch_scc0 L_got_126
    s_sub_u32 s59, s59, 1
    s_cbranch_scc0 L_poll_125
L_got_126:
    v_pk_add_f32 v[8:9], v[8:9], v[20:21]
    v_pk_add_f32 v[10:11], v[10:11], v[22:23]
    v_pk_add_f32 v[12:13], v[12:13], v[24:25]
    v_pk_add_f32 v[14:15], v[14:15], v[26:27]
    v_pk_add_f32 v[16:17], v[16:17], v[28:29]
    v_pk_add_f32 v[18:19], v[18:19], v[30:31]
    v_pk_add_f32 v[8:9], v[8:9], v[16:17]
    v_pk_add_f32 v[10:11], v[10:11], v[18:19]
    v_pk_add_f32 v[8:9], v[8:9], v[12:13]
    v_pk_add_f32 v[10:11], v[10:11], v[14:15]
    s_nop 1
    v_permlane32_swap_b32 v8, v9
    v_permlane32_swap_b32 v10, v11
    s_nop 0
    v_add_f32 v8, v8, v9
    v_add_f32 v10, v10, v11
    s_nop 1
    v_permlane16_swap_b32 v8, v10
    s_nop 1
    v_add_f32 v8, v8, v10
    s_nop 1
    v_add_f32_dpp v8, v8, v8 row_ror:8 row_mask:0xf bank_mask:0xf
    ds_write_b32 v34, v8
    ds_read_b128 v[24:27], v35 offset:7424
    s_waitcnt lgkmcnt(0)
    s_barrier
    s_cmp_lg_u32 s46, 0
    s_cbranch_scc1 L_reddone_127
    ds_read_b128 v[8:11], v35
    ds_read_b128 v[12:15], v35 offset:128
    ds_read_b128 v[16:19], v35 offset:256
    ds_read_b128 v[20:23], v35 offset:384
    s_waitcnt lgkmcnt(0)
    v_pk_add_f32 v[8:9], v[8:9], v[16:17]
    v_pk_add_f32 v[10:11], v[10:11], v[18:19]
    v_pk_add_f32 v[12:13], v[12:13], v[20:21]
    v_pk_add_f32 v[14:15], v[14:15], v[22:23]
    v_pk_add_f32 v[8:9], v[8:9], v[12:13]
    v_pk_add_f32 v[10:11], v[10:11], v[14:15]
    v_cvt_pk_bf16_f32 v8, 0, v8
    v_cvt_pk_bf16_f32 v9, 0, v9
    v_cvt_pk_bf16_f32 v10, 0, v10
    v_cvt_pk_bf16_f32 v11, 0, v11
    v_pk_add_f32 v[8:9], v[8:9], v[24:25]
    v_pk_add_f32 v[10:11], v[10:11], v[26:27]
    s_cmp_eq_u32 s56, 0
    s_cbranch_scc1 L_notfinal_128
    v_cvt_pk_bf16_f32 v12, v8, v9
    v_cvt_pk_bf16_f32 v13, v10, v11
    v_lshlrev_b32 v33, 3, v0
    s_lshl_b32 s60, s63, 6
    s_mov_b64 exec, 0xff
    buffer_store_dwordx2 v[12:13], v33, s[36:39], s60 offen
    s_mov_b64 exec, -1
    s_branch L_reddone_127
L_notfinal_128:
    v_cvt_pk_bf16_f32 v8, 0, v8
    v_cvt_pk_bf16_f32 v9, 0, v9
    v_cvt_pk_bf16_f32 v10, 0, v10
    v_cvt_pk_bf16_f32 v11, 0, v11
    buffer_store_dwordx4 v[8:11], v36, s[12:15], s60 offen sc1
    ds_write_b128 v35, v[8:11] offset:7424
    s_waitcnt lgkmcnt(0)
L_reddone_127:
    s_cmp_eq_u32 s56, 0
    s_cbranch_scc1 L_getx2
L_fin:
    s_waitcnt vmcnt(0)
    s_waitcnt vmcnt(0)
L_end:
    s_endpgm
.section .rodata,"a"
.p2align 6
.amdhsa_kernel interleave_layers__mha_block_cached__dense_activation_silu__decode_kernel
  .amdhsa_next_free_vgpr 512
  .amdhsa_next_free_sgpr 102
  .amdhsa_accum_offset 256
  .amdhsa_group_segment_fixed_size 0
  .amdhsa_kernarg_size 88
  .amdhsa_user_sgpr_count 2
  .amdhsa_user_sgpr_kernarg_segment_ptr 1
  .amdhsa_system_sgpr_workgroup_id_x 1
.end_amdhsa_kernel
```
